```python
import torch

def _softmax(x, axis=-1):
    return torch.softmax(x, dim=axis)
def _gelu(x):
    return torch.nn.functional.gelu(x, approximate="tanh")
def _silu(x):
    return torch.nn.functional.silu(x)
def _sigmoid(x):
    return torch.sigmoid(x)
def _layernorm(x, axis=-1, eps=1e-5):
    m = x.mean(dim=axis, keepdim=True)
    v = x.var(dim=axis, keepdim=True, unbiased=False)
    return (x - m) / torch.sqrt(v + eps)
def _scatter_add(tgt, idx, src, axis=0):
    return tgt.clone().index_add_(axis, idx, src)
def _segment_sum(src, seg, n):
    out = torch.zeros((n,) + src.shape[1:], dtype=src.dtype)
    return out.index_add_(0, seg, src)
def _pad(x, pw):
    flat = tuple(v for pair in reversed(pw) for v in pair)
    return torch.nn.functional.pad(x, flat)

kernel_name = 'recurrent_scan__mha_block_cached__moe_arch_mod__prompt'

def setup_inputs():

    _w = (lambda a: (lambda t: t.to(torch.bfloat16) if t.is_floating_point() else t)(torch.as_tensor(a)))
    def _A_setup():
        B, Sq, D = 1, 2048, 512
        H, Sk, Dh = 32, 2048, 128
        return {
            "x": _w((lambda *s: torch.randn(*s, dtype=torch.bfloat16) * 0.05)(B, Sq, D)),
            "k_cache": _w((lambda *s: torch.randn(*s, dtype=torch.bfloat16) * 1.6)(B, H, Sk, Dh)),
            "v_cache": _w((lambda *s: torch.randn(*s, dtype=torch.bfloat16) * 0.2)(B, H, Sk, Dh)),
            "wq": _w((lambda *s: torch.randn(*s, dtype=torch.bfloat16) * 1.6)(D, H * Dh) * (D ** -0.5)),
            "wo": _w((lambda *s: torch.randn(*s, dtype=torch.bfloat16) * 0.2)(H * Dh, D) * ((H * Dh) ** -0.5)),
        }
    _A_in = _A_setup()

    def _B_setup():
        B, S, D, F, C = 1, 2048, 512, 1792, 8
        return {
            "x": _w((lambda *s: torch.randn(*s, dtype=torch.bfloat16) * 0.05)(B, S, D)),
            "w_r": _w((lambda *s: torch.randn(*s, dtype=torch.bfloat16) * 0.2)(D)),
            "w_gate": _w((lambda *s: torch.randn(*s, dtype=torch.bfloat16) * 0.1)(D, F)),
            "w_up": _w((lambda *s: torch.randn(*s, dtype=torch.bfloat16) * 0.1)(D, F)),
            "w_down": _w((lambda *s: torch.randn(*s, dtype=torch.bfloat16) * 0.1)(F, D)),
        }
    _B_in = _B_setup()

    return {
        "A_x": _A_in["x"],
        "A_k_cache": _A_in["k_cache"],
        "A_v_cache": _A_in["v_cache"],
        "A_wq": _A_in["wq"],
        "A_wo": _A_in["wo"],
        "B_x": _B_in["x"],
        "B_w_r": _B_in["w_r"],
        "B_w_gate": _B_in["w_gate"],
        "B_w_up": _B_in["w_up"],
        "B_w_down": _B_in["w_down"],
    }

def reference(A_x, A_k_cache, A_v_cache, A_wq, A_wo, B_x, B_w_r, B_w_gate, B_w_up, B_w_down):
    def _A_ref(x, k_cache, v_cache, wq, wo):
        B, Sq, D = x.shape
        H, Dh = 32, 128
        q = (lambda x, *d: x.permute(*d))((x @ wq).reshape(B, Sq, H, Dh), 0, 2, 1, 3)
        scores = torch.einsum("bhqd,bhkd->bhqk", q, k_cache) * (Dh ** -0.5)
        p = _softmax(scores, axis=-1)
        o = torch.einsum("bhqk,bhkd->bhqd", p, v_cache)
        return (lambda x, *d: x.permute(*d))(o, 0, 2, 1, 3).reshape(B, Sq, H * Dh) @ wo

    def _B_ref(x, w_r, w_gate, w_up, w_down):
        B, S, D = x.shape
        C = 8
        r = x @ w_r
        idx = torch.argsort(-r, axis=-1)[:, :C]
        idx_e = (lambda x, n, axis: torch.repeat_interleave(x, n, dim=axis))(idx.reshape(B, C, 1), D, axis=2)
        x_sel = (lambda x, i, axis: torch.take_along_dim(x, i, dim=axis))(x, idx_e, axis=1)
        g = _silu(x_sel @ w_gate)
        u = x_sel @ w_up
        y = (g * u) @ w_down
        r_sel = _sigmoid((lambda x, i, axis: torch.take_along_dim(x, i, dim=axis))(r, idx, axis=1))
        y = y * r_sel.reshape(B, C, 1)
        b_off = (torch.arange(B) * S).reshape(B, 1)
        flat_idx = (idx + b_off).reshape(B * C)
        zero = (x * 0.0).reshape(B * S, D)
        upd = _scatter_add(zero, flat_idx, y.reshape(B * C, D), axis=0)
        return x + upd.reshape(B, S, D)

    x = A_x
    xn = _layernorm(x, axis=-1)
    s = _A_ref(xn, A_k_cache, A_v_cache, A_wq, A_wo)
    g = _silu(_B_ref(xn, B_w_r, B_w_gate, B_w_up, B_w_down))
    return x + s * g
```

```asm
; @launch grid=(256,1,1) block=(256,1,1) lds=163840
.amdgcn_target "amdgcn-amd-amdhsa--gfx950"
.text
.p2align 12
.globl recurrent_scan__mha_block_cached__moe_arch_mod__prompt_kernel
.p2align 8
.type recurrent_scan__mha_block_cached__moe_arch_mod__prompt_kernel,@function
recurrent_scan__mha_block_cached__moe_arch_mod__prompt_kernel:
    s_cmp_ge_u32 s2, 256
    s_cbranch_scc1 L_end
    s_load_dwordx16 s[36:51], s[0:1], 0
    s_load_dwordx8 s[52:59], s[0:1], 64
    s_load_dwordx2 s[60:61], s[0:1], 96
    s_memrealtime s[68:69]
    s_getpc_b64 s[32:33]
    v_lshrrev_b32 v1, 6, v0
    v_and_b32 v0, 63, v0
    s_and_b32 s3, s2, 0xf8
    s_lshl_b32 s3, s3, 1
    v_lshl_add_u32 v4, v1, 2, v0
    v_add_lshl_u32 v4, v4, s3, 7
    v_min_u32 v4, L_end-recurrent_scan__mha_block_cached__moe_arch_mod__prompt_kernel-128, v4
    s_mov_b64 exec, 15
    global_load_dword v23, v4, s[32:33]
    s_mov_b64 exec, -1
    v_readfirstlane_b32 s20, v1
    s_and_b32 s3, s2, 7
    s_lshl_b32 s3, s3, 2
    s_bfe_u32 s21, s2, 0x20003
    s_or_b32 s21, s21, s3
    s_lshr_b32 s22, s2, 5
    v_lshrrev_b32 v1, 4, v0
    v_and_b32 v2, 15, v0
    v_lshrrev_b32 v4, 3, v0
    s_lshl_b32 s3, s20, 6
    v_add_u32 v4, s3, v4
    v_lshlrev_b32 v4, 10, v4
    v_and_b32 v5, 7, v0
    v_xor_b32 v6, v5, v1
    v_xor_b32 v7, 4, v6
    v_lshl_add_u32 v6, v6, 4, v4
    v_lshl_add_u32 v7, v7, 4, v4
    v_add_u32 v76, 0, v6
    v_add_u32 v77, 7168, v7
    v_add_u32 v78, 14336, v6
    v_add_u32 v79, 21504, v7
    v_add_u32 v80, 32768, v6
    v_add_u32 v81, 39936, v7
    v_add_u32 v82, 47104, v6
    v_add_u32 v83, 54272, v7
    s_lshl_b32 s3, s20, 4
    v_add_u32 v4, s3, v1
    v_lshlrev_b32 v4, 13, v4
    v_lshlrev_b32 v5, 1, v1
    v_xor_b32 v6, v5, v2
    v_xor_b32 v7, 8, v6
    v_lshl_add_u32 v6, v6, 4, v4
    v_lshl_add_u32 v7, v7, 4, v4
    v_add_u32 v84, 0, v6
    v_add_u32 v85, 31744, v6
    v_add_u32 v86, 63488, v7
    v_add_u32 v87, 95232, v7
    s_lshl_b32 s62, s20, 13
    s_lshl_b32 s25, s20, 12
    s_add_u32 s63, s25, 0xC000
    s_and_b32 s3, s22, 6
    s_lshl_b32 s34, s3, 7
    s_lshl_b32 s35, s3, 19
    s_mov_b32 s6, 0x40000
    s_mov_b32 s7, 0x20000
    s_mov_b32 s31, 0x20000
    s_lshl_b32 s3, s22, 18
    s_lshl_b32 s67, s21, 8
    s_sub_u32 s30, 0x400000, s67
    s_waitcnt lgkmcnt(0)
    s_add_u32 s4, s36, s3
    s_addc_u32 s5, s37, 0
    s_add_u32 s28, s42, s67
    s_addc_u32 s29, s43, 0
    s_or_b32 s3, s2, s20
    s_cbranch_scc1 L_nononce
    s_getreg_b32 s3, hwreg(HW_REG_XCC_ID, 0, 1)
    s_lshl_b32 s68, s68, 2
    s_lshl_b32 s3, s3, 1
    s_or_b32 s68, s68, s3
    s_or_b32 s68, s68, 1
    v_mov_b32 v4, 0
    v_mov_b32 v5, s68
    global_store_dword v4, v5, s[58:59] sc1
L_nononce:
    s_add_u32 m0, s63, 0
    s_nop 0
    buffer_load_dwordx4 v84, s[28:31], s35 offen offset:0 lds
    v_lshlrev_b32 v3, 4, v0
    s_lshl_b32 s3, s21, 2
    s_add_u32 s3, s3, s20
    s_lshl_b32 s66, s3, 11
    v_lshrrev_b32 v4, 1, v2
    buffer_load_dwordx4 v85, s[28:31], s35 offen offset:1024 lds
    v_xor_b32 v4, v4, v1
    v_lshl_add_u32 v5, v2, 7, s62
    v_lshl_add_u32 v6, v4, 4, v5
    v_add_u32 v88, 0x18000, v6
    v_add_u32 v90, 16384, v6
    buffer_load_dwordx4 v86, s[28:31], s35 offen offset:2048 lds
    v_xor_b32 v89, 64, v88
    v_xor_b32 v91, 64, v90
    v_lshrrev_b32 v4, 2, v2
    v_and_b32 v63, 3, v0
    v_and_b32 v6, 1, v1
    buffer_load_dwordx4 v87, s[28:31], s35 offen offset:3072 lds
    v_lshl_add_u32 v60, v6, 2, v4
    v_lshl_add_u32 v5, v1, 3, v4
    v_lshlrev_b32 v5, 8, v5
    v_lshl_add_u32 v5, v63, 3, v5
    v_lshl_add_u32 v5, v60, 5, v5
    s_add_u32 s35, s35, 0x80000
    s_bitset0_b32 s35, 22
    s_add_u32 m0, s62, 98304
    s_nop 0
    buffer_load_dwordx4 v76, s[4:7], s34 offen offset:0 lds
    s_lshl_b32 s3, s20, 6
    s_add_u32 s3, s3, 0xC000
    v_xor_b32 v92, s3, v5
    v_xor_b32 v93, 32, v92
    v_xor_b32 v94, 64, v92
    buffer_load_dwordx4 v77, s[4:7], s34 offen offset:1024 lds
    v_xor_b32 v95, 96, v92
    v_xor_b32 v96, 128, v92
    v_xor_b32 v97, 160, v92
    v_xor_b32 v98, 192, v92
    v_xor_b32 v99, 224, v92
    buffer_load_dwordx4 v78, s[4:7], s34 offen offset:2048 lds
    v_mov_b32 v100, 0
    v_mov_b32 v101, 0
    v_mov_b32 v102, 0
    v_mov_b32 v103, 0
    v_mov_b32 v104, 0
    buffer_load_dwordx4 v79, s[4:7], s34 offen offset:3072 lds
    v_mov_b32 v105, 0
    v_mov_b32 v106, 0
    v_mov_b32 v107, 0
    v_mov_b32 v62, 0x3f803f80
    v_cmp_gt_u32 vcc, 2, v63
    s_add_u32 m0, s62, 102400
    s_nop 0
    buffer_load_dwordx4 v80, s[4:7], s34 offen offset:0 lds
    v_and_b32 v4, 1, v0
    v_mov_b32 v5, 0x44444444
    v_mov_b32 v6, 0xeeeeeeee
    v_cndmask_b32 v24, 0, v62, vcc
    v_cndmask_b32 v25, 0, v62, vcc
    buffer_load_dwordx4 v81, s[4:7], s34 offen offset:1024 lds
    v_cndmask_b32 v26, 0, v62, vcc
    v_cndmask_b32 v27, 0, v62, vcc
    v_cmp_eq_u32 vcc, 1, v4
    s_lshl_b32 s1, s22, 2
    s_add_u32 s1, s1, s20
    buffer_load_dwordx4 v82, s[4:7], s34 offen offset:2048 lds
    v_cndmask_b32 v22, v5, v6, vcc
    s_lshl_b32 s1, s1, 9
    s_add_u32 s1, s1, 16777216
    buffer_load_dwordx4 v83, s[4:7], s34 offen offset:3072 lds
    s_add_u32 s34, s34, 128
    s_bitset0_b32 s34, 10
    s_add_u32 m0, s63, 16384
    s_nop 0
    buffer_load_dwordx4 v84, s[28:31], s35 offen offset:0 lds
    v_lshl_add_u32 v61, v1, 8, s25
    v_xor_b32 v62, v1, v2
    v_mfma_f32_32x32x16_bf16 a[0:15], v[104:107], v[104:107], 0
    v_lshl_add_u32 v16, v62, 4, v61
    v_xor_b32 v17, 64, v16
    v_xor_b32 v18, 128, v16
    buffer_load_dwordx4 v85, s[28:31], s35 offen offset:1024 lds
    v_xor_b32 v19, 192, v16
    v_lshlrev_b32 v62, 1, v1
    v_xor_b32 v62, v62, v2
    v_lshl_add_u32 v20, v62, 4, v61
    v_mfma_f32_32x32x16_bf16 a[16:31], v[104:107], v[104:107], 0
    v_xor_b32 v21, 128, v20
    buffer_load_dwordx4 v86, s[28:31], s35 offen offset:2048 lds
    v_lshrrev_b32 v61, 2, v0
    v_lshlrev_b32 v61, 8, v61
    v_lshl_add_u32 v61, v63, 3, v61
    v_lshl_add_u32 v61, v60, 5, v61
    v_add_u32 v8, 65536, v61
    v_xor_b32 v9, 32, v8
    buffer_load_dwordx4 v87, s[28:31], s35 offen offset:3072 lds
    v_mfma_f32_32x32x16_bf16 a[32:47], v[104:107], v[104:107], 0
    v_xor_b32 v10, 64, v8
    v_xor_b32 v11, 96, v8
    v_xor_b32 v12, 128, v8
    v_xor_b32 v13, 160, v8
    v_xor_b32 v14, 192, v8
    s_add_u32 s35, s35, 0x80000
    s_bitset0_b32 s35, 22
    s_add_u32 m0, s62, 131072
    s_nop 0
    buffer_load_dwordx4 v76, s[4:7], s34 offen offset:0 lds
    v_xor_b32 v15, 224, v8
    v_lshrrev_b32 v61, 1, v1
    v_mfma_f32_32x32x16_bf16 a[48:63], v[104:107], v[104:107], 0
    v_and_b32 v62, 1, v1
    v_lshl_add_u32 v62, v62, 1, v61
    v_lshl_add_u32 v62, s20, 2, v62
    buffer_load_dwordx4 v77, s[4:7], s34 offen offset:1024 lds
    v_xor_b32 v61, v62, v2
    v_lshlrev_b32 v61, 4, v61
    v_lshl_add_u32 v4, v2, 8, v61
    v_xor_b32 v5, 64, v4
    v_mfma_f32_32x32x16_bf16 a[64:79], v[104:107], v[104:107], 0
    v_xor_b32 v6, 128, v4
    buffer_load_dwordx4 v78, s[4:7], s34 offen offset:2048 lds
    v_xor_b32 v7, 192, v4
    v_xor_b32 v61, v62, v63
    v_lshlrev_b32 v61, 4, v61
    v_lshl_add_u32 v108, v63, 8, v61
    v_xor_b32 v109, 64, v108
    v_xor_b32 v110, 128, v108
    buffer_load_dwordx4 v79, s[4:7], s34 offen offset:3072 lds
    v_mfma_f32_32x32x16_bf16 a[80:95], v[104:107], v[104:107], 0
    v_xor_b32 v111, 192, v108
    s_add_u32 s67, s62, 131072
    v_lshl_add_u32 v62, v2, 2, s67
    v_lshlrev_b32 v61, 3, v2
    v_lshl_add_u32 v124, v1, 4, s67
    s_add_u32 m0, s62, 135168
    s_nop 0
    buffer_load_dwordx4 v80, s[4:7], s34 offen offset:0 lds
    v_xor_b32 v125, 8192, v124
    v_xor_b32 v126, 16384, v124
    v_mfma_f32_32x32x16_bf16 a[96:111], v[104:107], v[104:107], 0
    v_xor_b32 v127, 24576, v124
    v_mov_b32 v1, v20
    v_mov_b32 v2, v21
    buffer_load_dwordx4 v81, s[4:7], s34 offen offset:1024 lds
    s_lshl_b32 s3, s21, 19
    s_add_u32 s8, s38, s3
    s_addc_u32 s9, s39, 0
    s_add_u32 s12, s40, s3
    s_addc_u32 s13, s41, 0
    s_mov_b32 s10, 0x80000
    v_mfma_f32_32x32x16_bf16 a[112:127], v[104:107], v[104:107], 0
    s_mov_b32 s11, 0x20000
    buffer_load_dwordx4 v82, s[4:7], s34 offen offset:2048 lds
    s_mov_b32 s14, 0x80000
    s_mov_b32 s15, 0x20000
    s_mov_b32 s16, s60
    s_mov_b32 s17, s61
    s_mov_b32 s18, 0x10000000
    s_mov_b32 s19, 0x20000
    buffer_load_dwordx4 v83, s[4:7], s34 offen offset:3072 lds
    s_lshl_b32 s23, s21, 14
    s_mov_b32 s24, s23
    s_mov_b32 s33, 0x100000
    s_add_u32 s26, s25, 65536
    s_add_u32 s34, s34, 128
    s_bitset0_b32 s34, 10
    buffer_load_dwordx4 v[64:67], v3, s[4:7], s66 offen
    buffer_load_dwordx4 v[68:71], v3, s[4:7], s66 offen offset:1024
    global_load_dwordx4 v[72:75], v3, s[48:49]
    v_mov_b32 v55, 0
    s_lshl_b32 s3, s22, 8
    s_lshr_b32 s66, s66, 10
    s_add_u32 s66, s66, s3
    s_waitcnt vmcnt(15) lgkmcnt(0)
    s_barrier
    ds_read_b128 a[128:131], v88 offset:0
    ds_read_b128 a[132:135], v89 offset:0
    ds_read_b128 a[136:139], v88 offset:2048
    ds_read_b128 a[140:143], v89 offset:2048
    ds_read_b128 a[144:147], v88 offset:4096
    ds_read_b128 a[148:151], v89 offset:4096
    ds_read_b128 a[152:155], v88 offset:6144
    ds_read_b128 a[156:159], v89 offset:6144
    ds_read_b64_tr_b16 a[192:193], v92 offset:0
    ds_read_b64_tr_b16 a[194:195], v92 offset:1024
    ds_read_b64_tr_b16 a[196:197], v92 offset:8192
    ds_read_b64_tr_b16 a[198:199], v92 offset:9216
    ds_read_b64_tr_b16 a[200:201], v93 offset:0
    ds_read_b64_tr_b16 a[202:203], v93 offset:1024
    ds_read_b64_tr_b16 a[204:205], v93 offset:8192
    ds_read_b64_tr_b16 a[206:207], v93 offset:9216
    s_waitcnt lgkmcnt(4)
    v_mfma_f32_16x16x32_bf16 v[224:227], a[192:195], a[128:131], 0
    s_add_u32 m0, s63, 32768
    ds_read_b64_tr_b16 a[208:209], v94 offset:0
    v_mfma_f32_16x16x32_bf16 v[224:227], a[196:199], a[132:135], v[224:227]
    buffer_load_dwordx4 v84, s[28:31], s35 offen offset:0 lds
    v_mfma_f32_16x16x32_bf16 v[232:235], a[196:199], a[140:143], 0
    ds_read_b64_tr_b16 a[210:211], v94 offset:1024
    v_mfma_f32_16x16x32_bf16 v[232:235], a[192:195], a[136:139], v[232:235]
    v_mfma_f32_16x16x32_bf16 v[240:243], a[192:195], a[144:147], 0
    ds_read_b64_tr_b16 a[212:213], v94 offset:8192
    v_mfma_f32_16x16x32_bf16 v[240:243], a[196:199], a[148:151], v[240:243]
    buffer_load_dwordx4 v85, s[28:31], s35 offen offset:1024 lds
    v_mfma_f32_16x16x32_bf16 v[248:251], a[196:199], a[156:159], 0
    ds_read_b64_tr_b16 a[214:215], v94 offset:9216
    v_mfma_f32_16x16x32_bf16 v[248:251], a[192:195], a[152:155], v[248:251]
    buffer_load_dwordx4 v86, s[28:31], s35 offen offset:2048 lds
    v_smfmac_f32_16x16x64_bf16 v[100:103], v[24:27], a[192:199], v22
    s_waitcnt lgkmcnt(4)
    v_mfma_f32_16x16x32_bf16 v[228:231], a[200:203], a[128:131], 0
    ds_read_b64_tr_b16 a[216:217], v95 offset:0
    v_mfma_f32_16x16x32_bf16 v[228:231], a[204:207], a[132:135], v[228:231]
    buffer_load_dwordx4 v87, s[28:31], s35 offen offset:3072 lds
    v_mfma_f32_16x16x32_bf16 v[236:239], a[204:207], a[140:143], 0
    s_add_u32 s35, s35, 0x80000
    ds_read_b64_tr_b16 a[218:219], v95 offset:1024
    v_mfma_f32_16x16x32_bf16 v[236:239], a[200:203], a[136:139], v[236:239]
    s_bitset0_b32 s35, 22
    v_mfma_f32_16x16x32_bf16 v[244:247], a[200:203], a[144:147], 0
    s_add_u32 m0, s62, 16384
    ds_read_b64_tr_b16 a[220:221], v95 offset:8192
    v_mfma_f32_16x16x32_bf16 v[244:247], a[204:207], a[148:151], v[244:247]
    buffer_load_dwordx4 v76, s[4:7], s34 offen offset:0 lds
    v_mfma_f32_16x16x32_bf16 v[252:255], a[204:207], a[156:159], 0
    ds_read_b64_tr_b16 a[222:223], v95 offset:9216
    v_mfma_f32_16x16x32_bf16 v[252:255], a[200:203], a[152:155], v[252:255]
    buffer_load_dwordx4 v77, s[4:7], s34 offen offset:1024 lds
    v_smfmac_f32_16x16x64_bf16 v[104:107], v[24:27], a[200:207], v22
    s_waitcnt lgkmcnt(4)
    v_mfma_f32_16x16x32_bf16 v[192:195], a[208:211], a[128:131], 0
    ds_read_b64_tr_b16 a[192:193], v96 offset:0
    v_mfma_f32_16x16x32_bf16 v[192:195], a[212:215], a[132:135], v[192:195]
    buffer_load_dwordx4 v78, s[4:7], s34 offen offset:2048 lds
    v_mfma_f32_16x16x32_bf16 v[200:203], a[212:215], a[140:143], 0
    ds_read_b64_tr_b16 a[194:195], v96 offset:1024
    v_mfma_f32_16x16x32_bf16 v[200:203], a[208:211], a[136:139], v[200:203]
    v_mfma_f32_16x16x32_bf16 v[208:211], a[208:211], a[144:147], 0
    ds_read_b64_tr_b16 a[196:197], v96 offset:8192
    v_mfma_f32_16x16x32_bf16 v[208:211], a[212:215], a[148:151], v[208:211]
    buffer_load_dwordx4 v79, s[4:7], s34 offen offset:3072 lds
    v_mfma_f32_16x16x32_bf16 v[216:219], a[212:215], a[156:159], 0
    s_add_u32 m0, s62, 20480
    ds_read_b64_tr_b16 a[198:199], v96 offset:9216
    v_mfma_f32_16x16x32_bf16 v[216:219], a[208:211], a[152:155], v[216:219]
    s_waitcnt lgkmcnt(4)
    v_mfma_f32_16x16x32_bf16 v[196:199], a[216:219], a[128:131], 0
    ds_read_b64_tr_b16 a[200:201], v97 offset:0
    v_mfma_f32_16x16x32_bf16 v[196:199], a[220:223], a[132:135], v[196:199]
    buffer_load_dwordx4 v80, s[4:7], s34 offen offset:0 lds
    v_mfma_f32_16x16x32_bf16 v[204:207], a[220:223], a[140:143], 0
    ds_read_b64_tr_b16 a[202:203], v97 offset:1024
    v_mfma_f32_16x16x32_bf16 v[204:207], a[216:219], a[136:139], v[204:207]
    v_mfma_f32_16x16x32_bf16 v[212:215], a[216:219], a[144:147], 0
    ds_read_b64_tr_b16 a[204:205], v97 offset:8192
    v_mfma_f32_16x16x32_bf16 v[212:215], a[220:223], a[148:151], v[212:215]
    buffer_load_dwordx4 v81, s[4:7], s34 offen offset:1024 lds
    v_mfma_f32_16x16x32_bf16 v[220:223], a[220:223], a[156:159], 0
    ds_read_b64_tr_b16 a[206:207], v97 offset:9216
    v_mfma_f32_16x16x32_bf16 v[220:223], a[216:219], a[152:155], v[220:223]
    s_waitcnt lgkmcnt(4)
    v_mfma_f32_16x16x32_bf16 v[160:163], a[192:195], a[128:131], 0
    ds_read_b64_tr_b16 a[208:209], v98 offset:0
    v_mfma_f32_16x16x32_bf16 v[160:163], a[196:199], a[132:135], v[160:163]
    buffer_load_dwordx4 v82, s[4:7], s34 offen offset:2048 lds
    v_mfma_f32_16x16x32_bf16 v[168:171], a[196:199], a[140:143], 0
    ds_read_b64_tr_b16 a[210:211], v98 offset:1024
    v_mfma_f32_16x16x32_bf16 v[168:171], a[192:195], a[136:139], v[168:171]
    buffer_load_dwordx4 v83, s[4:7], s34 offen offset:3072 lds
    v_mfma_f32_16x16x32_bf16 v[176:179], a[192:195], a[144:147], 0
    s_add_u32 s34, s34, 128
    ds_read_b64_tr_b16 a[212:213], v98 offset:8192
    v_mfma_f32_16x16x32_bf16 v[176:179], a[196:199], a[148:151], v[176:179]
    s_bitset0_b32 s34, 10
    v_mfma_f32_16x16x32_bf16 v[184:187], a[196:199], a[156:159], 0
    s_add_u32 m0, s62, 98304
    ds_read_b64_tr_b16 a[214:215], v98 offset:9216
    v_mfma_f32_16x16x32_bf16 v[184:187], a[192:195], a[152:155], v[184:187]
    s_waitcnt lgkmcnt(4)
    v_mfma_f32_16x16x32_bf16 v[164:167], a[200:203], a[128:131], 0
    ds_read_b64_tr_b16 a[216:217], v99 offset:0
    s_waitcnt vmcnt(12)
    v_mfma_f32_16x16x32_bf16 v[164:167], a[204:207], a[132:135], v[164:167]
    ds_read_b64_tr_b16 a[218:219], v99 offset:1024
    v_mov_b32 v50, 0x3b000000
    v_mfma_f32_16x16x32_bf16 v[172:175], a[204:207], a[140:143], 0
    ds_read_b64_tr_b16 a[220:221], v99 offset:8192
    v_lshlrev_b32 v32, 16, v64
    v_mfma_f32_16x16x32_bf16 v[172:175], a[200:203], a[136:139], v[172:175]
    ds_read_b64_tr_b16 a[222:223], v99 offset:9216
    v_and_b32 v33, 0xffff0000, v64
    v_mfma_f32_16x16x32_bf16 v[180:183], a[200:203], a[144:147], 0
    v_lshlrev_b32 v34, 16, v65
    v_and_b32 v35, 0xffff0000, v65
    v_mfma_f32_16x16x32_bf16 v[180:183], a[204:207], a[148:151], v[180:183]
    buffer_load_dwordx4 v76, s[4:7], s34 offen offset:0 lds
    v_mfma_f32_16x16x32_bf16 v[188:191], a[204:207], a[156:159], 0
    v_lshlrev_b32 v36, 16, v66
    v_and_b32 v37, 0xffff0000, v66
    v_mfma_f32_16x16x32_bf16 v[188:191], a[200:203], a[152:155], v[188:191]
    s_waitcnt vmcnt(16) lgkmcnt(0)
    s_barrier
    v_lshlrev_b32 v38, 16, v67
    v_mfma_f32_16x16x32_bf16 v[128:131], a[208:211], a[128:131], 0
    ds_read_b128 a[160:163], v88 offset:32768
    v_and_b32 v39, 0xffff0000, v67
    v_mfma_f32_16x16x32_bf16 v[128:131], a[212:215], a[132:135], v[128:131]
    ds_read_b128 a[164:167], v89 offset:32768
    v_add_f32 v40, v32, v33
    v_mfma_f32_16x16x32_bf16 v[136:139], a[212:215], a[140:143], 0
    ds_read_b128 a[168:171], v88 offset:34816
    v_add_f32 v41, v34, v35
    v_mfma_f32_16x16x32_bf16 v[136:139], a[208:211], a[136:139], v[136:139]
    ds_read_b128 a[172:175], v89 offset:34816
    v_add_f32 v42, v36, v37
    v_mfma_f32_16x16x32_bf16 v[144:147], a[208:211], a[144:147], 0
    ds_read_b64_tr_b16 a[192:193], v92 offset:16384
    v_add_f32 v43, v38, v39
    v_mfma_f32_16x16x32_bf16 v[144:147], a[212:215], a[148:151], v[144:147]
    ds_read_b64_tr_b16 a[194:195], v92 offset:17408
    v_add_f32 v40, v40, v41
    v_mfma_f32_16x16x32_bf16 v[152:155], a[212:215], a[156:159], 0
    ds_read_b64_tr_b16 a[196:197], v92 offset:24576
    v_add_f32 v42, v42, v43
    v_mfma_f32_16x16x32_bf16 v[152:155], a[208:211], a[152:155], v[152:155]
    ds_read_b64_tr_b16 a[198:199], v92 offset:25600
    v_add_f32 v48, v40, v42
    v_mfma_f32_16x16x32_bf16 v[132:135], a[216:219], a[128:131], 0
    ds_read_b128 a[176:179], v88 offset:36864
    v_add_f32_dpp v48, v48, v48 quad_perm:[1,0,3,2] row_mask:0xf bank_mask:0xf
    v_mfma_f32_16x16x32_bf16 v[132:135], a[220:223], a[132:135], v[132:135]
    ds_read_b128 a[180:183], v89 offset:36864
    v_add_f32_dpp v48, v48, v48 quad_perm:[2,3,0,1] row_mask:0xf bank_mask:0xf
    v_mfma_f32_16x16x32_bf16 v[140:143], a[220:223], a[140:143], 0
    ds_read_b128 a[184:187], v88 offset:38912
    v_add_f32_dpp v48, v48, v48 row_half_mirror row_mask:0xf bank_mask:0xf
    v_mfma_f32_16x16x32_bf16 v[140:143], a[216:219], a[136:139], v[140:143]
    ds_read_b128 a[188:191], v89 offset:38912
    v_add_f32_dpp v48, v48, v48 row_mirror row_mask:0xf bank_mask:0xf
    v_mfma_f32_16x16x32_bf16 v[148:151], a[216:219], a[144:147], 0
    ds_read_b64_tr_b16 a[200:201], v93 offset:16384
    v_add_f32_dpp v48, v48, v48 row_bcast:15 row_mask:0xa bank_mask:0xf
    v_mfma_f32_16x16x32_bf16 v[148:151], a[220:223], a[148:151], v[148:151]
    ds_read_b64_tr_b16 a[202:203], v93 offset:17408
    v_add_f32_dpp v48, v48, v48 row_bcast:31 row_mask:0xc bank_mask:0xf
    v_mfma_f32_16x16x32_bf16 v[156:159], a[220:223], a[156:159], 0
    ds_read_b64_tr_b16 a[204:205], v93 offset:24576
    v_readlane_b32 s68, v48, 63
    v_mfma_f32_16x16x32_bf16 v[156:159], a[216:219], a[152:155], v[156:159]
    ds_read_b64_tr_b16 a[206:207], v93 offset:25600
    s_waitcnt lgkmcnt(4)
    v_mfma_f32_16x16x32_bf16 v[224:227], a[192:195], a[160:163], v[224:227]
    ds_read_b64_tr_b16 a[208:209], v94 offset:16384
    v_mul_f32 v48, s68, v50
    v_mfma_f32_16x16x32_bf16 v[224:227], a[196:199], a[164:167], v[224:227]
    global_load_dword v23, v55, s[58:59] sc1
    v_mfma_f32_16x16x32_bf16 v[232:235], a[196:199], a[172:175], v[232:235]
    ds_read_b64_tr_b16 a[210:211], v94 offset:17408
    v_sub_f32 v40, v32, v48
    v_mfma_f32_16x16x32_bf16 v[232:235], a[192:195], a[168:171], v[232:235]
    v_sub_f32 v41, v33, v48
    v_sub_f32 v42, v34, v48
    v_mfma_f32_16x16x32_bf16 v[240:243], a[192:195], a[176:179], v[240:243]
    ds_read_b64_tr_b16 a[212:213], v94 offset:24576
    v_sub_f32 v43, v35, v48
    v_mfma_f32_16x16x32_bf16 v[240:243], a[196:199], a[180:183], v[240:243]
    buffer_load_dwordx4 v77, s[4:7], s34 offen offset:1024 lds
    v_mfma_f32_16x16x32_bf16 v[248:251], a[196:199], a[188:191], v[248:251]
    ds_read_b64_tr_b16 a[214:215], v94 offset:25600
    v_sub_f32 v44, v36, v48
    v_mfma_f32_16x16x32_bf16 v[248:251], a[192:195], a[184:187], v[248:251]
    buffer_load_dwordx4 v78, s[4:7], s34 offen offset:2048 lds
    v_smfmac_f32_16x16x64_bf16 v[100:103], v[24:27], a[192:199], v22
    s_waitcnt lgkmcnt(4)
    v_sub_f32 v45, v37, v48
    v_sub_f32 v46, v38, v48
    v_mfma_f32_16x16x32_bf16 v[228:231], a[200:203], a[160:163], v[228:231]
    ds_read_b64_tr_b16 a[216:217], v95 offset:16384
    v_sub_f32 v47, v39, v48
    v_mfma_f32_16x16x32_bf16 v[228:231], a[204:207], a[164:167], v[228:231]
    buffer_load_dwordx4 v79, s[4:7], s34 offen offset:3072 lds
    v_mfma_f32_16x16x32_bf16 v[236:239], a[204:207], a[172:175], v[236:239]
    s_add_u32 m0, s62, 102400
    ds_read_b64_tr_b16 a[218:219], v95 offset:17408
    v_mul_f32 v49, v40, v40
    v_mfma_f32_16x16x32_bf16 v[236:239], a[200:203], a[168:171], v[236:239]
    v_fmac_f32 v49, v41, v41
    v_fmac_f32 v49, v42, v42
    v_mfma_f32_16x16x32_bf16 v[244:247], a[200:203], a[176:179], v[244:247]
    ds_read_b64_tr_b16 a[220:221], v95 offset:24576
    v_fmac_f32 v49, v43, v43
    v_mfma_f32_16x16x32_bf16 v[244:247], a[204:207], a[180:183], v[244:247]
    buffer_load_dwordx4 v80, s[4:7], s34 offen offset:0 lds
    v_mfma_f32_16x16x32_bf16 v[252:255], a[204:207], a[188:191], v[252:255]
    ds_read_b64_tr_b16 a[222:223], v95 offset:25600
    v_fmac_f32 v49, v44, v44
    v_mfma_f32_16x16x32_bf16 v[252:255], a[200:203], a[184:187], v[252:255]
    buffer_load_dwordx4 v81, s[4:7], s34 offen offset:1024 lds
    v_smfmac_f32_16x16x64_bf16 v[104:107], v[24:27], a[200:207], v22
    s_waitcnt lgkmcnt(4)
    v_fmac_f32 v49, v45, v45
    v_fmac_f32 v49, v46, v46
    v_mfma_f32_16x16x32_bf16 v[192:195], a[208:211], a[160:163], v[192:195]
    ds_read_b64_tr_b16 a[192:193], v96 offset:16384
    v_fmac_f32 v49, v47, v47
    v_mfma_f32_16x16x32_bf16 v[192:195], a[212:215], a[164:167], v[192:195]
    buffer_load_dwordx4 v82, s[4:7], s34 offen offset:2048 lds
    v_mfma_f32_16x16x32_bf16 v[200:203], a[212:215], a[172:175], v[200:203]
    ds_read_b64_tr_b16 a[194:195], v96 offset:17408
    v_add_f32_dpp v49, v49, v49 quad_perm:[1,0,3,2] row_mask:0xf bank_mask:0xf
    v_mfma_f32_16x16x32_bf16 v[200:203], a[208:211], a[168:171], v[200:203]
    s_nop 0
    v_add_f32_dpp v49, v49, v49 quad_perm:[2,3,0,1] row_mask:0xf bank_mask:0xf
    v_mfma_f32_16x16x32_bf16 v[208:211], a[208:211], a[176:179], v[208:211]
    ds_read_b64_tr_b16 a[196:197], v96 offset:24576
    v_add_f32_dpp v49, v49, v49 row_half_mirror row_mask:0xf bank_mask:0xf
    v_mfma_f32_16x16x32_bf16 v[208:211], a[212:215], a[180:183], v[208:211]
    buffer_load_dwordx4 v83, s[4:7], s34 offen offset:3072 lds
    v_mfma_f32_16x16x32_bf16 v[216:219], a[212:215], a[188:191], v[216:219]
    s_add_u32 s34, s34, 128
    ds_read_b64_tr_b16 a[198:199], v96 offset:25600
    v_add_f32_dpp v49, v49, v49 row_mirror row_mask:0xf bank_mask:0xf
    v_mfma_f32_16x16x32_bf16 v[216:219], a[208:211], a[184:187], v[216:219]
    s_waitcnt lgkmcnt(4)
    v_add_f32_dpp v49, v49, v49 row_bcast:15 row_mask:0xa bank_mask:0xf
    v_mfma_f32_16x16x32_bf16 v[196:199], a[216:219], a[160:163], v[196:199]
    s_bitset0_b32 s34, 10
    ds_read_b64_tr_b16 a[200:201], v97 offset:16384
    v_add_f32_dpp v49, v49, v49 row_bcast:31 row_mask:0xc bank_mask:0xf
    v_mfma_f32_16x16x32_bf16 v[196:199], a[220:223], a[164:167], v[196:199]
    s_add_u32 m0, s63, 0
    v_readlane_b32 s68, v49, 63
    v_mfma_f32_16x16x32_bf16 v[204:207], a[220:223], a[172:175], v[204:207]
    ds_read_b64_tr_b16 a[202:203], v97 offset:17408
    v_mul_f32 v49, s68, v50
    v_mfma_f32_16x16x32_bf16 v[204:207], a[216:219], a[168:171], v[204:207]
    v_cvt_pk_bf16_f32 v49, v49, v49
    v_lshlrev_b32 v49, 16, v49
    v_mfma_f32_16x16x32_bf16 v[212:215], a[216:219], a[176:179], v[212:215]
    ds_read_b64_tr_b16 a[204:205], v97 offset:24576
    v_add_f32 v49, 0x3727c5ac, v49
    v_mfma_f32_16x16x32_bf16 v[212:215], a[220:223], a[180:183], v[212:215]
    buffer_load_dwordx4 v84, s[28:31], s35 offen offset:0 lds
    v_mfma_f32_16x16x32_bf16 v[220:223], a[220:223], a[188:191], v[220:223]
    ds_read_b64_tr_b16 a[206:207], v97 offset:25600
    v_cvt_pk_bf16_f32 v49, v49, v49
    v_mfma_f32_16x16x32_bf16 v[220:223], a[216:219], a[184:187], v[220:223]
    s_waitcnt lgkmcnt(4)
    v_lshlrev_b32 v49, 16, v49
    v_mfma_f32_16x16x32_bf16 v[160:163], a[192:195], a[160:163], v[160:163]
    ds_read_b64_tr_b16 a[208:209], v98 offset:16384
    v_mfma_f32_16x16x32_bf16 v[160:163], a[196:199], a[164:167], v[160:163]
    buffer_load_dwordx4 v85, s[28:31], s35 offen offset:1024 lds
    v_mfma_f32_16x16x32_bf16 v[168:171], a[196:199], a[172:175], v[168:171]
    ds_read_b64_tr_b16 a[210:211], v98 offset:17408
    v_mfma_f32_16x16x32_bf16 v[168:171], a[192:195], a[168:171], v[168:171]
    buffer_load_dwordx4 v86, s[28:31], s35 offen offset:2048 lds
    v_mfma_f32_16x16x32_bf16 v[176:179], a[192:195], a[176:179], v[176:179]
    ds_read_b64_tr_b16 a[212:213], v98 offset:24576
    v_mfma_f32_16x16x32_bf16 v[176:179], a[196:199], a[180:183], v[176:179]
    buffer_load_dwordx4 v87, s[28:31], s35 offen offset:3072 lds
    v_mfma_f32_16x16x32_bf16 v[184:187], a[196:199], a[188:191], v[184:187]
    s_add_u32 s35, s35, 0x80000
    ds_read_b64_tr_b16 a[214:215], v98 offset:25600
    v_mfma_f32_16x16x32_bf16 v[184:187], a[192:195], a[184:187], v[184:187]
    s_waitcnt lgkmcnt(4)
    v_sqrt_f32 v49, v49
    v_mfma_f32_16x16x32_bf16 v[164:167], a[200:203], a[160:163], v[164:167]
    s_bitset0_b32 s35, 22
    ds_read_b64_tr_b16 a[216:217], v99 offset:16384
    v_cvt_pk_bf16_f32 v120, v48, v49
    v_mfma_f32_16x16x32_bf16 v[164:167], a[204:207], a[164:167], v[164:167]
    s_add_u32 m0, s62, 131072
    ds_read_b64_tr_b16 a[218:219], v99 offset:17408
    v_lshlrev_b32 v32, 16, v68
    v_mfma_f32_16x16x32_bf16 v[172:175], a[204:207], a[172:175], v[172:175]
    ds_read_b64_tr_b16 a[220:221], v99 offset:24576
    v_and_b32 v33, 0xffff0000, v68
    v_mfma_f32_16x16x32_bf16 v[172:175], a[200:203], a[168:171], v[172:175]
    ds_read_b64_tr_b16 a[222:223], v99 offset:25600
    v_lshlrev_b32 v34, 16, v69
    v_mfma_f32_16x16x32_bf16 v[180:183], a[200:203], a[176:179], v[180:183]
    v_and_b32 v35, 0xffff0000, v69
    v_lshlrev_b32 v36, 16, v70
    v_mfma_f32_16x16x32_bf16 v[180:183], a[204:207], a[180:183], v[180:183]
    buffer_load_dwordx4 v76, s[4:7], s34 offen offset:0 lds
    v_mfma_f32_16x16x32_bf16 v[188:191], a[204:207], a[188:191], v[188:191]
    v_and_b32 v37, 0xffff0000, v70
    v_lshlrev_b32 v38, 16, v71
    v_mfma_f32_16x16x32_bf16 v[188:191], a[200:203], a[184:187], v[188:191]
    s_waitcnt vmcnt(14) lgkmcnt(0)
    s_barrier
    v_and_b32 v39, 0xffff0000, v71
    v_mfma_f32_16x16x32_bf16 v[128:131], a[208:211], a[160:163], v[128:131]
    ds_read_b128 a[128:131], v90 offset:0
    v_add_f32 v40, v32, v33
    v_mfma_f32_16x16x32_bf16 v[128:131], a[212:215], a[164:167], v[128:131]
    ds_read_b128 a[132:135], v91 offset:0
    v_add_f32 v41, v34, v35
    v_mfma_f32_16x16x32_bf16 v[136:139], a[212:215], a[172:175], v[136:139]
    ds_read_b128 a[136:139], v90 offset:2048
    v_add_f32 v42, v36, v37
    v_mfma_f32_16x16x32_bf16 v[136:139], a[208:211], a[168:171], v[136:139]
    ds_read_b128 a[140:143], v91 offset:2048
    v_add_f32 v43, v38, v39
    v_mfma_f32_16x16x32_bf16 v[144:147], a[208:211], a[176:179], v[144:147]
    ds_read_b64_tr_b16 a[192:193], v92 offset:32768
    v_add_f32 v40, v40, v41
    v_mfma_f32_16x16x32_bf16 v[144:147], a[212:215], a[180:183], v[144:147]
    ds_read_b64_tr_b16 a[194:195], v92 offset:33792
    v_add_f32 v42, v42, v43
    v_mfma_f32_16x16x32_bf16 v[152:155], a[212:215], a[188:191], v[152:155]
    ds_read_b64_tr_b16 a[196:197], v92 offset:40960
    v_add_f32 v48, v40, v42
    v_mfma_f32_16x16x32_bf16 v[152:155], a[208:211], a[184:187], v[152:155]
    ds_read_b64_tr_b16 a[198:199], v92 offset:41984
    v_add_f32_dpp v48, v48, v48 quad_perm:[1,0,3,2] row_mask:0xf bank_mask:0xf
    v_mfma_f32_16x16x32_bf16 v[132:135], a[216:219], a[160:163], v[132:135]
    ds_read_b128 a[144:147], v90 offset:4096
    v_add_f32_dpp v48, v48, v48 quad_perm:[2,3,0,1] row_mask:0xf bank_mask:0xf
    v_mfma_f32_16x16x32_bf16 v[132:135], a[220:223], a[164:167], v[132:135]
    ds_read_b128 a[148:151], v91 offset:4096
    v_add_f32_dpp v48, v48, v48 row_half_mirror row_mask:0xf bank_mask:0xf
    v_mfma_f32_16x16x32_bf16 v[140:143], a[220:223], a[172:175], v[140:143]
    ds_read_b128 a[152:155], v90 offset:6144
    v_add_f32_dpp v48, v48, v48 row_mirror row_mask:0xf bank_mask:0xf
    v_mfma_f32_16x16x32_bf16 v[140:143], a[216:219], a[168:171], v[140:143]
    ds_read_b128 a[156:159], v91 offset:6144
    v_add_f32_dpp v48, v48, v48 row_bcast:15 row_mask:0xa bank_mask:0xf
    v_mfma_f32_16x16x32_bf16 v[148:151], a[216:219], a[176:179], v[148:151]
    ds_read_b64_tr_b16 a[200:201], v93 offset:32768
    v_add_f32_dpp v48, v48, v48 row_bcast:31 row_mask:0xc bank_mask:0xf
    v_mfma_f32_16x16x32_bf16 v[148:151], a[220:223], a[180:183], v[148:151]
    ds_read_b64_tr_b16 a[202:203], v93 offset:33792
    v_readlane_b32 s68, v48, 63
    v_mfma_f32_16x16x32_bf16 v[156:159], a[220:223], a[188:191], v[156:159]
    ds_read_b64_tr_b16 a[204:205], v93 offset:40960
    v_mul_f32 v48, s68, v50
    v_mfma_f32_16x16x32_bf16 v[156:159], a[216:219], a[184:187], v[156:159]
    ds_read_b64_tr_b16 a[206:207], v93 offset:41984
    s_waitcnt lgkmcnt(4)
    v_mfma_f32_16x16x32_bf16 v[224:227], a[192:195], a[128:131], v[224:227]
    ds_read_b64_tr_b16 a[208:209], v94 offset:32768
    v_sub_f32 v40, v32, v48
    v_mfma_f32_16x16x32_bf16 v[224:227], a[196:199], a[132:135], v[224:227]
    buffer_load_dwordx4 v77, s[4:7], s34 offen offset:1024 lds
    v_mfma_f32_16x16x32_bf16 v[232:235], a[196:199], a[140:143], v[232:235]
    ds_read_b64_tr_b16 a[210:211], v94 offset:33792
    v_sub_f32 v41, v33, v48
    v_mfma_f32_16x16x32_bf16 v[232:235], a[192:195], a[136:139], v[232:235]
    v_sub_f32 v42, v34, v48
    v_sub_f32 v43, v35, v48
    v_mfma_f32_16x16x32_bf16 v[240:243], a[192:195], a[144:147], v[240:243]
    ds_read_b64_tr_b16 a[212:213], v94 offset:40960
    v_sub_f32 v44, v36, v48
    v_mfma_f32_16x16x32_bf16 v[240:243], a[196:199], a[148:151], v[240:243]
    buffer_load_dwordx4 v78, s[4:7], s34 offen offset:2048 lds
    v_mfma_f32_16x16x32_bf16 v[248:251], a[196:199], a[156:159], v[248:251]
    ds_read_b64_tr_b16 a[214:215], v94 offset:41984
    v_sub_f32 v45, v37, v48
    v_mfma_f32_16x16x32_bf16 v[248:251], a[192:195], a[152:155], v[248:251]
    buffer_load_dwordx4 v79, s[4:7], s34 offen offset:3072 lds
    v_smfmac_f32_16x16x64_bf16 v[100:103], v[24:27], a[192:199], v22
    s_waitcnt lgkmcnt(4)
    v_sub_f32 v46, v38, v48
    v_sub_f32 v47, v39, v48
    v_mfma_f32_16x16x32_bf16 v[228:231], a[200:203], a[128:131], v[228:231]
    s_add_u32 m0, s62, 135168
    ds_read_b64_tr_b16 a[216:217], v95 offset:32768
    v_mul_f32 v49, v40, v40
    v_mfma_f32_16x16x32_bf16 v[228:231], a[204:207], a[132:135], v[228:231]
    buffer_load_dwordx4 v80, s[4:7], s34 offen offset:0 lds
    v_mfma_f32_16x16x32_bf16 v[236:239], a[204:207], a[140:143], v[236:239]
    ds_read_b64_tr_b16 a[218:219], v95 offset:33792
    v_fmac_f32 v49, v41, v41
    v_mfma_f32_16x16x32_bf16 v[236:239], a[200:203], a[136:139], v[236:239]
    v_fmac_f32 v49, v42, v42
    v_fmac_f32 v49, v43, v43
    v_mfma_f32_16x16x32_bf16 v[244:247], a[200:203], a[144:147], v[244:247]
    ds_read_b64_tr_b16 a[220:221], v95 offset:40960
    v_fmac_f32 v49, v44, v44
    v_mfma_f32_16x16x32_bf16 v[244:247], a[204:207], a[148:151], v[244:247]
    buffer_load_dwordx4 v81, s[4:7], s34 offen offset:1024 lds
    v_mfma_f32_16x16x32_bf16 v[252:255], a[204:207], a[156:159], v[252:255]
    ds_read_b64_tr_b16 a[222:223], v95 offset:41984
    v_fmac_f32 v49, v45, v45
    v_mfma_f32_16x16x32_bf16 v[252:255], a[200:203], a[152:155], v[252:255]
    buffer_load_dwordx4 v82, s[4:7], s34 offen offset:2048 lds
    v_smfmac_f32_16x16x64_bf16 v[104:107], v[24:27], a[200:207], v22
    s_waitcnt lgkmcnt(4)
    v_fmac_f32 v49, v46, v46
    v_fmac_f32 v49, v47, v47
    v_mfma_f32_16x16x32_bf16 v[192:195], a[208:211], a[128:131], v[192:195]
    ds_read_b64_tr_b16 a[192:193], v96 offset:32768
    v_add_f32_dpp v49, v49, v49 quad_perm:[1,0,3,2] row_mask:0xf bank_mask:0xf
    v_mfma_f32_16x16x32_bf16 v[192:195], a[212:215], a[132:135], v[192:195]
    buffer_load_dwordx4 v83, s[4:7], s34 offen offset:3072 lds
    v_mfma_f32_16x16x32_bf16 v[200:203], a[212:215], a[140:143], v[200:203]
    s_add_u32 s34, s34, 128
    ds_read_b64_tr_b16 a[194:195], v96 offset:33792
    v_add_f32_dpp v49, v49, v49 quad_perm:[2,3,0,1] row_mask:0xf bank_mask:0xf
    v_mfma_f32_16x16x32_bf16 v[200:203], a[208:211], a[136:139], v[200:203]
    s_bitset0_b32 s34, 10
    v_add_f32_dpp v49, v49, v49 row_half_mirror row_mask:0xf bank_mask:0xf
    v_mfma_f32_16x16x32_bf16 v[208:211], a[208:211], a[144:147], v[208:211]
    s_add_u32 m0, s63, 16384
    ds_read_b64_tr_b16 a[196:197], v96 offset:40960
    v_add_f32_dpp v49, v49, v49 row_mirror row_mask:0xf bank_mask:0xf
    v_mfma_f32_16x16x32_bf16 v[208:211], a[212:215], a[148:151], v[208:211]
    buffer_load_dwordx4 v84, s[28:31], s35 offen offset:0 lds
    v_mfma_f32_16x16x32_bf16 v[216:219], a[212:215], a[156:159], v[216:219]
    ds_read_b64_tr_b16 a[198:199], v96 offset:41984
    v_add_f32_dpp v49, v49, v49 row_bcast:15 row_mask:0xa bank_mask:0xf
    v_mfma_f32_16x16x32_bf16 v[216:219], a[208:211], a[152:155], v[216:219]
    s_waitcnt lgkmcnt(4)
    v_add_f32_dpp v49, v49, v49 row_bcast:31 row_mask:0xc bank_mask:0xf
    v_mfma_f32_16x16x32_bf16 v[196:199], a[216:219], a[128:131], v[196:199]
    ds_read_b64_tr_b16 a[200:201], v97 offset:32768
    v_readlane_b32 s68, v49, 63
    v_mfma_f32_16x16x32_bf16 v[196:199], a[220:223], a[132:135], v[196:199]
    buffer_load_dwordx4 v85, s[28:31], s35 offen offset:1024 lds
    v_mfma_f32_16x16x32_bf16 v[204:207], a[220:223], a[140:143], v[204:207]
    ds_read_b64_tr_b16 a[202:203], v97 offset:33792
    v_mul_f32 v49, s68, v50
    v_mfma_f32_16x16x32_bf16 v[204:207], a[216:219], a[136:139], v[204:207]
    v_cvt_pk_bf16_f32 v49, v49, v49
    v_lshlrev_b32 v49, 16, v49
    v_mfma_f32_16x16x32_bf16 v[212:215], a[216:219], a[144:147], v[212:215]
    ds_read_b64_tr_b16 a[204:205], v97 offset:40960
    v_add_f32 v49, 0x3727c5ac, v49
    v_mfma_f32_16x16x32_bf16 v[212:215], a[220:223], a[148:151], v[212:215]
    buffer_load_dwordx4 v86, s[28:31], s35 offen offset:2048 lds
    v_mfma_f32_16x16x32_bf16 v[220:223], a[220:223], a[156:159], v[220:223]
    ds_read_b64_tr_b16 a[206:207], v97 offset:41984
    v_cvt_pk_bf16_f32 v49, v49, v49
    v_mfma_f32_16x16x32_bf16 v[220:223], a[216:219], a[152:155], v[220:223]
    s_waitcnt lgkmcnt(4)
    v_lshlrev_b32 v49, 16, v49
    v_mfma_f32_16x16x32_bf16 v[160:163], a[192:195], a[128:131], v[160:163]
    ds_read_b64_tr_b16 a[208:209], v98 offset:32768
    v_mfma_f32_16x16x32_bf16 v[160:163], a[196:199], a[132:135], v[160:163]
    buffer_load_dwordx4 v87, s[28:31], s35 offen offset:3072 lds
    v_mfma_f32_16x16x32_bf16 v[168:171], a[196:199], a[140:143], v[168:171]
    s_add_u32 s35, s35, 0x80000
    ds_read_b64_tr_b16 a[210:211], v98 offset:33792
    v_mfma_f32_16x16x32_bf16 v[168:171], a[192:195], a[136:139], v[168:171]
    s_bitset0_b32 s35, 22
    v_sqrt_f32 v49, v49
    v_mfma_f32_16x16x32_bf16 v[176:179], a[192:195], a[144:147], v[176:179]
    s_add_u32 m0, s62, 16384
    ds_read_b64_tr_b16 a[212:213], v98 offset:40960
    v_cvt_pk_bf16_f32 v122, v48, v49
    v_mfma_f32_16x16x32_bf16 v[176:179], a[196:199], a[148:151], v[176:179]
    buffer_load_dwordx4 v76, s[4:7], s34 offen offset:0 lds
    v_mfma_f32_16x16x32_bf16 v[184:187], a[196:199], a[156:159], v[184:187]
    ds_read_b64_tr_b16 a[214:215], v98 offset:41984
    v_mfma_f32_16x16x32_bf16 v[184:187], a[192:195], a[152:155], v[184:187]
    s_waitcnt lgkmcnt(4)
    v_mfma_f32_16x16x32_bf16 v[164:167], a[200:203], a[128:131], v[164:167]
    ds_read_b64_tr_b16 a[216:217], v99 offset:32768
    v_mfma_f32_16x16x32_bf16 v[164:167], a[204:207], a[132:135], v[164:167]
    ds_read_b64_tr_b16 a[218:219], v99 offset:33792
    v_mfma_f32_16x16x32_bf16 v[172:175], a[204:207], a[140:143], v[172:175]
    ds_read_b64_tr_b16 a[220:221], v99 offset:40960
    v_mfma_f32_16x16x32_bf16 v[172:175], a[200:203], a[136:139], v[172:175]
    ds_read_b64_tr_b16 a[222:223], v99 offset:41984
    v_mfma_f32_16x16x32_bf16 v[180:183], a[200:203], a[144:147], v[180:183]
    s_waitcnt vmcnt(24)
    v_readfirstlane_b32 s46, v23
    s_nop 0
    s_cmp_eq_u32 s46, 0
    s_cbranch_scc1 L_nonce_retry
L_nonce_ok:
    v_mfma_f32_16x16x32_bf16 v[180:183], a[204:207], a[148:151], v[180:183]
    buffer_load_dwordx4 v77, s[4:7], s34 offen offset:1024 lds
    v_mfma_f32_16x16x32_bf16 v[188:191], a[204:207], a[156:159], v[188:191]
    v_mov_b32 v121, s46
    v_mov_b32 v123, s46
    v_mfma_f32_16x16x32_bf16 v[188:191], a[200:203], a[152:155], v[188:191]
    s_waitcnt vmcnt(14) lgkmcnt(0)
    s_barrier
    s_lshl_b32 s68, s66, 3
    v_mfma_f32_16x16x32_bf16 v[128:131], a[208:211], a[128:131], v[128:131]
    ds_read_b128 a[160:163], v88 offset:0
    s_add_u32 s65, s68, 16793600
    v_mfma_f32_16x16x32_bf16 v[128:131], a[212:215], a[132:135], v[128:131]
    ds_read_b128 a[164:167], v89 offset:0
    s_add_u32 s68, s68, 16777216
    v_mfma_f32_16x16x32_bf16 v[136:139], a[212:215], a[140:143], v[136:139]
    ds_read_b128 a[168:171], v88 offset:2048
    v_mfma_f32_16x16x32_bf16 v[136:139], a[208:211], a[136:139], v[136:139]
    ds_read_b128 a[172:175], v89 offset:2048
    v_mfma_f32_16x16x32_bf16 v[144:147], a[208:211], a[144:147], v[144:147]
    ds_read_b64_tr_b16 a[192:193], v92 offset:0
    v_mfma_f32_16x16x32_bf16 v[144:147], a[212:215], a[148:151], v[144:147]
    ds_read_b64_tr_b16 a[194:195], v92 offset:1024
    v_mfma_f32_16x16x32_bf16 v[152:155], a[212:215], a[156:159], v[152:155]
    ds_read_b64_tr_b16 a[196:197], v92 offset:8192
    v_mfma_f32_16x16x32_bf16 v[152:155], a[208:211], a[152:155], v[152:155]
    ds_read_b64_tr_b16 a[198:199], v92 offset:9216
    v_mfma_f32_16x16x32_bf16 v[132:135], a[216:219], a[128:131], v[132:135]
    ds_read_b128 a[176:179], v88 offset:4096
    v_mfma_f32_16x16x32_bf16 v[132:135], a[220:223], a[132:135], v[132:135]
    ds_read_b128 a[180:183], v89 offset:4096
    v_mfma_f32_16x16x32_bf16 v[140:143], a[220:223], a[140:143], v[140:143]
    ds_read_b128 a[184:187], v88 offset:6144
    v_mfma_f32_16x16x32_bf16 v[140:143], a[216:219], a[136:139], v[140:143]
    ds_read_b128 a[188:191], v89 offset:6144
    v_mfma_f32_16x16x32_bf16 v[148:151], a[216:219], a[144:147], v[148:151]
    ds_read_b64_tr_b16 a[200:201], v93 offset:0
    v_mfma_f32_16x16x32_bf16 v[148:151], a[220:223], a[148:151], v[148:151]
    ds_read_b64_tr_b16 a[202:203], v93 offset:1024
    v_mfma_f32_16x16x32_bf16 v[156:159], a[220:223], a[156:159], v[156:159]
    ds_read_b64_tr_b16 a[204:205], v93 offset:8192
    v_mfma_f32_16x16x32_bf16 v[156:159], a[216:219], a[152:155], v[156:159]
    ds_read_b64_tr_b16 a[206:207], v93 offset:9216
    s_waitcnt lgkmcnt(4)
    v_mfma_f32_16x16x32_bf16 v[224:227], a[192:195], a[160:163], v[224:227]
    ds_read_b64_tr_b16 a[208:209], v94 offset:0
    v_mfma_f32_16x16x32_bf16 v[224:227], a[196:199], a[164:167], v[224:227]
    buffer_load_dwordx4 v78, s[4:7], s34 offen offset:2048 lds
    v_mfma_f32_16x16x32_bf16 v[232:235], a[196:199], a[172:175], v[232:235]
    ds_read_b64_tr_b16 a[210:211], v94 offset:1024
    v_mfma_f32_16x16x32_bf16 v[232:235], a[192:195], a[168:171], v[232:235]
    s_mov_b64 exec, 1
    buffer_store_dwordx4 v[120:123], off, s[16:19], s68 sc1
    s_mov_b64 exec, -1
    v_mfma_f32_16x16x32_bf16 v[240:243], a[192:195], a[176:179], v[240:243]
    ds_read_b64_tr_b16 a[212:213], v94 offset:8192
    v_lshlrev_b32 v112, 16, v72
    v_mfma_f32_16x16x32_bf16 v[240:243], a[196:199], a[180:183], v[240:243]
    buffer_load_dwordx4 v79, s[4:7], s34 offen offset:3072 lds
    v_mfma_f32_16x16x32_bf16 v[248:251], a[196:199], a[188:191], v[248:251]
    s_add_u32 m0, s62, 20480
    ds_read_b64_tr_b16 a[214:215], v94 offset:9216
    v_and_b32 v113, 0xffff0000, v72
    v_mfma_f32_16x16x32_bf16 v[248:251], a[192:195], a[184:187], v[248:251]
    buffer_load_dwordx4 v80, s[4:7], s34 offen offset:0 lds
    v_smfmac_f32_16x16x64_bf16 v[100:103], v[24:27], a[192:199], v22
    s_waitcnt lgkmcnt(4)
    v_lshlrev_b32 v114, 16, v73
    v_and_b32 v115, 0xffff0000, v73
    v_mfma_f32_16x16x32_bf16 v[228:231], a[200:203], a[160:163], v[228:231]
    ds_read_b64_tr_b16 a[216:217], v95 offset:0
    v_lshlrev_b32 v116, 16, v74
    v_mfma_f32_16x16x32_bf16 v[228:231], a[204:207], a[164:167], v[228:231]
    buffer_load_dwordx4 v81, s[4:7], s34 offen offset:1024 lds
    v_mfma_f32_16x16x32_bf16 v[236:239], a[204:207], a[172:175], v[236:239]
    ds_read_b64_tr_b16 a[218:219], v95 offset:1024
    v_and_b32 v117, 0xffff0000, v74
    v_mfma_f32_16x16x32_bf16 v[236:239], a[200:203], a[168:171], v[236:239]
    v_lshlrev_b32 v118, 16, v75
    v_and_b32 v119, 0xffff0000, v75
    v_mfma_f32_16x16x32_bf16 v[244:247], a[200:203], a[176:179], v[244:247]
    ds_read_b64_tr_b16 a[220:221], v95 offset:8192
    v_lshlrev_b32 v32, 16, v64
    v_mfma_f32_16x16x32_bf16 v[244:247], a[204:207], a[180:183], v[244:247]
    buffer_load_dwordx4 v82, s[4:7], s34 offen offset:2048 lds
    v_mfma_f32_16x16x32_bf16 v[252:255], a[204:207], a[188:191], v[252:255]
    ds_read_b64_tr_b16 a[222:223], v95 offset:9216
    v_and_b32 v33, 0xffff0000, v64
    v_mfma_f32_16x16x32_bf16 v[252:255], a[200:203], a[184:187], v[252:255]
    buffer_load_dwordx4 v83, s[4:7], s34 offen offset:3072 lds
    v_smfmac_f32_16x16x64_bf16 v[104:107], v[24:27], a[200:207], v22
    s_waitcnt lgkmcnt(4)
    v_lshlrev_b32 v34, 16, v65
    v_and_b32 v35, 0xffff0000, v65
    v_mfma_f32_16x16x32_bf16 v[192:195], a[208:211], a[160:163], v[192:195]
    s_add_u32 s34, s34, 128
    ds_read_b64_tr_b16 a[192:193], v96 offset:0
    v_lshlrev_b32 v36, 16, v66
    v_mfma_f32_16x16x32_bf16 v[192:195], a[212:215], a[164:167], v[192:195]
    s_bitset0_b32 s34, 10
    v_and_b32 v37, 0xffff0000, v66
    v_lshlrev_b32 v38, 16, v67
    v_mfma_f32_16x16x32_bf16 v[200:203], a[212:215], a[172:175], v[200:203]
    s_add_u32 m0, s63, 32768
    ds_read_b64_tr_b16 a[194:195], v96 offset:1024
    v_and_b32 v39, 0xffff0000, v67
    v_mfma_f32_16x16x32_bf16 v[200:203], a[208:211], a[168:171], v[200:203]
    v_lshlrev_b32 v48, 16, v120
    v_and_b32 v49, 0xffff0000, v120
    v_mfma_f32_16x16x32_bf16 v[208:211], a[208:211], a[176:179], v[208:211]
    ds_read_b64_tr_b16 a[196:197], v96 offset:8192
    v_mfma_f32_16x16x32_bf16 v[208:211], a[212:215], a[180:183], v[208:211]
    buffer_load_dwordx4 v84, s[28:31], s35 offen offset:0 lds
    v_mfma_f32_16x16x32_bf16 v[216:219], a[212:215], a[188:191], v[216:219]
    ds_read_b64_tr_b16 a[198:199], v96 offset:9216
    v_mfma_f32_16x16x32_bf16 v[216:219], a[208:211], a[184:187], v[216:219]
    s_waitcnt lgkmcnt(4)
    v_rcp_f32 v49, v49
    v_mfma_f32_16x16x32_bf16 v[196:199], a[216:219], a[160:163], v[196:199]
    ds_read_b64_tr_b16 a[200:201], v97 offset:0
    v_sub_f32 v32, v32, v48
    v_mfma_f32_16x16x32_bf16 v[196:199], a[220:223], a[164:167], v[196:199]
    buffer_load_dwordx4 v85, s[28:31], s35 offen offset:1024 lds
    v_mfma_f32_16x16x32_bf16 v[204:207], a[220:223], a[172:175], v[204:207]
    ds_read_b64_tr_b16 a[202:203], v97 offset:1024
    v_sub_f32 v33, v33, v48
    v_mfma_f32_16x16x32_bf16 v[204:207], a[216:219], a[168:171], v[204:207]
    v_sub_f32 v34, v34, v48
    v_sub_f32 v35, v35, v48
    v_mfma_f32_16x16x32_bf16 v[212:215], a[216:219], a[176:179], v[212:215]
    ds_read_b64_tr_b16 a[204:205], v97 offset:8192
    v_sub_f32 v36, v36, v48
    v_mfma_f32_16x16x32_bf16 v[212:215], a[220:223], a[180:183], v[212:215]
    buffer_load_dwordx4 v86, s[28:31], s35 offen offset:2048 lds
    v_mfma_f32_16x16x32_bf16 v[220:223], a[220:223], a[188:191], v[220:223]
    ds_read_b64_tr_b16 a[206:207], v97 offset:9216
    v_sub_f32 v37, v37, v48
    v_mfma_f32_16x16x32_bf16 v[220:223], a[216:219], a[184:187], v[220:223]
    s_waitcnt lgkmcnt(4)
    v_sub_f32 v38, v38, v48
    v_sub_f32 v39, v39, v48
    v_mfma_f32_16x16x32_bf16 v[160:163], a[192:195], a[160:163], v[160:163]
    ds_read_b64_tr_b16 a[208:209], v98 offset:0
    v_cvt_pk_bf16_f32 v40, v32, v33
    v_mfma_f32_16x16x32_bf16 v[160:163], a[196:199], a[164:167], v[160:163]
    buffer_load_dwordx4 v87, s[28:31], s35 offen offset:3072 lds
    v_mfma_f32_16x16x32_bf16 v[168:171], a[196:199], a[172:175], v[168:171]
    s_add_u32 s35, s35, 0x80000
    ds_read_b64_tr_b16 a[210:211], v98 offset:1024
    v_cvt_pk_bf16_f32 v41, v34, v35
    v_mfma_f32_16x16x32_bf16 v[168:171], a[192:195], a[168:171], v[168:171]
    s_bitset0_b32 s35, 22
    v_cvt_pk_bf16_f32 v42, v36, v37
    v_cvt_pk_bf16_f32 v43, v38, v39
    v_mfma_f32_16x16x32_bf16 v[176:179], a[192:195], a[176:179], v[176:179]
    s_add_u32 m0, s62, 98304
    ds_read_b64_tr_b16 a[212:213], v98 offset:8192
    v_lshlrev_b32 v32, 16, v40
    v_mfma_f32_16x16x32_bf16 v[176:179], a[196:199], a[180:183], v[176:179]
    buffer_load_dwordx4 v76, s[4:7], s34 offen offset:0 lds
    v_mfma_f32_16x16x32_bf16 v[184:187], a[196:199], a[188:191], v[184:187]
    ds_read_b64_tr_b16 a[214:215], v98 offset:9216
    v_and_b32 v33, 0xffff0000, v40
    v_mfma_f32_16x16x32_bf16 v[184:187], a[192:195], a[184:187], v[184:187]
    s_waitcnt lgkmcnt(4)
    v_lshlrev_b32 v34, 16, v41
    v_and_b32 v35, 0xffff0000, v41
    v_mfma_f32_16x16x32_bf16 v[164:167], a[200:203], a[160:163], v[164:167]
    ds_read_b64_tr_b16 a[216:217], v99 offset:0
    v_lshlrev_b32 v36, 16, v42
    v_mfma_f32_16x16x32_bf16 v[164:167], a[204:207], a[164:167], v[164:167]
    ds_read_b64_tr_b16 a[218:219], v99 offset:1024
    v_and_b32 v37, 0xffff0000, v42
    v_mfma_f32_16x16x32_bf16 v[172:175], a[204:207], a[172:175], v[172:175]
    ds_read_b64_tr_b16 a[220:221], v99 offset:8192
    v_lshlrev_b32 v38, 16, v43
    v_mfma_f32_16x16x32_bf16 v[172:175], a[200:203], a[168:171], v[172:175]
    ds_read_b64_tr_b16 a[222:223], v99 offset:9216
    v_and_b32 v39, 0xffff0000, v43
    v_mfma_f32_16x16x32_bf16 v[180:183], a[200:203], a[176:179], v[180:183]
    v_mul_f32 v32, v32, v49
    v_mul_f32 v33, v33, v49
    v_mfma_f32_16x16x32_bf16 v[180:183], a[204:207], a[180:183], v[180:183]
    buffer_load_dwordx4 v77, s[4:7], s34 offen offset:1024 lds
    v_mfma_f32_16x16x32_bf16 v[188:191], a[204:207], a[188:191], v[188:191]
    v_mul_f32 v34, v34, v49
    v_mul_f32 v35, v35, v49
    v_mfma_f32_16x16x32_bf16 v[188:191], a[200:203], a[184:187], v[188:191]
    s_waitcnt vmcnt(15) lgkmcnt(0)
    s_barrier
    v_mul_f32 v36, v36, v49
    v_mfma_f32_16x16x32_bf16 v[128:131], a[208:211], a[160:163], v[128:131]
    ds_read_b128 a[128:131], v88 offset:32768
    v_mul_f32 v37, v37, v49
    v_mfma_f32_16x16x32_bf16 v[128:131], a[212:215], a[164:167], v[128:131]
    ds_read_b128 a[132:135], v89 offset:32768
    v_mul_f32 v38, v38, v49
    v_mfma_f32_16x16x32_bf16 v[136:139], a[212:215], a[172:175], v[136:139]
    ds_read_b128 a[136:139], v88 offset:34816
    v_mul_f32 v39, v39, v49
    v_mfma_f32_16x16x32_bf16 v[136:139], a[208:211], a[168:171], v[136:139]
    ds_read_b128 a[140:143], v89 offset:34816
    v_cvt_pk_bf16_f32 v64, v32, v33
    v_mfma_f32_16x16x32_bf16 v[144:147], a[208:211], a[176:179], v[144:147]
    ds_read_b64_tr_b16 a[192:193], v92 offset:16384
    v_cvt_pk_bf16_f32 v65, v34, v35
    v_mfma_f32_16x16x32_bf16 v[144:147], a[212:215], a[180:183], v[144:147]
    ds_read_b64_tr_b16 a[194:195], v92 offset:17408
    v_cvt_pk_bf16_f32 v66, v36, v37
    v_mfma_f32_16x16x32_bf16 v[152:155], a[212:215], a[188:191], v[152:155]
    ds_read_b64_tr_b16 a[196:197], v92 offset:24576
    v_cvt_pk_bf16_f32 v67, v38, v39
    v_mfma_f32_16x16x32_bf16 v[152:155], a[208:211], a[184:187], v[152:155]
    ds_read_b64_tr_b16 a[198:199], v92 offset:25600
    v_lshlrev_b32 v32, 16, v64
    v_mfma_f32_16x16x32_bf16 v[132:135], a[216:219], a[160:163], v[132:135]
    ds_read_b128 a[144:147], v88 offset:36864
    v_and_b32 v33, 0xffff0000, v64
    v_mfma_f32_16x16x32_bf16 v[132:135], a[220:223], a[164:167], v[132:135]
    ds_read_b128 a[148:151], v89 offset:36864
    v_lshlrev_b32 v34, 16, v65
    v_mfma_f32_16x16x32_bf16 v[140:143], a[220:223], a[172:175], v[140:143]
    ds_read_b128 a[152:155], v88 offset:38912
    v_and_b32 v35, 0xffff0000, v65
    v_mfma_f32_16x16x32_bf16 v[140:143], a[216:219], a[168:171], v[140:143]
    ds_read_b128 a[156:159], v89 offset:38912
    v_lshlrev_b32 v36, 16, v66
    v_mfma_f32_16x16x32_bf16 v[148:151], a[216:219], a[176:179], v[148:151]
    ds_read_b64_tr_b16 a[200:201], v93 offset:16384
    v_and_b32 v37, 0xffff0000, v66
    v_mfma_f32_16x16x32_bf16 v[148:151], a[220:223], a[180:183], v[148:151]
    ds_read_b64_tr_b16 a[202:203], v93 offset:17408
    v_lshlrev_b32 v38, 16, v67
    v_mfma_f32_16x16x32_bf16 v[156:159], a[220:223], a[188:191], v[156:159]
    ds_read_b64_tr_b16 a[204:205], v93 offset:24576
    v_and_b32 v39, 0xffff0000, v67
    v_mfma_f32_16x16x32_bf16 v[156:159], a[216:219], a[184:187], v[156:159]
    ds_read_b64_tr_b16 a[206:207], v93 offset:25600
    s_waitcnt lgkmcnt(4)
    v_mfma_f32_16x16x32_bf16 v[224:227], a[192:195], a[128:131], v[224:227]
    ds_read_b64_tr_b16 a[208:209], v94 offset:16384
    v_mul_f32 v49, v32, v112
    v_mfma_f32_16x16x32_bf16 v[224:227], a[196:199], a[132:135], v[224:227]
    buffer_load_dwordx4 v78, s[4:7], s34 offen offset:2048 lds
    v_mfma_f32_16x16x32_bf16 v[232:235], a[196:199], a[140:143], v[232:235]
    ds_read_b64_tr_b16 a[210:211], v94 offset:17408
    v_fmac_f32 v49, v33, v113
    v_mfma_f32_16x16x32_bf16 v[232:235], a[192:195], a[136:139], v[232:235]
    v_fmac_f32 v49, v34, v114
    v_fmac_f32 v49, v35, v115
    v_mfma_f32_16x16x32_bf16 v[240:243], a[192:195], a[144:147], v[240:243]
    ds_read_b64_tr_b16 a[212:213], v94 offset:24576
    v_fmac_f32 v49, v36, v116
    v_mfma_f32_16x16x32_bf16 v[240:243], a[196:199], a[148:151], v[240:243]
    buffer_load_dwordx4 v79, s[4:7], s34 offen offset:3072 lds
    v_mfma_f32_16x16x32_bf16 v[248:251], a[196:199], a[156:159], v[248:251]
    s_add_u32 m0, s62, 102400
    ds_read_b64_tr_b16 a[214:215], v94 offset:25600
    v_fmac_f32 v49, v37, v117
    v_mfma_f32_16x16x32_bf16 v[248:251], a[192:195], a[152:155], v[248:251]
    buffer_load_dwordx4 v80, s[4:7], s34 offen offset:0 lds
    v_smfmac_f32_16x16x64_bf16 v[100:103], v[24:27], a[192:199], v22
    s_waitcnt lgkmcnt(4)
    v_fmac_f32 v49, v38, v118
    v_fmac_f32 v49, v39, v119
    v_mfma_f32_16x16x32_bf16 v[228:231], a[200:203], a[128:131], v[228:231]
    ds_read_b64_tr_b16 a[216:217], v95 offset:16384
    v_add_f32_dpp v49, v49, v49 quad_perm:[1,0,3,2] row_mask:0xf bank_mask:0xf
    v_mfma_f32_16x16x32_bf16 v[228:231], a[204:207], a[132:135], v[228:231]
    buffer_load_dwordx4 v81, s[4:7], s34 offen offset:1024 lds
    v_mfma_f32_16x16x32_bf16 v[236:239], a[204:207], a[140:143], v[236:239]
    ds_read_b64_tr_b16 a[218:219], v95 offset:17408
    v_add_f32_dpp v49, v49, v49 quad_perm:[2,3,0,1] row_mask:0xf bank_mask:0xf
    v_mfma_f32_16x16x32_bf16 v[236:239], a[200:203], a[136:139], v[236:239]
    s_nop 0
    v_add_f32_dpp v49, v49, v49 row_half_mirror row_mask:0xf bank_mask:0xf
    v_mfma_f32_16x16x32_bf16 v[244:247], a[200:203], a[144:147], v[244:247]
    ds_read_b64_tr_b16 a[220:221], v95 offset:24576
    v_add_f32_dpp v49, v49, v49 row_mirror row_mask:0xf bank_mask:0xf
    v_mfma_f32_16x16x32_bf16 v[244:247], a[204:207], a[148:151], v[244:247]
    buffer_load_dwordx4 v82, s[4:7], s34 offen offset:2048 lds
    v_mfma_f32_16x16x32_bf16 v[252:255], a[204:207], a[156:159], v[252:255]
    ds_read_b64_tr_b16 a[222:223], v95 offset:25600
    v_add_f32_dpp v49, v49, v49 row_bcast:15 row_mask:0xa bank_mask:0xf
    v_mfma_f32_16x16x32_bf16 v[252:255], a[200:203], a[152:155], v[252:255]
    buffer_load_dwordx4 v83, s[4:7], s34 offen offset:3072 lds
    v_smfmac_f32_16x16x64_bf16 v[104:107], v[24:27], a[200:207], v22
    s_waitcnt lgkmcnt(4)
    v_add_f32_dpp v49, v49, v49 row_bcast:31 row_mask:0xc bank_mask:0xf
    v_mfma_f32_16x16x32_bf16 v[192:195], a[208:211], a[128:131], v[192:195]
    s_add_u32 s34, s34, 128
    ds_read_b64_tr_b16 a[192:193], v96 offset:16384
    v_readlane_b32 s68, v49, 63
    v_mfma_f32_16x16x32_bf16 v[192:195], a[212:215], a[132:135], v[192:195]
    s_bitset0_b32 s34, 10
    s_sub_u32 s67, 2047, s66
    v_mov_b32 v49, s68
    v_mfma_f32_16x16x32_bf16 v[200:203], a[212:215], a[140:143], v[200:203]
    s_add_u32 m0, s63, 0
    ds_read_b64_tr_b16 a[194:195], v96 offset:17408
    v_cvt_pk_bf16_f32 v49, v49, v49
    v_mfma_f32_16x16x32_bf16 v[200:203], a[208:211], a[136:139], v[200:203]
    v_ashrrev_i32 v48, 31, v49
    v_or_b32 v48, 0x80000000, v48
    v_mfma_f32_16x16x32_bf16 v[208:211], a[208:211], a[144:147], v[208:211]
    ds_read_b64_tr_b16 a[196:197], v96 offset:24576
    v_xor_b32 v49, v48, v49
    v_mfma_f32_16x16x32_bf16 v[208:211], a[212:215], a[148:151], v[208:211]
    buffer_load_dwordx4 v84, s[28:31], s35 offen offset:0 lds
    v_mfma_f32_16x16x32_bf16 v[216:219], a[212:215], a[156:159], v[216:219]
    ds_read_b64_tr_b16 a[198:199], v96 offset:25600
    v_and_b32 v49, 0xffff0000, v49
    v_mfma_f32_16x16x32_bf16 v[216:219], a[208:211], a[152:155], v[216:219]
    s_waitcnt lgkmcnt(4)
    v_or_b32 v72, s67, v49
    v_mov_b32 v74, s46
    v_mfma_f32_16x16x32_bf16 v[196:199], a[216:219], a[128:131], v[196:199]
    ds_read_b64_tr_b16 a[200:201], v97 offset:16384
    v_lshlrev_b32 v32, 16, v68
    v_mfma_f32_16x16x32_bf16 v[196:199], a[220:223], a[132:135], v[196:199]
    buffer_load_dwordx4 v85, s[28:31], s35 offen offset:1024 lds
    v_mfma_f32_16x16x32_bf16 v[204:207], a[220:223], a[140:143], v[204:207]
    ds_read_b64_tr_b16 a[202:203], v97 offset:17408
    v_and_b32 v33, 0xffff0000, v68
    v_mfma_f32_16x16x32_bf16 v[204:207], a[216:219], a[136:139], v[204:207]
    v_lshlrev_b32 v34, 16, v69
    v_and_b32 v35, 0xffff0000, v69
    v_mfma_f32_16x16x32_bf16 v[212:215], a[216:219], a[144:147], v[212:215]
    ds_read_b64_tr_b16 a[204:205], v97 offset:24576
    v_lshlrev_b32 v36, 16, v70
    v_mfma_f32_16x16x32_bf16 v[212:215], a[220:223], a[148:151], v[212:215]
    buffer_load_dwordx4 v86, s[28:31], s35 offen offset:2048 lds
    v_mfma_f32_16x16x32_bf16 v[220:223], a[220:223], a[156:159], v[220:223]
    ds_read_b64_tr_b16 a[206:207], v97 offset:25600
    v_and_b32 v37, 0xffff0000, v70
    v_mfma_f32_16x16x32_bf16 v[220:223], a[216:219], a[152:155], v[220:223]
    s_waitcnt lgkmcnt(4)
    v_lshlrev_b32 v38, 16, v71
    v_and_b32 v39, 0xffff0000, v71
    v_mfma_f32_16x16x32_bf16 v[160:163], a[192:195], a[128:131], v[160:163]
    ds_read_b64_tr_b16 a[208:209], v98 offset:16384
    v_lshlrev_b32 v48, 16, v122
    v_mfma_f32_16x16x32_bf16 v[160:163], a[196:199], a[132:135], v[160:163]
    buffer_load_dwordx4 v87, s[28:31], s35 offen offset:3072 lds
    v_mfma_f32_16x16x32_bf16 v[168:171], a[196:199], a[140:143], v[168:171]
    s_add_u32 s35, s35, 0x80000
    ds_read_b64_tr_b16 a[210:211], v98 offset:17408
    v_and_b32 v49, 0xffff0000, v122
    v_mfma_f32_16x16x32_bf16 v[168:171], a[192:195], a[136:139], v[168:171]
    s_bitset0_b32 s35, 22
    v_rcp_f32 v49, v49
    v_mfma_f32_16x16x32_bf16 v[176:179], a[192:195], a[144:147], v[176:179]
    s_add_u32 m0, s62, 131072
    ds_read_b64_tr_b16 a[212:213], v98 offset:24576
    v_sub_f32 v32, v32, v48
    v_mfma_f32_16x16x32_bf16 v[176:179], a[196:199], a[148:151], v[176:179]
    buffer_load_dwordx4 v76, s[4:7], s34 offen offset:0 lds
    v_mfma_f32_16x16x32_bf16 v[184:187], a[196:199], a[156:159], v[184:187]
    ds_read_b64_tr_b16 a[214:215], v98 offset:25600
    v_sub_f32 v33, v33, v48
    v_mfma_f32_16x16x32_bf16 v[184:187], a[192:195], a[152:155], v[184:187]
    s_waitcnt lgkmcnt(4)
    v_sub_f32 v34, v34, v48
    v_sub_f32 v35, v35, v48
    v_mfma_f32_16x16x32_bf16 v[164:167], a[200:203], a[128:131], v[164:167]
    ds_read_b64_tr_b16 a[216:217], v99 offset:16384
    v_sub_f32 v36, v36, v48
    v_mfma_f32_16x16x32_bf16 v[164:167], a[204:207], a[132:135], v[164:167]
    ds_read_b64_tr_b16 a[218:219], v99 offset:17408
    v_sub_f32 v37, v37, v48
    v_mfma_f32_16x16x32_bf16 v[172:175], a[204:207], a[140:143], v[172:175]
    ds_read_b64_tr_b16 a[220:221], v99 offset:24576
    v_sub_f32 v38, v38, v48
    v_mfma_f32_16x16x32_bf16 v[172:175], a[200:203], a[136:139], v[172:175]
    ds_read_b64_tr_b16 a[222:223], v99 offset:25600
    v_sub_f32 v39, v39, v48
    v_mfma_f32_16x16x32_bf16 v[180:183], a[200:203], a[144:147], v[180:183]
    v_cvt_pk_bf16_f32 v40, v32, v33
    v_cvt_pk_bf16_f32 v41, v34, v35
    v_mfma_f32_16x16x32_bf16 v[180:183], a[204:207], a[148:151], v[180:183]
    buffer_load_dwordx4 v77, s[4:7], s34 offen offset:1024 lds
    v_mfma_f32_16x16x32_bf16 v[188:191], a[204:207], a[156:159], v[188:191]
    v_cvt_pk_bf16_f32 v42, v36, v37
    v_cvt_pk_bf16_f32 v43, v38, v39
    v_mfma_f32_16x16x32_bf16 v[188:191], a[200:203], a[152:155], v[188:191]
    s_waitcnt vmcnt(14) lgkmcnt(0)
    s_barrier
    v_lshlrev_b32 v32, 16, v40
    v_mfma_f32_16x16x32_bf16 v[128:131], a[208:211], a[128:131], v[128:131]
    ds_read_b128 a[160:163], v90 offset:0
    v_and_b32 v33, 0xffff0000, v40
    v_mfma_f32_16x16x32_bf16 v[128:131], a[212:215], a[132:135], v[128:131]
    ds_read_b128 a[164:167], v91 offset:0
    v_lshlrev_b32 v34, 16, v41
    v_mfma_f32_16x16x32_bf16 v[136:139], a[212:215], a[140:143], v[136:139]
    ds_read_b128 a[168:171], v90 offset:2048
    v_and_b32 v35, 0xffff0000, v41
    v_mfma_f32_16x16x32_bf16 v[136:139], a[208:211], a[136:139], v[136:139]
    ds_read_b128 a[172:175], v91 offset:2048
    v_lshlrev_b32 v36, 16, v42
    v_mfma_f32_16x16x32_bf16 v[144:147], a[208:211], a[144:147], v[144:147]
    ds_read_b64_tr_b16 a[192:193], v92 offset:32768
    v_and_b32 v37, 0xffff0000, v42
    v_mfma_f32_16x16x32_bf16 v[144:147], a[212:215], a[148:151], v[144:147]
    ds_read_b64_tr_b16 a[194:195], v92 offset:33792
    v_lshlrev_b32 v38, 16, v43
    v_mfma_f32_16x16x32_bf16 v[152:155], a[212:215], a[156:159], v[152:155]
    ds_read_b64_tr_b16 a[196:197], v92 offset:40960
    v_and_b32 v39, 0xffff0000, v43
    v_mfma_f32_16x16x32_bf16 v[152:155], a[208:211], a[152:155], v[152:155]
    ds_read_b64_tr_b16 a[198:199], v92 offset:41984
    v_mul_f32 v32, v32, v49
    v_mfma_f32_16x16x32_bf16 v[132:135], a[216:219], a[128:131], v[132:135]
    ds_read_b128 a[176:179], v90 offset:4096
    v_mul_f32 v33, v33, v49
    v_mfma_f32_16x16x32_bf16 v[132:135], a[220:223], a[132:135], v[132:135]
    ds_read_b128 a[180:183], v91 offset:4096
    v_mul_f32 v34, v34, v49
    v_mfma_f32_16x16x32_bf16 v[140:143], a[220:223], a[140:143], v[140:143]
    ds_read_b128 a[184:187], v90 offset:6144
    v_mul_f32 v35, v35, v49
    v_mfma_f32_16x16x32_bf16 v[140:143], a[216:219], a[136:139], v[140:143]
    ds_read_b128 a[188:191], v91 offset:6144
    v_mul_f32 v36, v36, v49
    v_mfma_f32_16x16x32_bf16 v[148:151], a[216:219], a[144:147], v[148:151]
    ds_read_b64_tr_b16 a[200:201], v93 offset:32768
    v_mul_f32 v37, v37, v49
    v_mfma_f32_16x16x32_bf16 v[148:151], a[220:223], a[148:151], v[148:151]
    ds_read_b64_tr_b16 a[202:203], v93 offset:33792
    v_mul_f32 v38, v38, v49
    v_mfma_f32_16x16x32_bf16 v[156:159], a[220:223], a[156:159], v[156:159]
    ds_read_b64_tr_b16 a[204:205], v93 offset:40960
    v_mul_f32 v39, v39, v49
    v_mfma_f32_16x16x32_bf16 v[156:159], a[216:219], a[152:155], v[156:159]
    ds_read_b64_tr_b16 a[206:207], v93 offset:41984
    s_waitcnt lgkmcnt(4)
    v_mfma_f32_16x16x32_bf16 v[224:227], a[192:195], a[160:163], v[224:227]
    ds_read_b64_tr_b16 a[208:209], v94 offset:32768
    v_cvt_pk_bf16_f32 v68, v32, v33
    v_mfma_f32_16x16x32_bf16 v[224:227], a[196:199], a[164:167], v[224:227]
    buffer_load_dwordx4 v78, s[4:7], s34 offen offset:2048 lds
    v_mfma_f32_16x16x32_bf16 v[232:235], a[196:199], a[172:175], v[232:235]
    ds_read_b64_tr_b16 a[210:211], v94 offset:33792
    v_cvt_pk_bf16_f32 v69, v34, v35
    v_mfma_f32_16x16x32_bf16 v[232:235], a[192:195], a[168:171], v[232:235]
    v_cvt_pk_bf16_f32 v70, v36, v37
    v_cvt_pk_bf16_f32 v71, v38, v39
    v_mfma_f32_16x16x32_bf16 v[240:243], a[192:195], a[176:179], v[240:243]
    ds_read_b64_tr_b16 a[212:213], v94 offset:40960
    v_lshlrev_b32 v32, 16, v68
    v_mfma_f32_16x16x32_bf16 v[240:243], a[196:199], a[180:183], v[240:243]
    buffer_load_dwordx4 v79, s[4:7], s34 offen offset:3072 lds
    v_mfma_f32_16x16x32_bf16 v[248:251], a[196:199], a[188:191], v[248:251]
    s_add_u32 m0, s62, 135168
    ds_read_b64_tr_b16 a[214:215], v94 offset:41984
    v_and_b32 v33, 0xffff0000, v68
    v_mfma_f32_16x16x32_bf16 v[248:251], a[192:195], a[184:187], v[248:251]
    buffer_load_dwordx4 v80, s[4:7], s34 offen offset:0 lds
    v_smfmac_f32_16x16x64_bf16 v[100:103], v[24:27], a[192:199], v22
    s_waitcnt lgkmcnt(4)
    v_lshlrev_b32 v34, 16, v69
    v_and_b32 v35, 0xffff0000, v69
    v_mfma_f32_16x16x32_bf16 v[228:231], a[200:203], a[160:163], v[228:231]
    ds_read_b64_tr_b16 a[216:217], v95 offset:32768
    v_lshlrev_b32 v36, 16, v70
    v_mfma_f32_16x16x32_bf16 v[228:231], a[204:207], a[164:167], v[228:231]
    buffer_load_dwordx4 v81, s[4:7], s34 offen offset:1024 lds
    v_mfma_f32_16x16x32_bf16 v[236:239], a[204:207], a[172:175], v[236:239]
    ds_read_b64_tr_b16 a[218:219], v95 offset:33792
    v_and_b32 v37, 0xffff0000, v70
    v_mfma_f32_16x16x32_bf16 v[236:239], a[200:203], a[168:171], v[236:239]
    v_lshlrev_b32 v38, 16, v71
    v_and_b32 v39, 0xffff0000, v71
    v_mfma_f32_16x16x32_bf16 v[244:247], a[200:203], a[176:179], v[244:247]
    ds_read_b64_tr_b16 a[220:221], v95 offset:40960
    v_mul_f32 v49, v32, v112
    v_mfma_f32_16x16x32_bf16 v[244:247], a[204:207], a[180:183], v[244:247]
    buffer_load_dwordx4 v82, s[4:7], s34 offen offset:2048 lds
    v_mfma_f32_16x16x32_bf16 v[252:255], a[204:207], a[188:191], v[252:255]
    ds_read_b64_tr_b16 a[222:223], v95 offset:41984
    v_fmac_f32 v49, v33, v113
    v_mfma_f32_16x16x32_bf16 v[252:255], a[200:203], a[184:187], v[252:255]
    buffer_load_dwordx4 v83, s[4:7], s34 offen offset:3072 lds
    v_smfmac_f32_16x16x64_bf16 v[104:107], v[24:27], a[200:207], v22
    s_waitcnt lgkmcnt(4)
    v_fmac_f32 v49, v34, v114
    v_fmac_f32 v49, v35, v115
    v_mfma_f32_16x16x32_bf16 v[192:195], a[208:211], a[160:163], v[192:195]
    s_add_u32 s34, s34, 128
    ds_read_b64_tr_b16 a[192:193], v96 offset:32768
    v_fmac_f32 v49, v36, v116
    v_mfma_f32_16x16x32_bf16 v[192:195], a[212:215], a[164:167], v[192:195]
    s_bitset0_b32 s34, 10
    v_fmac_f32 v49, v37, v117
    v_fmac_f32 v49, v38, v118
    v_mfma_f32_16x16x32_bf16 v[200:203], a[212:215], a[172:175], v[200:203]
    s_add_u32 m0, s63, 16384
    ds_read_b64_tr_b16 a[194:195], v96 offset:33792
    v_fmac_f32 v49, v39, v119
    v_mfma_f32_16x16x32_bf16 v[200:203], a[208:211], a[168:171], v[200:203]
    s_nop 0
    v_add_f32_dpp v49, v49, v49 quad_perm:[1,0,3,2] row_mask:0xf bank_mask:0xf
    v_mfma_f32_16x16x32_bf16 v[208:211], a[208:211], a[176:179], v[208:211]
    ds_read_b64_tr_b16 a[196:197], v96 offset:40960
    v_add_f32_dpp v49, v49, v49 quad_perm:[2,3,0,1] row_mask:0xf bank_mask:0xf
    v_mfma_f32_16x16x32_bf16 v[208:211], a[212:215], a[180:183], v[208:211]
    buffer_load_dwordx4 v84, s[28:31], s35 offen offset:0 lds
    v_mfma_f32_16x16x32_bf16 v[216:219], a[212:215], a[188:191], v[216:219]
    ds_read_b64_tr_b16 a[198:199], v96 offset:41984
    v_add_f32_dpp v49, v49, v49 row_half_mirror row_mask:0xf bank_mask:0xf
    v_mfma_f32_16x16x32_bf16 v[216:219], a[208:211], a[184:187], v[216:219]
    s_waitcnt lgkmcnt(4)
    v_add_f32_dpp v49, v49, v49 row_mirror row_mask:0xf bank_mask:0xf
    v_mfma_f32_16x16x32_bf16 v[196:199], a[216:219], a[160:163], v[196:199]
    ds_read_b64_tr_b16 a[200:201], v97 offset:32768
    v_add_f32_dpp v49, v49, v49 row_bcast:15 row_mask:0xa bank_mask:0xf
    v_mfma_f32_16x16x32_bf16 v[196:199], a[220:223], a[164:167], v[196:199]
    buffer_load_dwordx4 v85, s[28:31], s35 offen offset:1024 lds
    v_mfma_f32_16x16x32_bf16 v[204:207], a[220:223], a[172:175], v[204:207]
    ds_read_b64_tr_b16 a[202:203], v97 offset:33792
    v_add_f32_dpp v49, v49, v49 row_bcast:31 row_mask:0xc bank_mask:0xf
    v_mfma_f32_16x16x32_bf16 v[204:207], a[216:219], a[168:171], v[204:207]
    v_readlane_b32 s68, v49, 63
    s_sub_u32 s67, 2046, s66
    v_mfma_f32_16x16x32_bf16 v[212:215], a[216:219], a[176:179], v[212:215]
    ds_read_b64_tr_b16 a[204:205], v97 offset:40960
    v_mov_b32 v49, s68
    v_mfma_f32_16x16x32_bf16 v[212:215], a[220:223], a[180:183], v[212:215]
    buffer_load_dwordx4 v86, s[28:31], s35 offen offset:2048 lds
    v_mfma_f32_16x16x32_bf16 v[220:223], a[220:223], a[188:191], v[220:223]
    ds_read_b64_tr_b16 a[206:207], v97 offset:41984
    v_cvt_pk_bf16_f32 v49, v49, v49
    v_mfma_f32_16x16x32_bf16 v[220:223], a[216:219], a[184:187], v[220:223]
    s_waitcnt lgkmcnt(4)
    v_ashrrev_i32 v48, 31, v49
    v_or_b32 v48, 0x80000000, v48
    v_mfma_f32_16x16x32_bf16 v[160:163], a[192:195], a[160:163], v[160:163]
    ds_read_b64_tr_b16 a[208:209], v98 offset:32768
    v_xor_b32 v49, v48, v49
    v_mfma_f32_16x16x32_bf16 v[160:163], a[196:199], a[164:167], v[160:163]
    buffer_load_dwordx4 v87, s[28:31], s35 offen offset:3072 lds
    v_mfma_f32_16x16x32_bf16 v[168:171], a[196:199], a[172:175], v[168:171]
    s_add_u32 s35, s35, 0x80000
    ds_read_b64_tr_b16 a[210:211], v98 offset:33792
    v_and_b32 v49, 0xffff0000, v49
    v_mfma_f32_16x16x32_bf16 v[168:171], a[192:195], a[168:171], v[168:171]
    s_bitset0_b32 s35, 22
    v_or_b32 v73, s67, v49
    v_mov_b32 v75, s46
    v_mfma_f32_16x16x32_bf16 v[176:179], a[192:195], a[176:179], v[176:179]
    s_add_u32 m0, s25, 0
    ds_read_b64_tr_b16 a[212:213], v98 offset:40960
    s_lshl_b32 s64, s66, 10
    v_mfma_f32_16x16x32_bf16 v[176:179], a[196:199], a[180:183], v[176:179]
    buffer_load_dwordx4 v16, s[8:11], s23 offen offset:0 nt lds
    v_mfma_f32_16x16x32_bf16 v[184:187], a[196:199], a[188:191], v[184:187]
    ds_read_b64_tr_b16 a[214:215], v98 offset:41984
    s_add_u32 s64, s64, 18874368
    v_mfma_f32_16x16x32_bf16 v[184:187], a[192:195], a[184:187], v[184:187]
    s_waitcnt lgkmcnt(4)
    v_mfma_f32_16x16x32_bf16 v[164:167], a[200:203], a[160:163], v[164:167]
    ds_read_b64_tr_b16 a[216:217], v99 offset:32768
    v_mfma_f32_16x16x32_bf16 v[164:167], a[204:207], a[164:167], v[164:167]
    ds_read_b64_tr_b16 a[218:219], v99 offset:33792
    v_mfma_f32_16x16x32_bf16 v[172:175], a[204:207], a[172:175], v[172:175]
    ds_read_b64_tr_b16 a[220:221], v99 offset:40960
    v_mfma_f32_16x16x32_bf16 v[172:175], a[200:203], a[168:171], v[172:175]
    ds_read_b64_tr_b16 a[222:223], v99 offset:41984
    v_mfma_f32_16x16x32_bf16 v[180:183], a[200:203], a[176:179], v[180:183]
    v_mfma_f32_16x16x32_bf16 v[180:183], a[204:207], a[180:183], v[180:183]
    buffer_load_dwordx4 v17, s[8:11], s23 offen offset:1024 nt lds
    v_mfma_f32_16x16x32_bf16 v[188:191], a[204:207], a[188:191], v[188:191]
    v_mfma_f32_16x16x32_bf16 v[188:191], a[200:203], a[184:187], v[188:191]
    s_waitcnt vmcnt(14) lgkmcnt(0)
    s_barrier
    v_mfma_f32_16x16x32_bf16 v[128:131], a[208:211], a[160:163], v[128:131]
    ds_read_b128 a[128:131], v88 offset:0
    v_mfma_f32_16x16x32_bf16 v[128:131], a[212:215], a[164:167], v[128:131]
    ds_read_b128 a[132:135], v89 offset:0
    v_mfma_f32_16x16x32_bf16 v[136:139], a[212:215], a[172:175], v[136:139]
    ds_read_b128 a[136:139], v88 offset:2048
    v_mfma_f32_16x16x32_bf16 v[136:139], a[208:211], a[168:171], v[136:139]
    ds_read_b128 a[140:143], v89 offset:2048
    v_mfma_f32_16x16x32_bf16 v[144:147], a[208:211], a[176:179], v[144:147]
    ds_read_b64_tr_b16 a[192:193], v92 offset:0
    v_mfma_f32_16x16x32_bf16 v[144:147], a[212:215], a[180:183], v[144:147]
    ds_read_b64_tr_b16 a[194:195], v92 offset:1024
    v_mfma_f32_16x16x32_bf16 v[152:155], a[212:215], a[188:191], v[152:155]
    ds_read_b64_tr_b16 a[196:197], v92 offset:8192
    v_mfma_f32_16x16x32_bf16 v[152:155], a[208:211], a[184:187], v[152:155]
    ds_read_b64_tr_b16 a[198:199], v92 offset:9216
    v_mfma_f32_16x16x32_bf16 v[132:135], a[216:219], a[160:163], v[132:135]
    ds_read_b128 a[144:147], v88 offset:4096
    v_mfma_f32_16x16x32_bf16 v[132:135], a[220:223], a[164:167], v[132:135]
    ds_read_b128 a[148:151], v89 offset:4096
    v_mfma_f32_16x16x32_bf16 v[140:143], a[220:223], a[172:175], v[140:143]
    ds_read_b128 a[152:155], v88 offset:6144
    v_mfma_f32_16x16x32_bf16 v[140:143], a[216:219], a[168:171], v[140:143]
    ds_read_b128 a[156:159], v89 offset:6144
    v_mfma_f32_16x16x32_bf16 v[148:151], a[216:219], a[176:179], v[148:151]
    ds_read_b64_tr_b16 a[200:201], v93 offset:0
    v_mfma_f32_16x16x32_bf16 v[148:151], a[220:223], a[180:183], v[148:151]
    ds_read_b64_tr_b16 a[202:203], v93 offset:1024
    v_mfma_f32_16x16x32_bf16 v[156:159], a[220:223], a[188:191], v[156:159]
    ds_read_b64_tr_b16 a[204:205], v93 offset:8192
    v_mfma_f32_16x16x32_bf16 v[156:159], a[216:219], a[184:187], v[156:159]
    ds_read_b64_tr_b16 a[206:207], v93 offset:9216
    s_waitcnt lgkmcnt(4)
    v_mfma_f32_16x16x32_bf16 v[224:227], a[192:195], a[128:131], v[224:227]
    ds_read_b64_tr_b16 a[208:209], v94 offset:0
    s_mov_b32 s34, 0x4000
    v_mfma_f32_16x16x32_bf16 v[224:227], a[196:199], a[132:135], v[224:227]
    buffer_load_dwordx4 v18, s[8:11], s23 offen offset:2048 nt lds
    v_mfma_f32_16x16x32_bf16 v[232:235], a[196:199], a[140:143], v[232:235]
    ds_read_b64_tr_b16 a[210:211], v94 offset:1024
    s_mov_b32 s35, 0x4000
    v_mfma_f32_16x16x32_bf16 v[232:235], a[192:195], a[136:139], v[232:235]
    s_mov_b32 s27, 0
    s_and_b32 s3, s2, 3
    s_lshl_b32 s3, s3, 2
    v_mfma_f32_16x16x32_bf16 v[240:243], a[192:195], a[144:147], v[240:243]
    ds_read_b64_tr_b16 a[212:213], v94 offset:8192
    s_lshr_b32 s47, s2, 6
    v_mfma_f32_16x16x32_bf16 v[240:243], a[196:199], a[148:151], v[240:243]
    buffer_load_dwordx4 v19, s[8:11], s23 offen offset:3072 nt lds
    v_mfma_f32_16x16x32_bf16 v[248:251], a[196:199], a[156:159], v[248:251]
    s_add_u32 s23, s23, 0x4000
    ds_read_b64_tr_b16 a[214:215], v94 offset:9216
    s_add_u32 s47, s47, s3
    v_mfma_f32_16x16x32_bf16 v[248:251], a[192:195], a[152:155], v[248:251]
    s_bitset0_b32 s23, 19
    s_lshl_b32 s47, s47, 1
    s_bfe_u32 s67, s2, 0x10002
    v_smfmac_f32_16x16x64_bf16 v[100:103], v[24:27], a[192:199], v22
    s_waitcnt lgkmcnt(4)
    s_add_u32 s47, s47, s67
    s_bfe_u32 s32, s2, 0x30003
    v_mfma_f32_16x16x32_bf16 v[228:231], a[200:203], a[128:131], v[228:231]
    s_add_u32 m0, s25, 16384
    ds_read_b64_tr_b16 a[216:217], v95 offset:0
    s_andn2_b32 s67, 4, s2
    v_mfma_f32_16x16x32_bf16 v[228:231], a[204:207], a[132:135], v[228:231]
    buffer_load_dwordx4 v16, s[8:11], s23 offen offset:0 nt lds
    v_mfma_f32_16x16x32_bf16 v[236:239], a[204:207], a[140:143], v[236:239]
    ds_read_b64_tr_b16 a[218:219], v95 offset:1024
    s_add_u32 s67, s67, s20
    v_mfma_f32_16x16x32_bf16 v[236:239], a[200:203], a[136:139], v[236:239]
    s_lshl_b32 s67, s67, 19
    s_lshl_b32 s3, s32, 7
    s_add_u32 s3, s3, s67
    v_mfma_f32_16x16x32_bf16 v[244:247], a[200:203], a[144:147], v[244:247]
    ds_read_b64_tr_b16 a[220:221], v95 offset:8192
    s_sub_u32 s30, 0x400000, s3
    v_mfma_f32_16x16x32_bf16 v[244:247], a[204:207], a[148:151], v[244:247]
    buffer_load_dwordx4 v17, s[8:11], s23 offen offset:1024 nt lds
    v_mfma_f32_16x16x32_bf16 v[252:255], a[204:207], a[156:159], v[252:255]
    ds_read_b64_tr_b16 a[222:223], v95 offset:9216
    v_mfma_f32_16x16x32_bf16 v[252:255], a[200:203], a[152:155], v[252:255]
    buffer_load_dwordx4 v18, s[8:11], s23 offen offset:2048 nt lds
    v_smfmac_f32_16x16x64_bf16 v[104:107], v[24:27], a[200:207], v22
    s_waitcnt lgkmcnt(4)
    v_mfma_f32_16x16x32_bf16 v[192:195], a[208:211], a[128:131], v[192:195]
    ds_read_b64_tr_b16 a[192:193], v96 offset:0
    v_mfma_f32_16x16x32_bf16 v[192:195], a[212:215], a[132:135], v[192:195]
    buffer_load_dwordx4 v19, s[8:11], s23 offen offset:3072 nt lds
    v_mfma_f32_16x16x32_bf16 v[200:203], a[212:215], a[140:143], v[200:203]
    s_add_u32 s23, s23, 0x4000
    ds_read_b64_tr_b16 a[194:195], v96 offset:1024
    v_mfma_f32_16x16x32_bf16 v[200:203], a[208:211], a[136:139], v[200:203]
    s_bitset0_b32 s23, 19
    v_mfma_f32_16x16x32_bf16 v[208:211], a[208:211], a[144:147], v[208:211]
    s_add_u32 m0, s26, 16384
    ds_read_b64_tr_b16 a[196:197], v96 offset:8192
    v_mfma_f32_16x16x32_bf16 v[208:211], a[212:215], a[148:151], v[208:211]
    buffer_load_dwordx4 v20, s[12:15], s24 offen offset:0 nt lds
    v_mfma_f32_16x16x32_bf16 v[216:219], a[212:215], a[156:159], v[216:219]
    ds_read_b64_tr_b16 a[198:199], v96 offset:9216
    v_mfma_f32_16x16x32_bf16 v[216:219], a[208:211], a[152:155], v[216:219]
    s_waitcnt lgkmcnt(4)
    v_mfma_f32_16x16x32_bf16 v[196:199], a[216:219], a[128:131], v[196:199]
    ds_read_b64_tr_b16 a[200:201], v97 offset:0
    v_mfma_f32_16x16x32_bf16 v[196:199], a[220:223], a[132:135], v[196:199]
    buffer_load_dwordx4 v21, s[12:15], s24 offen offset:1024 nt lds
    v_mfma_f32_16x16x32_bf16 v[204:207], a[220:223], a[140:143], v[204:207]
    ds_read_b64_tr_b16 a[202:203], v97 offset:1024
    v_mfma_f32_16x16x32_bf16 v[204:207], a[216:219], a[136:139], v[204:207]
    s_add_u32 s28, s44, s3
    s_addc_u32 s29, s45, 0
    v_mfma_f32_16x16x32_bf16 v[212:215], a[216:219], a[144:147], v[212:215]
    ds_read_b64_tr_b16 a[204:205], v97 offset:8192
    s_bfe_u32 s3, s2, 0x20001
    v_mfma_f32_16x16x32_bf16 v[212:215], a[220:223], a[148:151], v[212:215]
    buffer_load_dwordx4 v20, s[12:15], s24 offen offset:2048 nt lds
    v_mfma_f32_16x16x32_bf16 v[220:223], a[220:223], a[156:159], v[220:223]
    ds_read_b64_tr_b16 a[206:207], v97 offset:9216
    s_mul_i32 s68, s3, 28
    v_mfma_f32_16x16x32_bf16 v[220:223], a[216:219], a[152:155], v[220:223]
    s_waitcnt lgkmcnt(4)
    s_lshr_b32 s67, s2, 3
    s_add_u32 s69, s68, s67
    v_mfma_f32_16x16x32_bf16 v[160:163], a[192:195], a[128:131], v[160:163]
    ds_read_b64_tr_b16 a[208:209], v98 offset:0
    s_lshr_b32 s3, s46, 1
    v_mfma_f32_16x16x32_bf16 v[160:163], a[196:199], a[132:135], v[160:163]
    buffer_load_dwordx4 v21, s[12:15], s24 offen offset:3072 nt lds
    v_mfma_f32_16x16x32_bf16 v[168:171], a[196:199], a[140:143], v[168:171]
    s_add_u32 s24, s24, 0x4000
    ds_read_b64_tr_b16 a[210:211], v98 offset:1024
    s_xor_b32 s66, s3, s2
    v_mfma_f32_16x16x32_bf16 v[168:171], a[192:195], a[136:139], v[168:171]
    s_bitset0_b32 s24, 19
    s_mov_b32 s62, 0x3c
    s_mov_b32 s63, 0xdc
    v_mfma_f32_16x16x32_bf16 v[176:179], a[192:195], a[144:147], v[176:179]
    ds_read_b64_tr_b16 a[212:213], v98 offset:8192
    v_mfma_f32_16x16x32_bf16 v[176:179], a[196:199], a[148:151], v[176:179]
    s_cmp_ge_u32 s67, 28
    s_cselect_b32 s69, -1, s69
    v_mfma_f32_16x16x32_bf16 v[184:187], a[196:199], a[156:159], v[184:187]
    ds_read_b64_tr_b16 a[214:215], v98 offset:9216
    v_mfma_f32_16x16x32_bf16 v[184:187], a[192:195], a[152:155], v[184:187]
    s_waitcnt lgkmcnt(4)
    v_mfma_f32_16x16x32_bf16 v[164:167], a[200:203], a[128:131], v[164:167]
    ds_read_b64_tr_b16 a[216:217], v99 offset:0
    v_mfma_f32_16x16x32_bf16 v[164:167], a[204:207], a[132:135], v[164:167]
    ds_read_b64_tr_b16 a[218:219], v99 offset:1024
    v_mfma_f32_16x16x32_bf16 v[172:175], a[204:207], a[140:143], v[172:175]
    ds_read_b64_tr_b16 a[220:221], v99 offset:8192
    v_mfma_f32_16x16x32_bf16 v[172:175], a[200:203], a[136:139], v[172:175]
    ds_read_b64_tr_b16 a[222:223], v99 offset:9216
    v_mfma_f32_16x16x32_bf16 v[180:183], a[200:203], a[144:147], v[180:183]
    s_cmp_ge_u32 s67, 28
    s_cselect_b32 s62, 0x25, s62
    s_cselect_b32 s63, 0xc6, s63
    v_mfma_f32_16x16x32_bf16 v[180:183], a[204:207], a[148:151], v[180:183]
    s_and_b32 s66, s66, 1
    s_cselect_b32 s62, 0x0, s62
    s_cselect_b32 s63, 0x80, s63
    v_mfma_f32_16x16x32_bf16 v[188:191], a[204:207], a[156:159], v[188:191]
    s_lshl_b32 s68, s68, 5
    s_lshl_b32 s67, s67, 1
    s_and_b32 s3, s20, 1
    v_mfma_f32_16x16x32_bf16 v[188:191], a[200:203], a[152:155], v[188:191]
    s_waitcnt vmcnt(12) lgkmcnt(0)
    s_barrier
    s_add_u32 s67, s67, s3
    v_mfma_f32_16x16x32_bf16 v[128:131], a[208:211], a[128:131], v[128:131]
    ds_read_b128 a[160:163], v88 offset:32768
    s_mul_i32 s67, s67, 28672
    v_mfma_f32_16x16x32_bf16 v[128:131], a[212:215], a[132:135], v[128:131]
    ds_read_b128 a[164:167], v89 offset:32768
    s_add_u32 s68, s68, s67
    v_mfma_f32_16x16x32_bf16 v[136:139], a[212:215], a[140:143], v[136:139]
    ds_read_b128 a[168:171], v88 offset:34816
    v_lshrrev_b32 v112, 3, v0
    v_mfma_f32_16x16x32_bf16 v[136:139], a[208:211], a[136:139], v[136:139]
    ds_read_b128 a[172:175], v89 offset:34816
    v_mul_u32_u24 v112, 3584, v112
    v_mfma_f32_16x16x32_bf16 v[144:147], a[208:211], a[144:147], v[144:147]
    ds_read_b64_tr_b16 a[192:193], v92 offset:16384
    v_and_b32 v113, 7, v0
    v_mfma_f32_16x16x32_bf16 v[144:147], a[212:215], a[148:151], v[144:147]
    ds_read_b64_tr_b16 a[194:195], v92 offset:17408
    v_min_u32 v113, 6, v113
    v_mfma_f32_16x16x32_bf16 v[152:155], a[212:215], a[156:159], v[152:155]
    ds_read_b64_tr_b16 a[196:197], v92 offset:24576
    v_lshl_add_u32 v112, v113, 7, v112
    v_mfma_f32_16x16x32_bf16 v[152:155], a[208:211], a[152:155], v[152:155]
    ds_read_b64_tr_b16 a[198:199], v92 offset:25600
    v_add_u32 v23, s68, v112
    v_mfma_f32_16x16x32_bf16 v[132:135], a[216:219], a[128:131], v[132:135]
    ds_read_b128 a[176:179], v88 offset:36864
    v_mfma_f32_16x16x32_bf16 v[132:135], a[220:223], a[132:135], v[132:135]
    ds_read_b128 a[180:183], v89 offset:36864
    v_mfma_f32_16x16x32_bf16 v[140:143], a[220:223], a[140:143], v[140:143]
    ds_read_b128 a[184:187], v88 offset:38912
    v_mfma_f32_16x16x32_bf16 v[140:143], a[216:219], a[136:139], v[140:143]
    ds_read_b128 a[188:191], v89 offset:38912
    v_mfma_f32_16x16x32_bf16 v[148:151], a[216:219], a[144:147], v[148:151]
    ds_read_b64_tr_b16 a[200:201], v93 offset:16384
    v_mfma_f32_16x16x32_bf16 v[148:151], a[220:223], a[148:151], v[148:151]
    ds_read_b64_tr_b16 a[202:203], v93 offset:17408
    v_mfma_f32_16x16x32_bf16 v[156:159], a[220:223], a[156:159], v[156:159]
    ds_read_b64_tr_b16 a[204:205], v93 offset:24576
    v_mfma_f32_16x16x32_bf16 v[156:159], a[216:219], a[152:155], v[156:159]
    ds_read_b64_tr_b16 a[206:207], v93 offset:25600
    s_waitcnt lgkmcnt(4)
    v_mfma_f32_16x16x32_bf16 v[224:227], a[192:195], a[160:163], v[224:227]
    ds_read_b64_tr_b16 a[208:209], v94 offset:16384
    v_mfma_f32_16x16x32_bf16 v[224:227], a[196:199], a[164:167], v[224:227]
    buffer_load_dwordx2 v[44:45], v61, s[16:19], s1 offen offset:0 sc1
    v_mfma_f32_16x16x32_bf16 v[232:235], a[196:199], a[172:175], v[232:235]
    ds_read_b64_tr_b16 a[210:211], v94 offset:17408
    v_mfma_f32_16x16x32_bf16 v[232:235], a[192:195], a[168:171], v[232:235]
    buffer_load_dwordx2 v[48:49], v61, s[16:19], s1 offen offset:128 sc1
    v_mfma_f32_16x16x32_bf16 v[240:243], a[192:195], a[176:179], v[240:243]
    ds_read_b64_tr_b16 a[212:213], v94 offset:24576
    v_mfma_f32_16x16x32_bf16 v[240:243], a[196:199], a[180:183], v[240:243]
    buffer_load_dwordx2 v[52:53], v61, s[16:19], s1 offen offset:256 sc1
    v_mfma_f32_16x16x32_bf16 v[248:251], a[196:199], a[188:191], v[248:251]
    ds_read_b64_tr_b16 a[214:215], v94 offset:25600
    v_mfma_f32_16x16x32_bf16 v[248:251], a[192:195], a[184:187], v[248:251]
    buffer_load_dwordx2 v[56:57], v61, s[16:19], s1 offen offset:384 sc1
    v_smfmac_f32_16x16x64_bf16 v[100:103], v[24:27], a[192:199], v22
    s_waitcnt lgkmcnt(4)
    v_mfma_f32_16x16x32_bf16 v[228:231], a[200:203], a[160:163], v[228:231]
    s_add_u32 m0, s25, 32768
    ds_read_b64_tr_b16 a[216:217], v95 offset:16384
    v_mfma_f32_16x16x32_bf16 v[228:231], a[204:207], a[164:167], v[228:231]
    buffer_load_dwordx4 v16, s[8:11], s23 offen offset:0 nt lds
    v_mfma_f32_16x16x32_bf16 v[236:239], a[204:207], a[172:175], v[236:239]
    ds_read_b64_tr_b16 a[218:219], v95 offset:17408
    v_mfma_f32_16x16x32_bf16 v[236:239], a[200:203], a[168:171], v[236:239]
    s_cmp_lt_u32 s20, 2
    s_cselect_b64 s[6:7], s[50:51], s[52:53]
    v_mfma_f32_16x16x32_bf16 v[244:247], a[200:203], a[176:179], v[244:247]
    ds_read_b64_tr_b16 a[220:221], v95 offset:24576
    s_mov_b32 s0, 0
    v_mfma_f32_16x16x32_bf16 v[244:247], a[204:207], a[180:183], v[244:247]
    buffer_load_dwordx4 v17, s[8:11], s23 offen offset:1024 nt lds
    v_mfma_f32_16x16x32_bf16 v[252:255], a[204:207], a[188:191], v[252:255]
    ds_read_b64_tr_b16 a[222:223], v95 offset:25600
    v_mfma_f32_16x16x32_bf16 v[252:255], a[200:203], a[184:187], v[252:255]
    buffer_load_dwordx4 v18, s[8:11], s23 offen offset:2048 nt lds
    v_smfmac_f32_16x16x64_bf16 v[104:107], v[24:27], a[200:207], v22
    s_waitcnt lgkmcnt(4)
    v_mfma_f32_16x16x32_bf16 v[192:195], a[208:211], a[160:163], v[192:195]
    ds_read_b64_tr_b16 a[192:193], v96 offset:16384
    v_add_f32 v100, v100, v101
    v_mfma_f32_16x16x32_bf16 v[192:195], a[212:215], a[164:167], v[192:195]
    buffer_load_dwordx4 v19, s[8:11], s23 offen offset:3072 nt lds
    v_mfma_f32_16x16x32_bf16 v[200:203], a[212:215], a[172:175], v[200:203]
    s_add_u32 s23, s23, 0x4000
    ds_read_b64_tr_b16 a[194:195], v96 offset:17408
    v_mfma_f32_16x16x32_bf16 v[200:203], a[208:211], a[168:171], v[200:203]
    s_bitset0_b32 s23, 19
    v_mfma_f32_16x16x32_bf16 v[208:211], a[208:211], a[176:179], v[208:211]
    s_add_u32 m0, s26, 32768
    ds_read_b64_tr_b16 a[196:197], v96 offset:24576
    v_add_f32 v104, v104, v105
    v_mfma_f32_16x16x32_bf16 v[208:211], a[212:215], a[180:183], v[208:211]
    buffer_load_dwordx4 v20, s[12:15], s24 offen offset:0 nt lds
    v_mfma_f32_16x16x32_bf16 v[216:219], a[212:215], a[188:191], v[216:219]
    ds_read_b64_tr_b16 a[198:199], v96 offset:25600
    v_mfma_f32_16x16x32_bf16 v[216:219], a[208:211], a[184:187], v[216:219]
    s_waitcnt lgkmcnt(4)
    v_mfma_f32_16x16x32_bf16 v[196:199], a[216:219], a[160:163], v[196:199]
    ds_read_b64_tr_b16 a[200:201], v97 offset:16384
    v_mfma_f32_16x16x32_bf16 v[196:199], a[220:223], a[164:167], v[196:199]
    buffer_load_dwordx4 v21, s[12:15], s24 offen offset:1024 nt lds
    v_mfma_f32_16x16x32_bf16 v[204:207], a[220:223], a[172:175], v[204:207]
    ds_read_b64_tr_b16 a[202:203], v97 offset:17408
    v_mfma_f32_16x16x32_bf16 v[204:207], a[216:219], a[168:171], v[204:207]
    ds_write2_b32 v62, v100, v104 offset0:0 offset1:16
    v_mfma_f32_16x16x32_bf16 v[212:215], a[216:219], a[176:179], v[212:215]
    ds_read_b64_tr_b16 a[204:205], v97 offset:24576
    v_mfma_f32_16x16x32_bf16 v[212:215], a[220:223], a[180:183], v[212:215]
    buffer_load_dwordx4 v20, s[12:15], s24 offen offset:2048 nt lds
    v_mfma_f32_16x16x32_bf16 v[220:223], a[220:223], a[188:191], v[220:223]
    ds_read_b64_tr_b16 a[206:207], v97 offset:25600
    v_mfma_f32_16x16x32_bf16 v[220:223], a[216:219], a[184:187], v[220:223]
    s_waitcnt lgkmcnt(4)
    v_mfma_f32_16x16x32_bf16 v[160:163], a[192:195], a[160:163], v[160:163]
    ds_read_b64_tr_b16 a[208:209], v98 offset:16384
    v_mfma_f32_16x16x32_bf16 v[160:163], a[196:199], a[164:167], v[160:163]
    buffer_load_dwordx4 v21, s[12:15], s24 offen offset:3072 nt lds
    v_mfma_f32_16x16x32_bf16 v[168:171], a[196:199], a[172:175], v[168:171]
    s_add_u32 s24, s24, 0x4000
    ds_read_b64_tr_b16 a[210:211], v98 offset:17408
    v_mfma_f32_16x16x32_bf16 v[168:171], a[192:195], a[168:171], v[168:171]
    s_bitset0_b32 s24, 19
    v_mfma_f32_16x16x32_bf16 v[176:179], a[192:195], a[176:179], v[176:179]
    s_add_u32 m0, s25, 49152
    ds_read_b64_tr_b16 a[212:213], v98 offset:24576
    v_mfma_f32_16x16x32_bf16 v[176:179], a[196:199], a[180:183], v[176:179]
    buffer_load_dwordx4 v16, s[8:11], s23 offen offset:0 nt lds
    v_mfma_f32_16x16x32_bf16 v[184:187], a[196:199], a[188:191], v[184:187]
    ds_read_b64_tr_b16 a[214:215], v98 offset:25600
    v_mfma_f32_16x16x32_bf16 v[184:187], a[192:195], a[184:187], v[184:187]
    s_waitcnt lgkmcnt(4)
    v_mfma_f32_16x16x32_bf16 v[164:167], a[200:203], a[160:163], v[164:167]
    ds_read_b64_tr_b16 a[216:217], v99 offset:16384
    v_mfma_f32_16x16x32_bf16 v[164:167], a[204:207], a[164:167], v[164:167]
    ds_read_b64_tr_b16 a[218:219], v99 offset:17408
    v_mfma_f32_16x16x32_bf16 v[172:175], a[204:207], a[172:175], v[172:175]
    ds_read_b64_tr_b16 a[220:221], v99 offset:24576
    v_mfma_f32_16x16x32_bf16 v[172:175], a[200:203], a[168:171], v[172:175]
    ds_read_b64_tr_b16 a[222:223], v99 offset:25600
    v_mfma_f32_16x16x32_bf16 v[180:183], a[200:203], a[176:179], v[180:183]
    v_mfma_f32_16x16x32_bf16 v[180:183], a[204:207], a[180:183], v[180:183]
    buffer_load_dwordx4 v17, s[8:11], s23 offen offset:1024 nt lds
    v_mfma_f32_16x16x32_bf16 v[188:191], a[204:207], a[188:191], v[188:191]
    v_mfma_f32_16x16x32_bf16 v[188:191], a[200:203], a[184:187], v[188:191]
    s_waitcnt vmcnt(22) lgkmcnt(0)
    s_barrier
    v_mfma_f32_16x16x32_bf16 v[128:131], a[208:211], a[160:163], v[128:131]
    ds_read_b128 v[28:31], v124 offset:0
    v_mfma_f32_16x16x32_bf16 v[128:131], a[212:215], a[164:167], v[128:131]
    ds_read_b128 v[32:35], v124 offset:64
    v_mfma_f32_16x16x32_bf16 v[136:139], a[212:215], a[172:175], v[136:139]
    ds_read_b128 v[36:39], v125 offset:0
    v_mfma_f32_16x16x32_bf16 v[136:139], a[208:211], a[168:171], v[136:139]
    ds_read_b128 v[40:43], v125 offset:64
    v_mfma_f32_16x16x32_bf16 v[144:147], a[208:211], a[176:179], v[144:147]
    ds_read_b128 a[192:195], v108
    v_mfma_f32_16x16x32_bf16 v[144:147], a[212:215], a[180:183], v[144:147]
    ds_read_b128 a[196:199], v109
    v_mfma_f32_16x16x32_bf16 v[152:155], a[212:215], a[188:191], v[152:155]
    ds_read_b128 a[200:203], v110
    v_mfma_f32_16x16x32_bf16 v[152:155], a[208:211], a[184:187], v[152:155]
    ds_read_b128 a[204:207], v111
    v_mfma_f32_16x16x32_bf16 v[132:135], a[216:219], a[160:163], v[132:135]
    ds_read_b128 a[128:131], v4 offset:0
    s_waitcnt vmcnt(10)
    v_mfma_f32_16x16x32_bf16 v[132:135], a[220:223], a[164:167], v[132:135]
    ds_read_b128 a[132:135], v5 offset:0
    v_xor_b32 v46, s46, v45
    v_mfma_f32_16x16x32_bf16 v[140:143], a[220:223], a[172:175], v[140:143]
    ds_read_b128 a[136:139], v6 offset:0
    v_xor_b32 v50, s46, v49
    v_mfma_f32_16x16x32_bf16 v[140:143], a[216:219], a[168:171], v[140:143]
    ds_read_b128 a[140:143], v7 offset:0
    v_xor_b32 v54, s46, v53
    v_mfma_f32_16x16x32_bf16 v[148:151], a[216:219], a[176:179], v[148:151]
    ds_read_b128 a[144:147], v4 offset:4096
    v_xor_b32 v58, s46, v57
    v_mfma_f32_16x16x32_bf16 v[148:151], a[220:223], a[180:183], v[148:151]
    ds_read_b128 a[148:151], v5 offset:4096
    v_or3_b32 v46, v46, v50, v54
    v_mfma_f32_16x16x32_bf16 v[156:159], a[220:223], a[188:191], v[156:159]
    ds_read_b128 a[152:155], v6 offset:4096
    v_or_b32 v46, v46, v58
    v_mfma_f32_16x16x32_bf16 v[156:159], a[216:219], a[184:187], v[156:159]
    ds_read_b128 a[156:159], v7 offset:4096
    v_cmp_ne_u32 vcc, 0, v46
    ds_read_b128 a[160:163], v4 offset:8192
    ds_read_b128 a[164:167], v5 offset:8192
    ds_read_b128 a[168:171], v6 offset:8192
    ds_read_b128 a[172:175], v7 offset:8192
    ds_read_b128 a[176:179], v4 offset:12288
    ds_read_b128 a[180:183], v5 offset:12288
    ds_read_b128 a[184:187], v6 offset:12288
    ds_read_b128 a[188:191], v7 offset:12288
    buffer_store_dwordx4 v[64:67], v3, s[16:19], s64 offen offset:0 sc1
    buffer_store_dwordx4 v[68:71], v3, s[16:19], s64 offen offset:1024 sc1
    s_cbranch_vccnz L_stat_retry
L_stat_ok:
    v_and_b32 v45, 0xffff0000, v44
    v_and_b32 v49, 0xffff0000, v48
    v_and_b32 v53, 0xffff0000, v52
    v_and_b32 v57, 0xffff0000, v56
    v_lshlrev_b32 v44, 16, v44
    v_lshlrev_b32 v48, 16, v48
    v_lshlrev_b32 v52, 16, v52
    v_lshlrev_b32 v56, 16, v56
    v_rcp_f32 v45, v45
    v_rcp_f32 v49, v49
    v_rcp_f32 v53, v53
    v_rcp_f32 v57, v57
    v_sub_f32 v44, 0, v44
    v_sub_f32 v48, 0, v48
    v_sub_f32 v52, 0, v52
    v_sub_f32 v56, 0, v56
    v_mul_f32 v45, 0x3e0293ee, v45
    v_mul_f32 v49, 0x3e0293ee, v49
    v_mul_f32 v53, 0x3e0293ee, v53
    v_mul_f32 v57, 0x3e0293ee, v57
    v_mov_b32 v60, v72
    v_mov_b32 v61, v73
    v_mov_b32 v62, v74
    v_mov_b32 v63, v75
    s_waitcnt lgkmcnt(0)
    v_pk_fma_f32 v[224:225], v[28:29], v[44:45], v[224:225] op_sel:[0,0,0] op_sel_hi:[1,0,1]
    v_pk_fma_f32 v[226:227], v[30:31], v[44:45], v[226:227] op_sel:[0,0,0] op_sel_hi:[1,0,1]
    v_pk_fma_f32 v[228:229], v[32:33], v[44:45], v[228:229] op_sel:[0,0,0] op_sel_hi:[1,0,1]
    v_pk_fma_f32 v[230:231], v[34:35], v[44:45], v[230:231] op_sel:[0,0,0] op_sel_hi:[1,0,1]
    v_pk_mul_f32 v[224:225], v[224:225], v[44:45] op_sel:[0,1] op_sel_hi:[1,1]
    v_pk_mul_f32 v[226:227], v[226:227], v[44:45] op_sel:[0,1] op_sel_hi:[1,1]
    v_pk_mul_f32 v[228:229], v[228:229], v[44:45] op_sel:[0,1] op_sel_hi:[1,1]
    v_pk_mul_f32 v[230:231], v[230:231], v[44:45] op_sel:[0,1] op_sel_hi:[1,1]
    v_cvt_pk_bf16_f32 v64, v224, v225
    v_cvt_pk_bf16_f32 v65, v226, v227
    v_cvt_pk_bf16_f32 v66, v228, v229
    v_cvt_pk_bf16_f32 v67, v230, v231
    buffer_load_dwordx4 v18, s[8:11], s23 offen offset:2048 nt lds
    v_pk_fma_f32 v[232:233], v[28:29], v[48:49], v[232:233] op_sel:[0,0,0] op_sel_hi:[1,0,1]
    v_pk_fma_f32 v[234:235], v[30:31], v[48:49], v[234:235] op_sel:[0,0,0] op_sel_hi:[1,0,1]
    v_pk_fma_f32 v[236:237], v[32:33], v[48:49], v[236:237] op_sel:[0,0,0] op_sel_hi:[1,0,1]
    v_pk_fma_f32 v[238:239], v[34:35], v[48:49], v[238:239] op_sel:[0,0,0] op_sel_hi:[1,0,1]
    v_pk_mul_f32 v[232:233], v[232:233], v[48:49] op_sel:[0,1] op_sel_hi:[1,1]
    v_pk_mul_f32 v[234:235], v[234:235], v[48:49] op_sel:[0,1] op_sel_hi:[1,1]
    v_pk_mul_f32 v[236:237], v[236:237], v[48:49] op_sel:[0,1] op_sel_hi:[1,1]
    v_pk_mul_f32 v[238:239], v[238:239], v[48:49] op_sel:[0,1] op_sel_hi:[1,1]
    v_cvt_pk_bf16_f32 v80, v232, v233
    v_cvt_pk_bf16_f32 v81, v234, v235
    v_cvt_pk_bf16_f32 v82, v236, v237
    v_cvt_pk_bf16_f32 v83, v238, v239
    buffer_load_dwordx4 v19, s[8:11], s23 offen offset:3072 nt lds
    v_pk_fma_f32 v[240:241], v[28:29], v[52:53], v[240:241] op_sel:[0,0,0] op_sel_hi:[1,0,1]
    v_pk_fma_f32 v[242:243], v[30:31], v[52:53], v[242:243] op_sel:[0,0,0] op_sel_hi:[1,0,1]
    v_pk_fma_f32 v[244:245], v[32:33], v[52:53], v[244:245] op_sel:[0,0,0] op_sel_hi:[1,0,1]
    v_pk_fma_f32 v[246:247], v[34:35], v[52:53], v[246:247] op_sel:[0,0,0] op_sel_hi:[1,0,1]
    v_pk_mul_f32 v[240:241], v[240:241], v[52:53] op_sel:[0,1] op_sel_hi:[1,1]
    v_pk_mul_f32 v[242:243], v[242:243], v[52:53] op_sel:[0,1] op_sel_hi:[1,1]
    v_pk_mul_f32 v[244:245], v[244:245], v[52:53] op_sel:[0,1] op_sel_hi:[1,1]
    v_pk_mul_f32 v[246:247], v[246:247], v[52:53] op_sel:[0,1] op_sel_hi:[1,1]
    v_cvt_pk_bf16_f32 v96, v240, v241
    v_cvt_pk_bf16_f32 v97, v242, v243
    v_cvt_pk_bf16_f32 v98, v244, v245
    v_cvt_pk_bf16_f32 v99, v246, v247
    s_add_u32 s23, s23, 0x4000
    s_bitset0_b32 s23, 19
    s_add_u32 m0, s26, 49152
    s_nop 0
    buffer_load_dwordx4 v20, s[12:15], s24 offen offset:0 nt lds
    v_pk_fma_f32 v[248:249], v[28:29], v[56:57], v[248:249] op_sel:[0,0,0] op_sel_hi:[1,0,1]
    v_pk_fma_f32 v[250:251], v[30:31], v[56:57], v[250:251] op_sel:[0,0,0] op_sel_hi:[1,0,1]
    v_pk_fma_f32 v[252:253], v[32:33], v[56:57], v[252:253] op_sel:[0,0,0] op_sel_hi:[1,0,1]
    v_pk_fma_f32 v[254:255], v[34:35], v[56:57], v[254:255] op_sel:[0,0,0] op_sel_hi:[1,0,1]
    ds_read_b128 v[28:31], v126 offset:0
    ds_read_b128 v[32:35], v126 offset:64
    v_pk_mul_f32 v[248:249], v[248:249], v[56:57] op_sel:[0,1] op_sel_hi:[1,1]
    v_pk_mul_f32 v[250:251], v[250:251], v[56:57] op_sel:[0,1] op_sel_hi:[1,1]
    v_pk_mul_f32 v[252:253], v[252:253], v[56:57] op_sel:[0,1] op_sel_hi:[1,1]
    v_pk_mul_f32 v[254:255], v[254:255], v[56:57] op_sel:[0,1] op_sel_hi:[1,1]
    v_cvt_pk_bf16_f32 v112, v248, v249
    v_cvt_pk_bf16_f32 v113, v250, v251
    v_cvt_pk_bf16_f32 v114, v252, v253
    v_cvt_pk_bf16_f32 v115, v254, v255
    buffer_load_dwordx4 v21, s[12:15], s24 offen offset:1024 nt lds
    v_permlane16_swap_b32 v64, v66
    v_permlane16_swap_b32 v65, v67
    v_permlane16_swap_b32 v80, v82
    v_permlane16_swap_b32 v81, v83
    v_permlane16_swap_b32 v96, v98
    v_permlane16_swap_b32 v97, v99
    v_permlane16_swap_b32 v112, v114
    v_permlane16_swap_b32 v113, v115
    s_nop 0
    v_pk_fma_f32 v[192:193], v[36:37], v[44:45], v[192:193] op_sel:[0,0,0] op_sel_hi:[1,0,1]
    v_pk_fma_f32 v[194:195], v[38:39], v[44:45], v[194:195] op_sel:[0,0,0] op_sel_hi:[1,0,1]
    v_pk_fma_f32 v[196:197], v[40:41], v[44:45], v[196:197] op_sel:[0,0,0] op_sel_hi:[1,0,1]
    v_pk_fma_f32 v[198:199], v[42:43], v[44:45], v[198:199] op_sel:[0,0,0] op_sel_hi:[1,0,1]
    v_pk_mul_f32 v[192:193], v[192:193], v[44:45] op_sel:[0,1] op_sel_hi:[1,1]
    v_pk_mul_f32 v[194:195], v[194:195], v[44:45] op_sel:[0,1] op_sel_hi:[1,1]
    v_pk_mul_f32 v[196:197], v[196:197], v[44:45] op_sel:[0,1] op_sel_hi:[1,1]
    v_pk_mul_f32 v[198:199], v[198:199], v[44:45] op_sel:[0,1] op_sel_hi:[1,1]
    v_cvt_pk_bf16_f32 v68, v192, v193
    v_cvt_pk_bf16_f32 v69, v194, v195
    v_cvt_pk_bf16_f32 v70, v196, v197
    v_cvt_pk_bf16_f32 v71, v198, v199
    buffer_load_dwordx4 v20, s[12:15], s24 offen offset:2048 nt lds
    v_pk_fma_f32 v[200:201], v[36:37], v[48:49], v[200:201] op_sel:[0,0,0] op_sel_hi:[1,0,1]
    v_pk_fma_f32 v[202:203], v[38:39], v[48:49], v[202:203] op_sel:[0,0,0] op_sel_hi:[1,0,1]
    v_pk_fma_f32 v[204:205], v[40:41], v[48:49], v[204:205] op_sel:[0,0,0] op_sel_hi:[1,0,1]
    v_pk_fma_f32 v[206:207], v[42:43], v[48:49], v[206:207] op_sel:[0,0,0] op_sel_hi:[1,0,1]
    v_pk_mul_f32 v[200:201], v[200:201], v[48:49] op_sel:[0,1] op_sel_hi:[1,1]
    v_pk_mul_f32 v[202:203], v[202:203], v[48:49] op_sel:[0,1] op_sel_hi:[1,1]
    v_pk_mul_f32 v[204:205], v[204:205], v[48:49] op_sel:[0,1] op_sel_hi:[1,1]
    v_pk_mul_f32 v[206:207], v[206:207], v[48:49] op_sel:[0,1] op_sel_hi:[1,1]
    v_cvt_pk_bf16_f32 v84, v200, v201
    v_cvt_pk_bf16_f32 v85, v202, v203
    v_cvt_pk_bf16_f32 v86, v204, v205
    v_cvt_pk_bf16_f32 v87, v206, v207
    buffer_load_dwordx4 v21, s[12:15], s24 offen offset:3072 nt lds
    v_pk_fma_f32 v[208:209], v[36:37], v[52:53], v[208:209] op_sel:[0,0,0] op_sel_hi:[1,0,1]
    v_pk_fma_f32 v[210:211], v[38:39], v[52:53], v[210:211] op_sel:[0,0,0] op_sel_hi:[1,0,1]
    v_pk_fma_f32 v[212:213], v[40:41], v[52:53], v[212:213] op_sel:[0,0,0] op_sel_hi:[1,0,1]
    v_pk_fma_f32 v[214:215], v[42:43], v[52:53], v[214:215] op_sel:[0,0,0] op_sel_hi:[1,0,1]
    v_pk_mul_f32 v[208:209], v[208:209], v[52:53] op_sel:[0,1] op_sel_hi:[1,1]
    v_pk_mul_f32 v[210:211], v[210:211], v[52:53] op_sel:[0,1] op_sel_hi:[1,1]
    v_pk_mul_f32 v[212:213], v[212:213], v[52:53] op_sel:[0,1] op_sel_hi:[1,1]
    v_pk_mul_f32 v[214:215], v[214:215], v[52:53] op_sel:[0,1] op_sel_hi:[1,1]
    v_cvt_pk_bf16_f32 v100, v208, v209
    v_cvt_pk_bf16_f32 v101, v210, v211
    v_cvt_pk_bf16_f32 v102, v212, v213
    v_cvt_pk_bf16_f32 v103, v214, v215
    s_add_u32 s24, s24, 0x4000
    s_bitset0_b32 s24, 19
    v_pk_fma_f32 v[216:217], v[36:37], v[56:57], v[216:217] op_sel:[0,0,0] op_sel_hi:[1,0,1]
    v_pk_fma_f32 v[218:219], v[38:39], v[56:57], v[218:219] op_sel:[0,0,0] op_sel_hi:[1,0,1]
    v_pk_fma_f32 v[220:221], v[40:41], v[56:57], v[220:221] op_sel:[0,0,0] op_sel_hi:[1,0,1]
    v_pk_fma_f32 v[222:223], v[42:43], v[56:57], v[222:223] op_sel:[0,0,0] op_sel_hi:[1,0,1]
    ds_read_b128 v[36:39], v127 offset:0
    ds_read_b128 v[40:43], v127 offset:64
    v_pk_mul_f32 v[216:217], v[216:217], v[56:57] op_sel:[0,1] op_sel_hi:[1,1]
    v_pk_mul_f32 v[218:219], v[218:219], v[56:57] op_sel:[0,1] op_sel_hi:[1,1]
    v_pk_mul_f32 v[220:221], v[220:221], v[56:57] op_sel:[0,1] op_sel_hi:[1,1]
    v_pk_mul_f32 v[222:223], v[222:223], v[56:57] op_sel:[0,1] op_sel_hi:[1,1]
    v_cvt_pk_bf16_f32 v116, v216, v217
    v_cvt_pk_bf16_f32 v117, v218, v219
    v_cvt_pk_bf16_f32 v118, v220, v221
    v_cvt_pk_bf16_f32 v119, v222, v223
    v_permlane16_swap_b32 v68, v70
    v_permlane16_swap_b32 v69, v71
    v_permlane16_swap_b32 v84, v86
    v_permlane16_swap_b32 v85, v87
    v_permlane16_swap_b32 v100, v102
    v_permlane16_swap_b32 v101, v103
    v_permlane16_swap_b32 v116, v118
    v_permlane16_swap_b32 v117, v119
    s_waitcnt lgkmcnt(0)
    v_pk_fma_f32 v[160:161], v[28:29], v[44:45], v[160:161] op_sel:[0,0,0] op_sel_hi:[1,0,1]
    v_pk_fma_f32 v[162:163], v[30:31], v[44:45], v[162:163] op_sel:[0,0,0] op_sel_hi:[1,0,1]
    v_pk_fma_f32 v[164:165], v[32:33], v[44:45], v[164:165] op_sel:[0,0,0] op_sel_hi:[1,0,1]
    v_pk_fma_f32 v[166:167], v[34:35], v[44:45], v[166:167] op_sel:[0,0,0] op_sel_hi:[1,0,1]
    v_pk_mul_f32 v[160:161], v[160:161], v[44:45] op_sel:[0,1] op_sel_hi:[1,1]
    v_pk_mul_f32 v[162:163], v[162:163], v[44:45] op_sel:[0,1] op_sel_hi:[1,1]
    v_pk_mul_f32 v[164:165], v[164:165], v[44:45] op_sel:[0,1] op_sel_hi:[1,1]
    v_pk_mul_f32 v[166:167], v[166:167], v[44:45] op_sel:[0,1] op_sel_hi:[1,1]
    v_cvt_pk_bf16_f32 v72, v160, v161
    v_cvt_pk_bf16_f32 v73, v162, v163
    v_cvt_pk_bf16_f32 v74, v164, v165
    v_cvt_pk_bf16_f32 v75, v166, v167
    v_pk_fma_f32 v[168:169], v[28:29], v[48:49], v[168:169] op_sel:[0,0,0] op_sel_hi:[1,0,1]
    v_pk_fma_f32 v[170:171], v[30:31], v[48:49], v[170:171] op_sel:[0,0,0] op_sel_hi:[1,0,1]
    v_pk_fma_f32 v[172:173], v[32:33], v[48:49], v[172:173] op_sel:[0,0,0] op_sel_hi:[1,0,1]
    v_pk_fma_f32 v[174:175], v[34:35], v[48:49], v[174:175] op_sel:[0,0,0] op_sel_hi:[1,0,1]
    v_pk_mul_f32 v[168:169], v[168:169], v[48:49] op_sel:[0,1] op_sel_hi:[1,1]
    v_pk_mul_f32 v[170:171], v[170:171], v[48:49] op_sel:[0,1] op_sel_hi:[1,1]
    v_pk_mul_f32 v[172:173], v[172:173], v[48:49] op_sel:[0,1] op_sel_hi:[1,1]
    v_pk_mul_f32 v[174:175], v[174:175], v[48:49] op_sel:[0,1] op_sel_hi:[1,1]
    v_cvt_pk_bf16_f32 v88, v168, v169
    v_cvt_pk_bf16_f32 v89, v170, v171
    v_cvt_pk_bf16_f32 v90, v172, v173
    v_cvt_pk_bf16_f32 v91, v174, v175
    v_pk_fma_f32 v[176:177], v[28:29], v[52:53], v[176:177] op_sel:[0,0,0] op_sel_hi:[1,0,1]
    v_pk_fma_f32 v[178:179], v[30:31], v[52:53], v[178:179] op_sel:[0,0,0] op_sel_hi:[1,0,1]
    v_pk_fma_f32 v[180:181], v[32:33], v[52:53], v[180:181] op_sel:[0,0,0] op_sel_hi:[1,0,1]
    v_pk_fma_f32 v[182:183], v[34:35], v[52:53], v[182:183] op_sel:[0,0,0] op_sel_hi:[1,0,1]
    v_pk_mul_f32 v[176:177], v[176:177], v[52:53] op_sel:[0,1] op_sel_hi:[1,1]
    v_pk_mul_f32 v[178:179], v[178:179], v[52:53] op_sel:[0,1] op_sel_hi:[1,1]
    v_pk_mul_f32 v[180:181], v[180:181], v[52:53] op_sel:[0,1] op_sel_hi:[1,1]
    v_pk_mul_f32 v[182:183], v[182:183], v[52:53] op_sel:[0,1] op_sel_hi:[1,1]
    v_cvt_pk_bf16_f32 v104, v176, v177
    v_cvt_pk_bf16_f32 v105, v178, v179
    v_cvt_pk_bf16_f32 v106, v180, v181
    v_cvt_pk_bf16_f32 v107, v182, v183
    v_pk_fma_f32 v[184:185], v[28:29], v[56:57], v[184:185] op_sel:[0,0,0] op_sel_hi:[1,0,1]
    v_pk_fma_f32 v[186:187], v[30:31], v[56:57], v[186:187] op_sel:[0,0,0] op_sel_hi:[1,0,1]
    v_pk_fma_f32 v[188:189], v[32:33], v[56:57], v[188:189] op_sel:[0,0,0] op_sel_hi:[1,0,1]
    v_pk_fma_f32 v[190:191], v[34:35], v[56:57], v[190:191] op_sel:[0,0,0] op_sel_hi:[1,0,1]
    v_pk_mul_f32 v[184:185], v[184:185], v[56:57] op_sel:[0,1] op_sel_hi:[1,1]
    v_pk_mul_f32 v[186:187], v[186:187], v[56:57] op_sel:[0,1] op_sel_hi:[1,1]
    v_pk_mul_f32 v[188:189], v[188:189], v[56:57] op_sel:[0,1] op_sel_hi:[1,1]
    v_pk_mul_f32 v[190:191], v[190:191], v[56:57] op_sel:[0,1] op_sel_hi:[1,1]
    v_cvt_pk_bf16_f32 v120, v184, v185
    v_cvt_pk_bf16_f32 v121, v186, v187
    v_cvt_pk_bf16_f32 v122, v188, v189
    v_cvt_pk_bf16_f32 v123, v190, v191
    v_permlane16_swap_b32 v72, v74
    v_permlane16_swap_b32 v73, v75
    v_permlane16_swap_b32 v88, v90
    v_permlane16_swap_b32 v89, v91
    v_permlane16_swap_b32 v104, v106
    v_permlane16_swap_b32 v105, v107
    v_permlane16_swap_b32 v120, v122
    v_permlane16_swap_b32 v121, v123
    s_waitcnt lgkmcnt(0)
    v_pk_fma_f32 v[128:129], v[36:37], v[44:45], v[128:129] op_sel:[0,0,0] op_sel_hi:[1,0,1]
    v_pk_fma_f32 v[130:131], v[38:39], v[44:45], v[130:131] op_sel:[0,0,0] op_sel_hi:[1,0,1]
    v_pk_fma_f32 v[132:133], v[40:41], v[44:45], v[132:133] op_sel:[0,0,0] op_sel_hi:[1,0,1]
    v_pk_fma_f32 v[134:135], v[42:43], v[44:45], v[134:135] op_sel:[0,0,0] op_sel_hi:[1,0,1]
    v_pk_mul_f32 v[128:129], v[128:129], v[44:45] op_sel:[0,1] op_sel_hi:[1,1]
    v_pk_mul_f32 v[130:131], v[130:131], v[44:45] op_sel:[0,1] op_sel_hi:[1,1]
    v_pk_mul_f32 v[132:133], v[132:133], v[44:45] op_sel:[0,1] op_sel_hi:[1,1]
    v_pk_mul_f32 v[134:135], v[134:135], v[44:45] op_sel:[0,1] op_sel_hi:[1,1]
    v_cvt_pk_bf16_f32 v76, v128, v129
    v_cvt_pk_bf16_f32 v77, v130, v131
    v_cvt_pk_bf16_f32 v78, v132, v133
    v_cvt_pk_bf16_f32 v79, v134, v135
    v_pk_fma_f32 v[136:137], v[36:37], v[48:49], v[136:137] op_sel:[0,0,0] op_sel_hi:[1,0,1]
    v_pk_fma_f32 v[138:139], v[38:39], v[48:49], v[138:139] op_sel:[0,0,0] op_sel_hi:[1,0,1]
    v_pk_fma_f32 v[140:141], v[40:41], v[48:49], v[140:141] op_sel:[0,0,0] op_sel_hi:[1,0,1]
    v_pk_fma_f32 v[142:143], v[42:43], v[48:49], v[142:143] op_sel:[0,0,0] op_sel_hi:[1,0,1]
    v_pk_mul_f32 v[136:137], v[136:137], v[48:49] op_sel:[0,1] op_sel_hi:[1,1]
    v_pk_mul_f32 v[138:139], v[138:139], v[48:49] op_sel:[0,1] op_sel_hi:[1,1]
    v_pk_mul_f32 v[140:141], v[140:141], v[48:49] op_sel:[0,1] op_sel_hi:[1,1]
    v_pk_mul_f32 v[142:143], v[142:143], v[48:49] op_sel:[0,1] op_sel_hi:[1,1]
    v_cvt_pk_bf16_f32 v92, v136, v137
    v_cvt_pk_bf16_f32 v93, v138, v139
    v_cvt_pk_bf16_f32 v94, v140, v141
    v_cvt_pk_bf16_f32 v95, v142, v143
    v_pk_fma_f32 v[144:145], v[36:37], v[52:53], v[144:145] op_sel:[0,0,0] op_sel_hi:[1,0,1]
    v_pk_fma_f32 v[146:147], v[38:39], v[52:53], v[146:147] op_sel:[0,0,0] op_sel_hi:[1,0,1]
    v_pk_fma_f32 v[148:149], v[40:41], v[52:53], v[148:149] op_sel:[0,0,0] op_sel_hi:[1,0,1]
    v_pk_fma_f32 v[150:151], v[42:43], v[52:53], v[150:151] op_sel:[0,0,0] op_sel_hi:[1,0,1]
    v_pk_mul_f32 v[144:145], v[144:145], v[52:53] op_sel:[0,1] op_sel_hi:[1,1]
    v_pk_mul_f32 v[146:147], v[146:147], v[52:53] op_sel:[0,1] op_sel_hi:[1,1]
    v_pk_mul_f32 v[148:149], v[148:149], v[52:53] op_sel:[0,1] op_sel_hi:[1,1]
    v_pk_mul_f32 v[150:151], v[150:151], v[52:53] op_sel:[0,1] op_sel_hi:[1,1]
    v_cvt_pk_bf16_f32 v108, v144, v145
    v_cvt_pk_bf16_f32 v109, v146, v147
    v_cvt_pk_bf16_f32 v110, v148, v149
    v_cvt_pk_bf16_f32 v111, v150, v151
    v_pk_fma_f32 v[152:153], v[36:37], v[56:57], v[152:153] op_sel:[0,0,0] op_sel_hi:[1,0,1]
    v_pk_fma_f32 v[154:155], v[38:39], v[56:57], v[154:155] op_sel:[0,0,0] op_sel_hi:[1,0,1]
    v_pk_fma_f32 v[156:157], v[40:41], v[56:57], v[156:157] op_sel:[0,0,0] op_sel_hi:[1,0,1]
    v_pk_fma_f32 v[158:159], v[42:43], v[56:57], v[158:159] op_sel:[0,0,0] op_sel_hi:[1,0,1]
    v_pk_mul_f32 v[152:153], v[152:153], v[56:57] op_sel:[0,1] op_sel_hi:[1,1]
    v_pk_mul_f32 v[154:155], v[154:155], v[56:57] op_sel:[0,1] op_sel_hi:[1,1]
    v_pk_mul_f32 v[156:157], v[156:157], v[56:57] op_sel:[0,1] op_sel_hi:[1,1]
    v_pk_mul_f32 v[158:159], v[158:159], v[56:57] op_sel:[0,1] op_sel_hi:[1,1]
    v_cvt_pk_bf16_f32 v124, v152, v153
    v_cvt_pk_bf16_f32 v125, v154, v155
    v_cvt_pk_bf16_f32 v126, v156, v157
    v_cvt_pk_bf16_f32 v127, v158, v159
    v_permlane16_swap_b32 v76, v78
    v_permlane16_swap_b32 v77, v79
    v_permlane16_swap_b32 v92, v94
    v_permlane16_swap_b32 v93, v95
    v_permlane16_swap_b32 v108, v110
    v_permlane16_swap_b32 v109, v111
    v_permlane16_swap_b32 v124, v126
    v_permlane16_swap_b32 v125, v127
    v_mfma_f32_16x16x32_bf16 v[176:179], a[192:195], v[64:67], 0
    v_mov_b32 v28, 0
    v_mov_b32 v29, 0
    v_mfma_f32_16x16x32_bf16 v[176:179], a[196:199], v[68:71], v[176:179]
    v_mov_b32 v30, 0
    v_mov_b32 v31, 0
    v_mfma_f32_16x16x32_bf16 v[176:179], a[200:203], v[72:75], v[176:179]
    v_mov_b32 v32, 0
    v_mov_b32 v33, 0
    v_mfma_f32_16x16x32_bf16 v[176:179], a[204:207], v[76:79], v[176:179]
    v_mov_b32 v34, 0
    v_mov_b32 v35, 0
    v_mfma_f32_16x16x32_bf16 v[180:183], a[192:195], v[80:83], 0
    v_mov_b32 v36, 0
    v_mov_b32 v37, 0
    v_mfma_f32_16x16x32_bf16 v[180:183], a[196:199], v[84:87], v[180:183]
    v_mov_b32 v38, 0
    v_mov_b32 v39, 0
    v_mfma_f32_16x16x32_bf16 v[180:183], a[200:203], v[88:91], v[180:183]
    v_mov_b32 v40, 0
    v_mov_b32 v41, 0
    v_mfma_f32_16x16x32_bf16 v[180:183], a[204:207], v[92:95], v[180:183]
    v_mov_b32 v42, 0
    v_mov_b32 v43, 0
    v_mfma_f32_16x16x32_bf16 v[184:187], a[192:195], v[96:99], 0
    v_max3_f32 v176, v176, v177, v178
    v_max_f32 v176, v176, v179
    v_mfma_f32_16x16x32_bf16 v[184:187], a[196:199], v[100:103], v[184:187]
    v_sub_f32 v44, 0xc1800000, v176
    v_sub_f32 v45, 0xc1800000, v176
    v_mfma_f32_16x16x32_bf16 v[184:187], a[200:203], v[104:107], v[184:187]
    v_sub_f32 v46, 0xc1800000, v176
    v_sub_f32 v47, 0xc1800000, v176
    v_mfma_f32_16x16x32_bf16 v[184:187], a[204:207], v[108:111], v[184:187]
    v_max3_f32 v180, v180, v181, v182
    v_max_f32 v180, v180, v183
    v_mfma_f32_16x16x32_bf16 v[188:191], a[192:195], v[112:115], 0
    v_sub_f32 v48, 0xc1800000, v180
    v_sub_f32 v49, 0xc1800000, v180
    v_mfma_f32_16x16x32_bf16 v[188:191], a[196:199], v[116:119], v[188:191]
    v_sub_f32 v50, 0xc1800000, v180
    v_sub_f32 v51, 0xc1800000, v180
    v_mfma_f32_16x16x32_bf16 v[188:191], a[200:203], v[120:123], v[188:191]
    v_mfma_f32_16x16x32_bf16 v[188:191], a[204:207], v[124:127], v[188:191]
    v_max3_f32 v184, v184, v185, v186
    v_max_f32 v184, v184, v187
    v_sub_f32 v52, 0xc1800000, v184
    v_sub_f32 v53, 0xc1800000, v184
    v_sub_f32 v54, 0xc1800000, v184
    v_sub_f32 v55, 0xc1800000, v184
    s_nop 0
    s_nop 0
    v_max3_f32 v188, v188, v189, v190
    v_max_f32 v188, v188, v191
    v_sub_f32 v56, 0xc1800000, v188
    v_sub_f32 v57, 0xc1800000, v188
    v_sub_f32 v58, 0xc1800000, v188
    v_sub_f32 v59, 0xc1800000, v188
    s_nop 1
    s_mov_b32 s43, 0x07060302
L_restart:
    v_mfma_f32_16x16x32_bf16 v[128:131], a[128:131], v[64:67], v[44:47]
    s_waitcnt vmcnt(22)
    s_barrier
    v_mfma_f32_16x16x32_bf16 v[128:131], a[132:135], v[68:71], v[128:131]
    s_add_u32 m0, s25, 0
    ds_read_b64_tr_b16 a[192:193], v8 offset:16384
    ds_read_b64_tr_b16 a[194:195], v8 offset:20480
    v_mfma_f32_16x16x32_bf16 v[128:131], a[136:139], v[72:75], v[128:131]
    buffer_load_dwordx4 v16, s[8:11], s23 offen offset:0 nt lds
    v_mfma_f32_16x16x32_bf16 v[128:131], a[140:143], v[76:79], v[128:131]
    ds_read_b64_tr_b16 a[224:225], v8 offset:24576
    ds_read_b64_tr_b16 a[226:227], v8 offset:28672
    v_mfma_f32_16x16x32_bf16 v[132:135], a[156:159], v[76:79], v[44:47]
    ds_read_b64_tr_b16 a[196:197], v9 offset:16384
    ds_read_b64_tr_b16 a[198:199], v9 offset:20480
    v_mfma_f32_16x16x32_bf16 v[132:135], a[152:155], v[72:75], v[132:135]
    s_nop 0
    v_mfma_f32_16x16x32_bf16 v[132:135], a[148:151], v[68:71], v[132:135]
    buffer_load_dwordx4 v17, s[8:11], s23 offen offset:1024 nt lds
    v_mfma_f32_16x16x32_bf16 v[132:135], a[144:147], v[64:67], v[132:135]
    v_exp_f32 v128, v128
    v_mfma_f32_16x16x32_bf16 v[136:139], a[160:163], v[64:67], v[44:47]
    v_exp_f32 v129, v129
    v_mfma_f32_16x16x32_bf16 v[136:139], a[164:167], v[68:71], v[136:139]
    v_exp_f32 v130, v130
    v_mfma_f32_16x16x32_bf16 v[136:139], a[168:171], v[72:75], v[136:139]
    buffer_load_dwordx4 v18, s[8:11], s23 offen offset:2048 nt lds
    v_mfma_f32_16x16x32_bf16 v[136:139], a[172:175], v[76:79], v[136:139]
    v_exp_f32 v131, v131
    v_mfma_f32_16x16x32_bf16 v[140:143], a[188:191], v[76:79], v[44:47]
    v_exp_f32 v132, v132
    v_mfma_f32_16x16x32_bf16 v[140:143], a[184:187], v[72:75], v[140:143]
    v_perm_b32 v192, v129, v128, s43
    v_perm_b32 v193, v131, v130, s43
    v_mfma_f32_16x16x32_bf16 v[140:143], a[180:183], v[68:71], v[140:143]
    buffer_load_dwordx4 v19, s[8:11], s23 offen offset:3072 nt lds
    v_mfma_f32_16x16x32_bf16 v[140:143], a[176:179], v[64:67], v[140:143]
    s_add_u32 s23, s23, 0x4000
    v_exp_f32 v133, v133
    v_mfma_f32_16x16x32_bf16 v[144:147], a[128:131], v[80:83], v[48:51]
    s_bitset0_b32 s23, 19
    v_exp_f32 v134, v134
    v_mfma_f32_16x16x32_bf16 v[144:147], a[132:135], v[84:87], v[144:147]
    s_add_u32 m0, s26, 0
    v_exp_f32 v135, v135
    v_mfma_f32_16x16x32_bf16 v[144:147], a[136:139], v[88:91], v[144:147]
    buffer_load_dwordx4 v20, s[12:15], s24 offen offset:0 nt lds
    v_mfma_f32_16x16x32_bf16 v[144:147], a[140:143], v[92:95], v[144:147]
    v_exp_f32 v136, v136
    v_mfma_f32_16x16x32_bf16 v[148:151], a[156:159], v[92:95], v[48:51]
    v_perm_b32 v194, v133, v132, s43
    v_perm_b32 v195, v135, v134, s43
    v_mfma_f32_16x16x32_bf16 v[148:151], a[152:155], v[88:91], v[148:151]
    v_exp_f32 v137, v137
    v_mfma_f32_16x16x32_bf16 v[148:151], a[148:151], v[84:87], v[148:151]
    buffer_load_dwordx4 v21, s[12:15], s24 offen offset:1024 nt lds
    v_mfma_f32_16x16x32_bf16 v[148:151], a[144:147], v[80:83], v[148:151]
    v_exp_f32 v138, v138
    v_mfma_f32_16x16x32_bf16 v[152:155], a[160:163], v[80:83], v[48:51]
    v_exp_f32 v139, v139
    v_mfma_f32_16x16x32_bf16 v[152:155], a[164:167], v[84:87], v[152:155]
    v_exp_f32 v140, v140
    v_mfma_f32_16x16x32_bf16 v[152:155], a[168:171], v[88:91], v[152:155]
    buffer_load_dwordx4 v20, s[12:15], s24 offen offset:2048 nt lds
    v_mfma_f32_16x16x32_bf16 v[152:155], a[172:175], v[92:95], v[152:155]
    v_perm_b32 v196, v137, v136, s43
    v_perm_b32 v197, v139, v138, s43
    v_mfma_f32_16x16x32_bf16 v[156:159], a[188:191], v[92:95], v[48:51]
    v_exp_f32 v141, v141
    v_mfma_f32_16x16x32_bf16 v[156:159], a[184:187], v[88:91], v[156:159]
    v_exp_f32 v142, v142
    v_mfma_f32_16x16x32_bf16 v[156:159], a[180:183], v[84:87], v[156:159]
    buffer_load_dwordx4 v21, s[12:15], s24 offen offset:3072 nt lds
    v_mfma_f32_16x16x32_bf16 v[156:159], a[176:179], v[80:83], v[156:159]
    s_add_u32 s24, s24, 0x4000
    v_exp_f32 v143, v143
    v_mfma_f32_16x16x32_bf16 v[160:163], a[128:131], v[96:99], v[52:55]
    s_bitset0_b32 s24, 19
    v_exp_f32 v144, v144
    v_mfma_f32_16x16x32_bf16 v[160:163], a[132:135], v[100:103], v[160:163]
    v_exp_f32 v145, v145
    v_mfma_f32_16x16x32_bf16 v[160:163], a[136:139], v[104:107], v[160:163]
    v_exp_f32 v146, v146
    v_mfma_f32_16x16x32_bf16 v[160:163], a[140:143], v[108:111], v[160:163]
    v_exp_f32 v147, v147
    v_mfma_f32_16x16x32_bf16 v[164:167], a[156:159], v[108:111], v[52:55]
    v_exp_f32 v148, v148
    v_mfma_f32_16x16x32_bf16 v[164:167], a[152:155], v[104:107], v[164:167]
    v_exp_f32 v149, v149
    v_mfma_f32_16x16x32_bf16 v[164:167], a[148:151], v[100:103], v[164:167]
    v_exp_f32 v150, v150
    v_mfma_f32_16x16x32_bf16 v[164:167], a[144:147], v[96:99], v[164:167]
    v_exp_f32 v151, v151
    v_mfma_f32_16x16x32_bf16 v[168:171], a[160:163], v[96:99], v[52:55]
    v_exp_f32 v152, v152
    v_mfma_f32_16x16x32_bf16 v[168:171], a[164:167], v[100:103], v[168:171]
    v_exp_f32 v153, v153
    v_mfma_f32_16x16x32_bf16 v[168:171], a[168:171], v[104:107], v[168:171]
    v_exp_f32 v154, v154
    v_mfma_f32_16x16x32_bf16 v[168:171], a[172:175], v[108:111], v[168:171]
    v_exp_f32 v155, v155
    v_mfma_f32_16x16x32_bf16 v[172:175], a[188:191], v[108:111], v[52:55]
    v_exp_f32 v156, v156
    v_mfma_f32_16x16x32_bf16 v[172:175], a[184:187], v[104:107], v[172:175]
    v_exp_f32 v157, v157
    v_mfma_f32_16x16x32_bf16 v[172:175], a[180:183], v[100:103], v[172:175]
    v_exp_f32 v158, v158
    v_mfma_f32_16x16x32_bf16 v[172:175], a[176:179], v[96:99], v[172:175]
    v_exp_f32 v159, v159
    v_mfma_f32_16x16x32_bf16 v[176:179], a[128:131], v[112:115], v[56:59]
    v_exp_f32 v160, v160
    v_mfma_f32_16x16x32_bf16 v[176:179], a[132:135], v[116:119], v[176:179]
    ds_read_b128 a[128:131], v4 offset:16384
    v_perm_b32 v198, v141, v140, s43
    v_mfma_f32_16x16x32_bf16 v[176:179], a[136:139], v[120:123], v[176:179]
    ds_read_b128 a[132:135], v5 offset:16384
    v_perm_b32 v199, v143, v142, s43
    v_mfma_f32_16x16x32_bf16 v[176:179], a[140:143], v[124:127], v[176:179]
    ds_read_b128 a[136:139], v6 offset:16384
    v_perm_b32 v200, v145, v144, s43
    v_mfma_f32_16x16x32_bf16 v[180:183], a[156:159], v[124:127], v[56:59]
    ds_read_b128 a[140:143], v7 offset:16384
    v_perm_b32 v201, v147, v146, s43
    v_mfma_f32_16x16x32_bf16 v[180:183], a[152:155], v[120:123], v[180:183]
    ds_read_b128 a[156:159], v7 offset:20480
    v_perm_b32 v202, v149, v148, s43
    v_mfma_f32_16x16x32_bf16 v[180:183], a[148:151], v[116:119], v[180:183]
    ds_read_b128 a[152:155], v6 offset:20480
    v_perm_b32 v203, v151, v150, s43
    v_mfma_f32_16x16x32_bf16 v[180:183], a[144:147], v[112:115], v[180:183]
    ds_read_b128 a[148:151], v5 offset:20480
    v_perm_b32 v204, v153, v152, s43
    v_mfma_f32_16x16x32_bf16 v[184:187], a[160:163], v[112:115], v[56:59]
    ds_read_b128 a[144:147], v4 offset:20480
    v_perm_b32 v205, v155, v154, s43
    v_mfma_f32_16x16x32_bf16 v[184:187], a[164:167], v[116:119], v[184:187]
    ds_read_b128 a[160:163], v4 offset:24576
    v_perm_b32 v206, v157, v156, s43
    v_mfma_f32_16x16x32_bf16 v[184:187], a[168:171], v[120:123], v[184:187]
    ds_read_b128 a[164:167], v5 offset:24576
    v_perm_b32 v207, v159, v158, s43
    v_mfma_f32_16x16x32_bf16 v[184:187], a[172:175], v[124:127], v[184:187]
    v_exp_f32 v161, v161
    v_mfma_f32_16x16x32_bf16 v[188:191], a[188:191], v[124:127], v[56:59]
    ds_read_b128 a[168:171], v6 offset:24576
    ds_read_b128 a[172:175], v7 offset:24576
    v_mfma_f32_16x16x32_bf16 v[188:191], a[184:187], v[120:123], v[188:191]
    v_exp_f32 v162, v162
    v_mfma_f32_16x16x32_bf16 v[188:191], a[180:183], v[116:119], v[188:191]
    ds_read_b128 a[188:191], v7 offset:28672
    v_perm_b32 v208, v161, v160, s43
    v_mfma_f32_16x16x32_bf16 v[188:191], a[176:179], v[112:115], v[188:191]
    ds_read_b128 a[184:187], v6 offset:28672
    ds_read_b128 a[180:183], v5 offset:28672
    ds_read_b128 a[176:179], v4 offset:28672
    v_exp_f32 v163, v163
    v_exp_f32 v164, v164
    v_perm_b32 v209, v163, v162, s43
    v_exp_f32 v165, v165
    v_exp_f32 v166, v166
    v_perm_b32 v210, v165, v164, s43
    v_exp_f32 v167, v167
    v_exp_f32 v168, v168
    v_perm_b32 v211, v167, v166, s43
    v_exp_f32 v169, v169
    v_exp_f32 v170, v170
    v_perm_b32 v212, v169, v168, s43
    v_exp_f32 v171, v171
    v_exp_f32 v172, v172
    v_perm_b32 v213, v171, v170, s43
    v_exp_f32 v173, v173
    v_exp_f32 v174, v174
    v_perm_b32 v214, v173, v172, s43
    v_exp_f32 v175, v175
    v_exp_f32 v176, v176
    v_perm_b32 v215, v175, v174, s43
    v_exp_f32 v177, v177
    v_exp_f32 v178, v178
    v_perm_b32 v216, v177, v176, s43
    v_exp_f32 v179, v179
    v_exp_f32 v180, v180
    v_perm_b32 v217, v179, v178, s43
    v_exp_f32 v181, v181
    v_exp_f32 v182, v182
    v_perm_b32 v218, v181, v180, s43
    v_exp_f32 v183, v183
    v_exp_f32 v184, v184
    v_perm_b32 v219, v183, v182, s43
    v_exp_f32 v185, v185
    v_exp_f32 v186, v186
    v_perm_b32 v220, v185, v184, s43
    v_exp_f32 v187, v187
    s_nop 0
    v_perm_b32 v221, v187, v186, s43
    s_waitcnt lgkmcnt(0)
    s_cmp_lg_u32 s0, 0
    s_cbranch_scc1 L_notouch
    s_waitcnt vmcnt(14)
    s_mov_b64 exec, 1
    buffer_store_dwordx4 v[60:63], off, s[16:19], s65 sc1
    s_mov_b64 exec, -1
    s_cmp_lg_u32 s66, 0
    s_cbranch_scc1 L_notouch
    global_load_dword v23, v23, s[6:7]
L_notouch:
L_loop:
    v_mfma_f32_16x16x32_bf16 v[128:131], a[128:131], v[64:67], v[44:47]
    v_exp_f32 v188, v188
    v_mfma_f32_16x16x32_bf16 v[128:131], a[132:135], v[68:71], v[128:131]
    ds_read_b64_tr_b16 a[228:229], v9 offset:24576
    v_mfma_f32_16x16x32_bf16 v[128:131], a[136:139], v[72:75], v[128:131]
    v_exp_f32 v189, v189
    v_mfma_f32_16x16x32_bf16 v[128:131], a[140:143], v[76:79], v[128:131]
    ds_read_b64_tr_b16 a[230:231], v9 offset:28672
    v_perm_b32 v222, v189, v188, s43
    v_mfma_f32_16x16x32_bf16 v[132:135], a[156:159], v[76:79], v[44:47]
    v_exp_f32 v190, v190
    v_mfma_f32_16x16x32_bf16 v[132:135], a[152:155], v[72:75], v[132:135]
    ds_read_b64_tr_b16 a[200:201], v10 offset:16384
    v_mfma_f32_16x16x32_bf16 v[132:135], a[148:151], v[68:71], v[132:135]
    v_exp_f32 v191, v191
    v_mfma_f32_16x16x32_bf16 v[132:135], a[144:147], v[64:67], v[132:135]
    ds_read_b64_tr_b16 a[202:203], v10 offset:20480
    v_perm_b32 v223, v191, v190, s43
    v_mfma_f32_16x16x32_bf16 v[136:139], a[160:163], v[64:67], v[44:47]
    v_exp_f32 v128, v128
    v_mfma_f32_16x16x32_bf16 v[136:139], a[164:167], v[68:71], v[136:139]
    ds_read_b64_tr_b16 a[232:233], v10 offset:24576
    v_mfma_f32_16x16x32_bf16 v[136:139], a[168:171], v[72:75], v[136:139]
    v_exp_f32 v129, v129
    v_mfma_f32_16x16x32_bf16 v[136:139], a[172:175], v[76:79], v[136:139]
    ds_read_b64_tr_b16 a[234:235], v10 offset:28672
    v_perm_b32 v224, v129, v128, s43
    v_mfma_f32_16x16x32_bf16 v[140:143], a[188:191], v[76:79], v[44:47]
    v_exp_f32 v130, v130
    v_mfma_f32_16x16x32_bf16 v[140:143], a[184:187], v[72:75], v[140:143]
    ds_read_b64_tr_b16 a[204:205], v11 offset:16384
    v_mfma_f32_16x16x32_bf16 v[140:143], a[180:183], v[68:71], v[140:143]
    v_exp_f32 v131, v131
    v_mfma_f32_16x16x32_bf16 v[140:143], a[176:179], v[64:67], v[140:143]
    ds_read_b64_tr_b16 a[206:207], v11 offset:20480
    v_perm_b32 v225, v131, v130, s43
    v_mfma_f32_16x16x32_bf16 v[144:147], a[128:131], v[80:83], v[48:51]
    v_exp_f32 v132, v132
    v_mfma_f32_16x16x32_bf16 v[144:147], a[132:135], v[84:87], v[144:147]
    ds_read_b64_tr_b16 a[236:237], v11 offset:24576
    v_mfma_f32_16x16x32_bf16 v[144:147], a[136:139], v[88:91], v[144:147]
    v_exp_f32 v133, v133
    v_mfma_f32_16x16x32_bf16 v[144:147], a[140:143], v[92:95], v[144:147]
    ds_read_b64_tr_b16 a[238:239], v11 offset:28672
    v_perm_b32 v226, v133, v132, s43
    v_mfma_f32_16x16x32_bf16 v[148:151], a[156:159], v[92:95], v[48:51]
    v_exp_f32 v134, v134
    v_mfma_f32_16x16x32_bf16 v[148:151], a[152:155], v[88:91], v[148:151]
    ds_read_b64_tr_b16 a[208:209], v12 offset:16384
    v_mfma_f32_16x16x32_bf16 v[148:151], a[148:151], v[84:87], v[148:151]
    v_exp_f32 v135, v135
    v_mfma_f32_16x16x32_bf16 v[148:151], a[144:147], v[80:83], v[148:151]
    ds_read_b64_tr_b16 a[210:211], v12 offset:20480
    v_perm_b32 v227, v135, v134, s43
    v_mfma_f32_16x16x32_bf16 v[152:155], a[160:163], v[80:83], v[48:51]
    v_exp_f32 v136, v136
    v_mfma_f32_16x16x32_bf16 v[152:155], a[164:167], v[84:87], v[152:155]
    ds_read_b64_tr_b16 a[240:241], v12 offset:24576
    v_mfma_f32_16x16x32_bf16 v[152:155], a[168:171], v[88:91], v[152:155]
    v_exp_f32 v137, v137
    v_mfma_f32_16x16x32_bf16 v[152:155], a[172:175], v[92:95], v[152:155]
    ds_read_b64_tr_b16 a[242:243], v12 offset:28672
    v_perm_b32 v228, v137, v136, s43
    v_mfma_f32_16x16x32_bf16 v[156:159], a[188:191], v[92:95], v[48:51]
    v_exp_f32 v138, v138
    v_mfma_f32_16x16x32_bf16 v[156:159], a[184:187], v[88:91], v[156:159]
    ds_read_b64_tr_b16 a[212:213], v13 offset:16384
    v_mfma_f32_16x16x32_bf16 v[156:159], a[180:183], v[84:87], v[156:159]
    v_exp_f32 v139, v139
    v_mfma_f32_16x16x32_bf16 v[156:159], a[176:179], v[80:83], v[156:159]
    ds_read_b64_tr_b16 a[214:215], v13 offset:20480
    v_perm_b32 v229, v139, v138, s43
    v_mfma_f32_16x16x32_bf16 v[160:163], a[128:131], v[96:99], v[52:55]
    v_exp_f32 v140, v140
    v_mfma_f32_16x16x32_bf16 v[160:163], a[132:135], v[100:103], v[160:163]
    ds_read_b64_tr_b16 a[244:245], v13 offset:24576
    v_mfma_f32_16x16x32_bf16 v[160:163], a[136:139], v[104:107], v[160:163]
    v_exp_f32 v141, v141
    v_mfma_f32_16x16x32_bf16 v[160:163], a[140:143], v[108:111], v[160:163]
    ds_read_b64_tr_b16 a[246:247], v13 offset:28672
    v_perm_b32 v230, v141, v140, s43
    v_mfma_f32_16x16x32_bf16 v[164:167], a[156:159], v[108:111], v[52:55]
    v_exp_f32 v142, v142
    v_mfma_f32_16x16x32_bf16 v[164:167], a[152:155], v[104:107], v[164:167]
    ds_read_b64_tr_b16 a[216:217], v14 offset:16384
    v_mfma_f32_16x16x32_bf16 v[164:167], a[148:151], v[100:103], v[164:167]
    v_exp_f32 v143, v143
    v_mfma_f32_16x16x32_bf16 v[164:167], a[144:147], v[96:99], v[164:167]
    ds_read_b64_tr_b16 a[218:219], v14 offset:20480
    v_perm_b32 v231, v143, v142, s43
    v_mfma_f32_16x16x32_bf16 v[168:171], a[160:163], v[96:99], v[52:55]
    v_exp_f32 v144, v144
    v_mfma_f32_16x16x32_bf16 v[168:171], a[164:167], v[100:103], v[168:171]
    ds_read_b64_tr_b16 a[248:249], v14 offset:24576
    v_mfma_f32_16x16x32_bf16 v[168:171], a[168:171], v[104:107], v[168:171]
    v_exp_f32 v145, v145
    v_mfma_f32_16x16x32_bf16 v[168:171], a[172:175], v[108:111], v[168:171]
    ds_read_b64_tr_b16 a[250:251], v14 offset:28672
    v_perm_b32 v232, v145, v144, s43
    v_mfma_f32_16x16x32_bf16 v[172:175], a[188:191], v[108:111], v[52:55]
    v_exp_f32 v146, v146
    v_mfma_f32_16x16x32_bf16 v[172:175], a[184:187], v[104:107], v[172:175]
    ds_read_b64_tr_b16 a[220:221], v15 offset:16384
    v_mfma_f32_16x16x32_bf16 v[172:175], a[180:183], v[100:103], v[172:175]
    v_exp_f32 v147, v147
    v_mfma_f32_16x16x32_bf16 v[172:175], a[176:179], v[96:99], v[172:175]
    ds_read_b64_tr_b16 a[222:223], v15 offset:20480
    v_perm_b32 v233, v147, v146, s43
    v_mfma_f32_16x16x32_bf16 v[176:179], a[128:131], v[112:115], v[56:59]
    v_exp_f32 v148, v148
    v_mfma_f32_16x16x32_bf16 v[176:179], a[132:135], v[116:119], v[176:179]
    ds_read_b64_tr_b16 a[252:253], v15 offset:24576
    v_mfma_f32_16x16x32_bf16 v[176:179], a[136:139], v[120:123], v[176:179]
    v_exp_f32 v149, v149
    v_mfma_f32_16x16x32_bf16 v[176:179], a[140:143], v[124:127], v[176:179]
    ds_read_b64_tr_b16 a[254:255], v15 offset:28672
    v_perm_b32 v234, v149, v148, s43
    v_mfma_f32_16x16x32_bf16 v[180:183], a[156:159], v[124:127], v[56:59]
    v_exp_f32 v150, v150
    v_mfma_f32_16x16x32_bf16 v[180:183], a[152:155], v[120:123], v[180:183]
    v_mfma_f32_16x16x32_bf16 v[180:183], a[148:151], v[116:119], v[180:183]
    v_exp_f32 v151, v151
    v_mfma_f32_16x16x32_bf16 v[180:183], a[144:147], v[112:115], v[180:183]
    v_perm_b32 v235, v151, v150, s43
    v_mfma_f32_16x16x32_bf16 v[184:187], a[160:163], v[112:115], v[56:59]
    v_exp_f32 v152, v152
    v_mfma_f32_16x16x32_bf16 v[184:187], a[164:167], v[116:119], v[184:187]
    v_mfma_f32_16x16x32_bf16 v[184:187], a[168:171], v[120:123], v[184:187]
    v_exp_f32 v153, v153
    v_mfma_f32_16x16x32_bf16 v[184:187], a[172:175], v[124:127], v[184:187]
    v_perm_b32 v236, v153, v152, s43
    v_mfma_f32_16x16x32_bf16 v[188:191], a[188:191], v[124:127], v[56:59]
    v_exp_f32 v154, v154
    v_mfma_f32_16x16x32_bf16 v[188:191], a[184:187], v[120:123], v[188:191]
    s_waitcnt vmcnt(16) lgkmcnt(0)
    v_mfma_f32_16x16x32_bf16 v[188:191], a[180:183], v[116:119], v[188:191]
    v_exp_f32 v155, v155
    v_mfma_f32_16x16x32_bf16 v[188:191], a[176:179], v[112:115], v[188:191]
    s_barrier
    v_mfma_f32_16x16x32_bf16 a[0:3], a[192:195], v[192:195], a[0:3]
    v_exp_f32 v156, v156
    v_mfma_f32_16x16x32_bf16 a[0:3], a[224:227], v[196:199], a[0:3]
    ds_read_b128 a[128:131], v4 offset:32768
    v_perm_b32 v237, v155, v154, s43
    v_mfma_f32_16x16x32_bf16 a[4:7], a[228:231], v[196:199], a[4:7]
    v_exp_f32 v157, v157
    v_mfma_f32_16x16x32_bf16 a[4:7], a[196:199], v[192:195], a[4:7]
    ds_read_b128 a[132:135], v5 offset:32768
    v_perm_b32 v238, v157, v156, s43
    v_mfma_f32_16x16x32_bf16 a[8:11], a[200:203], v[192:195], a[8:11]
    v_exp_f32 v158, v158
    v_mfma_f32_16x16x32_bf16 a[8:11], a[232:235], v[196:199], a[8:11]
    ds_read_b128 a[136:139], v6 offset:32768
    v_mfma_f32_16x16x32_bf16 a[12:15], a[236:239], v[196:199], a[12:15]
    v_exp_f32 v159, v159
    v_mfma_f32_16x16x32_bf16 a[12:15], a[204:207], v[192:195], a[12:15]
    ds_read_b128 a[140:143], v7 offset:32768
    v_perm_b32 v239, v159, v158, s43
    v_mfma_f32_16x16x32_bf16 a[16:19], a[208:211], v[192:195], a[16:19]
    s_add_u32 m0, s25, 16384
    v_exp_f32 v160, v160
    v_mfma_f32_16x16x32_bf16 a[16:19], a[240:243], v[196:199], a[16:19]
    buffer_load_dwordx4 v16, s[8:11], s23 offen offset:0 nt lds
    v_mfma_f32_16x16x32_bf16 a[20:23], a[244:247], v[196:199], a[20:23]
    v_exp_f32 v161, v161
    v_mfma_f32_16x16x32_bf16 a[20:23], a[212:215], v[192:195], a[20:23]
    ds_read_b128 a[144:147], v4 offset:36864
    v_perm_b32 v240, v161, v160, s43
    v_mfma_f32_16x16x32_bf16 a[24:27], a[216:219], v[192:195], a[24:27]
    v_exp_f32 v162, v162
    v_mfma_f32_16x16x32_bf16 a[24:27], a[248:251], v[196:199], a[24:27]
    buffer_load_dwordx4 v17, s[8:11], s23 offen offset:1024 nt lds
    v_mfma_f32_16x16x32_bf16 a[28:31], a[252:255], v[196:199], a[28:31]
    v_exp_f32 v163, v163
    v_mfma_f32_16x16x32_bf16 a[28:31], a[220:223], v[192:195], a[28:31]
    ds_read_b128 a[148:151], v5 offset:36864
    v_perm_b32 v241, v163, v162, s43
    v_smfmac_f32_16x16x64_bf16 v[28:31], v[24:27], v[192:199], v22
    ds_read_b128 a[152:155], v6 offset:36864
    v_mfma_f32_16x16x32_bf16 a[32:35], a[192:195], v[200:203], a[32:35]
    v_exp_f32 v164, v164
    v_mfma_f32_16x16x32_bf16 a[32:35], a[224:227], v[204:207], a[32:35]
    buffer_load_dwordx4 v18, s[8:11], s23 offen offset:2048 nt lds
    v_mfma_f32_16x16x32_bf16 a[36:39], a[228:231], v[204:207], a[36:39]
    v_exp_f32 v165, v165
    v_mfma_f32_16x16x32_bf16 a[36:39], a[196:199], v[200:203], a[36:39]
    ds_read_b128 a[156:159], v7 offset:36864
    v_perm_b32 v242, v165, v164, s43
    v_mfma_f32_16x16x32_bf16 a[40:43], a[200:203], v[200:203], a[40:43]
    v_exp_f32 v166, v166
    v_mfma_f32_16x16x32_bf16 a[40:43], a[232:235], v[204:207], a[40:43]
    ds_read_b128 a[160:163], v4 offset:40960
    v_mfma_f32_16x16x32_bf16 a[44:47], a[236:239], v[204:207], a[44:47]
    v_exp_f32 v167, v167
    v_mfma_f32_16x16x32_bf16 a[44:47], a[204:207], v[200:203], a[44:47]
    ds_read_b128 a[164:167], v5 offset:40960
    v_perm_b32 v243, v167, v166, s43
    v_mfma_f32_16x16x32_bf16 a[48:51], a[208:211], v[200:203], a[48:51]
    v_exp_f32 v168, v168
    v_mfma_f32_16x16x32_bf16 a[48:51], a[240:243], v[204:207], a[48:51]
    buffer_load_dwordx4 v19, s[8:11], s23 offen offset:3072 nt lds
    v_mfma_f32_16x16x32_bf16 a[52:55], a[244:247], v[204:207], a[52:55]
    v_exp_f32 v169, v169
    v_mfma_f32_16x16x32_bf16 a[52:55], a[212:215], v[200:203], a[52:55]
    ds_read_b128 a[168:171], v6 offset:40960
    v_perm_b32 v244, v169, v168, s43
    v_mfma_f32_16x16x32_bf16 a[56:59], a[216:219], v[200:203], a[56:59]
    v_exp_f32 v170, v170
    v_mfma_f32_16x16x32_bf16 a[56:59], a[248:251], v[204:207], a[56:59]
    ds_read_b128 a[172:175], v7 offset:40960
    v_mfma_f32_16x16x32_bf16 a[60:63], a[252:255], v[204:207], a[60:63]
    s_add_u32 m0, s26, 16384
    v_exp_f32 v171, v171
    v_mfma_f32_16x16x32_bf16 a[60:63], a[220:223], v[200:203], a[60:63]
    ds_read_b128 a[176:179], v4 offset:45056
    v_perm_b32 v245, v171, v170, s43
    v_smfmac_f32_16x16x64_bf16 v[32:35], v[24:27], v[200:207], v22
    buffer_load_dwordx4 v20, s[12:15], s24 offen offset:0 nt lds
    v_mfma_f32_16x16x32_bf16 a[64:67], a[192:195], v[208:211], a[64:67]
    v_exp_f32 v172, v172
    v_mfma_f32_16x16x32_bf16 a[64:67], a[224:227], v[212:215], a[64:67]
    ds_read_b128 a[180:183], v5 offset:45056
    v_mfma_f32_16x16x32_bf16 a[68:71], a[228:231], v[212:215], a[68:71]
    v_exp_f32 v173, v173
    v_mfma_f32_16x16x32_bf16 a[68:71], a[196:199], v[208:211], a[68:71]
    ds_read_b128 a[184:187], v6 offset:45056
    v_perm_b32 v246, v173, v172, s43
    v_mfma_f32_16x16x32_bf16 a[72:75], a[200:203], v[208:211], a[72:75]
    v_exp_f32 v174, v174
    v_mfma_f32_16x16x32_bf16 a[72:75], a[232:235], v[212:215], a[72:75]
    buffer_load_dwordx4 v21, s[12:15], s24 offen offset:1024 nt lds
    v_mfma_f32_16x16x32_bf16 a[76:79], a[236:239], v[212:215], a[76:79]
    v_exp_f32 v175, v175
    v_mfma_f32_16x16x32_bf16 a[76:79], a[204:207], v[208:211], a[76:79]
    ds_read_b128 a[188:191], v7 offset:45056
    v_perm_b32 v247, v175, v174, s43
    v_mfma_f32_16x16x32_bf16 a[80:83], a[208:211], v[208:211], a[80:83]
    v_exp_f32 v176, v176
    v_mfma_f32_16x16x32_bf16 a[80:83], a[240:243], v[212:215], a[80:83]
    v_mfma_f32_16x16x32_bf16 a[84:87], a[244:247], v[212:215], a[84:87]
    v_exp_f32 v177, v177
    v_mfma_f32_16x16x32_bf16 a[84:87], a[212:215], v[208:211], a[84:87]
    v_perm_b32 v248, v177, v176, s43
    v_mfma_f32_16x16x32_bf16 a[88:91], a[216:219], v[208:211], a[88:91]
    v_exp_f32 v178, v178
    v_mfma_f32_16x16x32_bf16 a[88:91], a[248:251], v[212:215], a[88:91]
    buffer_load_dwordx4 v1, s[12:15], s24 offen offset:2048 nt lds
    v_mfma_f32_16x16x32_bf16 a[92:95], a[252:255], v[212:215], a[92:95]
    v_exp_f32 v179, v179
    v_mfma_f32_16x16x32_bf16 a[92:95], a[220:223], v[208:211], a[92:95]
    v_perm_b32 v249, v179, v178, s43
    v_smfmac_f32_16x16x64_bf16 v[36:39], v[24:27], v[208:215], v22
    v_mfma_f32_16x16x32_bf16 a[96:99], a[192:195], v[216:219], a[96:99]
    v_exp_f32 v180, v180
    v_mfma_f32_16x16x32_bf16 a[96:99], a[224:227], v[220:223], a[96:99]
    buffer_load_dwordx4 v2, s[12:15], s24 offen offset:3072 nt lds
    v_mfma_f32_16x16x32_bf16 a[100:103], a[228:231], v[220:223], a[100:103]
    s_add_u32 s23, s23, s34
    v_exp_f32 v181, v181
    v_mfma_f32_16x16x32_bf16 a[100:103], a[196:199], v[216:219], a[100:103]
    v_perm_b32 v250, v181, v180, s43
    v_mfma_f32_16x16x32_bf16 a[104:107], a[200:203], v[216:219], a[104:107]
    s_add_u32 s24, s24, s35
    v_exp_f32 v182, v182
    v_mfma_f32_16x16x32_bf16 a[104:107], a[232:235], v[220:223], a[104:107]
    ds_read_b64_tr_b16 a[192:193], v8 offset:32768
    v_mfma_f32_16x16x32_bf16 a[108:111], a[236:239], v[220:223], a[108:111]
    s_bitset0_b32 s23, 19
    v_exp_f32 v183, v183
    v_mfma_f32_16x16x32_bf16 a[108:111], a[204:207], v[216:219], a[108:111]
    ds_read_b64_tr_b16 a[194:195], v8 offset:36864
    v_perm_b32 v251, v183, v182, s43
    v_mfma_f32_16x16x32_bf16 a[112:115], a[208:211], v[216:219], a[112:115]
    s_bitset0_b32 s24, 19
    v_exp_f32 v184, v184
    v_mfma_f32_16x16x32_bf16 a[112:115], a[240:243], v[220:223], a[112:115]
    ds_read_b64_tr_b16 a[224:225], v8 offset:40960
    v_mfma_f32_16x16x32_bf16 a[116:119], a[244:247], v[220:223], a[116:119]
    v_exp_f32 v185, v185
    v_mfma_f32_16x16x32_bf16 a[116:119], a[212:215], v[216:219], a[116:119]
    ds_read_b64_tr_b16 a[226:227], v8 offset:45056
    v_perm_b32 v252, v185, v184, s43
    v_mfma_f32_16x16x32_bf16 a[120:123], a[216:219], v[216:219], a[120:123]
    v_exp_f32 v186, v186
    v_mfma_f32_16x16x32_bf16 a[120:123], a[248:251], v[220:223], a[120:123]
    ds_read_b64_tr_b16 a[196:197], v9 offset:32768
    v_mfma_f32_16x16x32_bf16 a[124:127], a[252:255], v[220:223], a[124:127]
    v_exp_f32 v187, v187
    v_mfma_f32_16x16x32_bf16 a[124:127], a[220:223], v[216:219], a[124:127]
    ds_read_b64_tr_b16 a[198:199], v9 offset:36864
    v_perm_b32 v253, v187, v186, s43
    v_smfmac_f32_16x16x64_bf16 v[40:43], v[24:27], v[216:223], v22
    s_waitcnt lgkmcnt(6)
    v_mfma_f32_16x16x32_bf16 v[128:131], a[128:131], v[64:67], v[44:47]
    v_exp_f32 v188, v188
    v_mfma_f32_16x16x32_bf16 v[128:131], a[132:135], v[68:71], v[128:131]
    ds_read_b64_tr_b16 a[228:229], v9 offset:40960
    v_mfma_f32_16x16x32_bf16 v[128:131], a[136:139], v[72:75], v[128:131]
    v_exp_f32 v189, v189
    v_mfma_f32_16x16x32_bf16 v[128:131], a[140:143], v[76:79], v[128:131]
    ds_read_b64_tr_b16 a[230:231], v9 offset:45056
    v_perm_b32 v254, v189, v188, s43
    v_mfma_f32_16x16x32_bf16 v[132:135], a[156:159], v[76:79], v[44:47]
    v_exp_f32 v190, v190
    v_mfma_f32_16x16x32_bf16 v[132:135], a[152:155], v[72:75], v[132:135]
    ds_read_b64_tr_b16 a[200:201], v10 offset:32768
    v_mfma_f32_16x16x32_bf16 v[132:135], a[148:151], v[68:71], v[132:135]
    v_exp_f32 v191, v191
    v_mfma_f32_16x16x32_bf16 v[132:135], a[144:147], v[64:67], v[132:135]
    ds_read_b64_tr_b16 a[202:203], v10 offset:36864
    v_perm_b32 v255, v191, v190, s43
    v_mfma_f32_16x16x32_bf16 v[136:139], a[160:163], v[64:67], v[44:47]
    v_exp_f32 v128, v128
    v_mfma_f32_16x16x32_bf16 v[136:139], a[164:167], v[68:71], v[136:139]
    ds_read_b64_tr_b16 a[232:233], v10 offset:40960
    v_mfma_f32_16x16x32_bf16 v[136:139], a[168:171], v[72:75], v[136:139]
    v_exp_f32 v129, v129
    v_mfma_f32_16x16x32_bf16 v[136:139], a[172:175], v[76:79], v[136:139]
    ds_read_b64_tr_b16 a[234:235], v10 offset:45056
    v_perm_b32 v192, v129, v128, s43
    v_mfma_f32_16x16x32_bf16 v[140:143], a[188:191], v[76:79], v[44:47]
    v_exp_f32 v130, v130
    v_mfma_f32_16x16x32_bf16 v[140:143], a[184:187], v[72:75], v[140:143]
    ds_read_b64_tr_b16 a[204:205], v11 offset:32768
    v_mfma_f32_16x16x32_bf16 v[140:143], a[180:183], v[68:71], v[140:143]
    v_exp_f32 v131, v131
    v_mfma_f32_16x16x32_bf16 v[140:143], a[176:179], v[64:67], v[140:143]
    ds_read_b64_tr_b16 a[206:207], v11 offset:36864
    v_perm_b32 v193, v131, v130, s43
    v_mfma_f32_16x16x32_bf16 v[144:147], a[128:131], v[80:83], v[48:51]
    v_exp_f32 v132, v132
    v_mfma_f32_16x16x32_bf16 v[144:147], a[132:135], v[84:87], v[144:147]
    ds_read_b64_tr_b16 a[236:237], v11 offset:40960
    v_mfma_f32_16x16x32_bf16 v[144:147], a[136:139], v[88:91], v[144:147]
    v_exp_f32 v133, v133
    v_mfma_f32_16x16x32_bf16 v[144:147], a[140:143], v[92:95], v[144:147]
    ds_read_b64_tr_b16 a[238:239], v11 offset:45056
    v_perm_b32 v194, v133, v132, s43
    v_mfma_f32_16x16x32_bf16 v[148:151], a[156:159], v[92:95], v[48:51]
    v_exp_f32 v134, v134
    v_mfma_f32_16x16x32_bf16 v[148:151], a[152:155], v[88:91], v[148:151]
    ds_read_b64_tr_b16 a[208:209], v12 offset:32768
    v_mfma_f32_16x16x32_bf16 v[148:151], a[148:151], v[84:87], v[148:151]
    v_exp_f32 v135, v135
    v_mfma_f32_16x16x32_bf16 v[148:151], a[144:147], v[80:83], v[148:151]
    ds_read_b64_tr_b16 a[210:211], v12 offset:36864
    v_perm_b32 v195, v135, v134, s43
    v_mfma_f32_16x16x32_bf16 v[152:155], a[160:163], v[80:83], v[48:51]
    v_exp_f32 v136, v136
    v_mfma_f32_16x16x32_bf16 v[152:155], a[164:167], v[84:87], v[152:155]
    ds_read_b64_tr_b16 a[240:241], v12 offset:40960
    v_mfma_f32_16x16x32_bf16 v[152:155], a[168:171], v[88:91], v[152:155]
    v_exp_f32 v137, v137
    v_mfma_f32_16x16x32_bf16 v[152:155], a[172:175], v[92:95], v[152:155]
    ds_read_b64_tr_b16 a[242:243], v12 offset:45056
    v_perm_b32 v196, v137, v136, s43
    v_mfma_f32_16x16x32_bf16 v[156:159], a[188:191], v[92:95], v[48:51]
    v_exp_f32 v138, v138
    v_mfma_f32_16x16x32_bf16 v[156:159], a[184:187], v[88:91], v[156:159]
    ds_read_b64_tr_b16 a[212:213], v13 offset:32768
    v_mfma_f32_16x16x32_bf16 v[156:159], a[180:183], v[84:87], v[156:159]
    v_exp_f32 v139, v139
    v_mfma_f32_16x16x32_bf16 v[156:159], a[176:179], v[80:83], v[156:159]
    ds_read_b64_tr_b16 a[214:215], v13 offset:36864
    v_perm_b32 v197, v139, v138, s43
    v_mfma_f32_16x16x32_bf16 v[160:163], a[128:131], v[96:99], v[52:55]
    v_exp_f32 v140, v140
    v_mfma_f32_16x16x32_bf16 v[160:163], a[132:135], v[100:103], v[160:163]
    ds_read_b64_tr_b16 a[244:245], v13 offset:40960
    v_mfma_f32_16x16x32_bf16 v[160:163], a[136:139], v[104:107], v[160:163]
    v_exp_f32 v141, v141
    v_mfma_f32_16x16x32_bf16 v[160:163], a[140:143], v[108:111], v[160:163]
    ds_read_b64_tr_b16 a[246:247], v13 offset:45056
    v_perm_b32 v198, v141, v140, s43
    v_mfma_f32_16x16x32_bf16 v[164:167], a[156:159], v[108:111], v[52:55]
    v_exp_f32 v142, v142
    v_mfma_f32_16x16x32_bf16 v[164:167], a[152:155], v[104:107], v[164:167]
    ds_read_b64_tr_b16 a[216:217], v14 offset:32768
    v_mfma_f32_16x16x32_bf16 v[164:167], a[148:151], v[100:103], v[164:167]
    v_exp_f32 v143, v143
    v_mfma_f32_16x16x32_bf16 v[164:167], a[144:147], v[96:99], v[164:167]
    ds_read_b64_tr_b16 a[218:219], v14 offset:36864
    v_perm_b32 v199, v143, v142, s43
    v_mfma_f32_16x16x32_bf16 v[168:171], a[160:163], v[96:99], v[52:55]
    v_exp_f32 v144, v144
    v_mfma_f32_16x16x32_bf16 v[168:171], a[164:167], v[100:103], v[168:171]
    ds_read_b64_tr_b16 a[248:249], v14 offset:40960
    v_mfma_f32_16x16x32_bf16 v[168:171], a[168:171], v[104:107], v[168:171]
    v_exp_f32 v145, v145
    v_mfma_f32_16x16x32_bf16 v[168:171], a[172:175], v[108:111], v[168:171]
    ds_read_b64_tr_b16 a[250:251], v14 offset:45056
    v_perm_b32 v200, v145, v144, s43
    v_mfma_f32_16x16x32_bf16 v[172:175], a[188:191], v[108:111], v[52:55]
    v_exp_f32 v146, v146
    v_mfma_f32_16x16x32_bf16 v[172:175], a[184:187], v[104:107], v[172:175]
    ds_read_b64_tr_b16 a[220:221], v15 offset:32768
    v_mfma_f32_16x16x32_bf16 v[172:175], a[180:183], v[100:103], v[172:175]
    v_exp_f32 v147, v147
    v_mfma_f32_16x16x32_bf16 v[172:175], a[176:179], v[96:99], v[172:175]
    ds_read_b64_tr_b16 a[222:223], v15 offset:36864
    v_perm_b32 v201, v147, v146, s43
    v_mfma_f32_16x16x32_bf16 v[176:179], a[128:131], v[112:115], v[56:59]
    v_exp_f32 v148, v148
    v_mfma_f32_16x16x32_bf16 v[176:179], a[132:135], v[116:119], v[176:179]
    ds_read_b64_tr_b16 a[252:253], v15 offset:40960
    v_mfma_f32_16x16x32_bf16 v[176:179], a[136:139], v[120:123], v[176:179]
    v_exp_f32 v149, v149
    v_mfma_f32_16x16x32_bf16 v[176:179], a[140:143], v[124:127], v[176:179]
    ds_read_b64_tr_b16 a[254:255], v15 offset:45056
    v_perm_b32 v202, v149, v148, s43
    v_mfma_f32_16x16x32_bf16 v[180:183], a[156:159], v[124:127], v[56:59]
    v_exp_f32 v150, v150
    v_mfma_f32_16x16x32_bf16 v[180:183], a[152:155], v[120:123], v[180:183]
    v_mfma_f32_16x16x32_bf16 v[180:183], a[148:151], v[116:119], v[180:183]
    v_exp_f32 v151, v151
    v_mfma_f32_16x16x32_bf16 v[180:183], a[144:147], v[112:115], v[180:183]
    v_perm_b32 v203, v151, v150, s43
    v_mfma_f32_16x16x32_bf16 v[184:187], a[160:163], v[112:115], v[56:59]
    v_exp_f32 v152, v152
    v_mfma_f32_16x16x32_bf16 v[184:187], a[164:167], v[116:119], v[184:187]
    v_mfma_f32_16x16x32_bf16 v[184:187], a[168:171], v[120:123], v[184:187]
    v_exp_f32 v153, v153
    v_mfma_f32_16x16x32_bf16 v[184:187], a[172:175], v[124:127], v[184:187]
    v_perm_b32 v204, v153, v152, s43
    v_mfma_f32_16x16x32_bf16 v[188:191], a[188:191], v[124:127], v[56:59]
    v_exp_f32 v154, v154
    v_mfma_f32_16x16x32_bf16 v[188:191], a[184:187], v[120:123], v[188:191]
    s_waitcnt vmcnt(16) lgkmcnt(0)
    v_mfma_f32_16x16x32_bf16 v[188:191], a[180:183], v[116:119], v[188:191]
    v_exp_f32 v155, v155
    v_mfma_f32_16x16x32_bf16 v[188:191], a[176:179], v[112:115], v[188:191]
    s_barrier
    v_mfma_f32_16x16x32_bf16 a[0:3], a[192:195], v[224:227], a[0:3]
    v_exp_f32 v156, v156
    v_mfma_f32_16x16x32_bf16 a[0:3], a[224:227], v[228:231], a[0:3]
    ds_read_b128 a[128:131], v4 offset:49152
    v_perm_b32 v205, v155, v154, s43
    v_mfma_f32_16x16x32_bf16 a[4:7], a[228:231], v[228:231], a[4:7]
    v_exp_f32 v157, v157
    v_mfma_f32_16x16x32_bf16 a[4:7], a[196:199], v[224:227], a[4:7]
    ds_read_b128 a[132:135], v5 offset:49152
    v_perm_b32 v206, v157, v156, s43
    v_mfma_f32_16x16x32_bf16 a[8:11], a[200:203], v[224:227], a[8:11]
    v_exp_f32 v158, v158
    v_mfma_f32_16x16x32_bf16 a[8:11], a[232:235], v[228:231], a[8:11]
    ds_read_b128 a[136:139], v6 offset:49152
    v_mfma_f32_16x16x32_bf16 a[12:15], a[236:239], v[228:231], a[12:15]
    v_exp_f32 v159, v159
    v_mfma_f32_16x16x32_bf16 a[12:15], a[204:207], v[224:227], a[12:15]
    ds_read_b128 a[140:143], v7 offset:49152
    v_perm_b32 v207, v159, v158, s43
    v_mfma_f32_16x16x32_bf16 a[16:19], a[208:211], v[224:227], a[16:19]
    s_add_u32 m0, s25, 32768
    v_exp_f32 v160, v160
    v_mfma_f32_16x16x32_bf16 a[16:19], a[240:243], v[228:231], a[16:19]
    buffer_load_dwordx4 v16, s[8:11], s23 offen offset:0 nt lds
    v_mfma_f32_16x16x32_bf16 a[20:23], a[244:247], v[228:231], a[20:23]
    v_exp_f32 v161, v161
    v_mfma_f32_16x16x32_bf16 a[20:23], a[212:215], v[224:227], a[20:23]
    ds_read_b128 a[144:147], v4 offset:53248
    v_perm_b32 v208, v161, v160, s43
    v_mfma_f32_16x16x32_bf16 a[24:27], a[216:219], v[224:227], a[24:27]
    v_exp_f32 v162, v162
    v_mfma_f32_16x16x32_bf16 a[24:27], a[248:251], v[228:231], a[24:27]
    buffer_load_dwordx4 v17, s[8:11], s23 offen offset:1024 nt lds
    v_mfma_f32_16x16x32_bf16 a[28:31], a[252:255], v[228:231], a[28:31]
    v_exp_f32 v163, v163
    v_mfma_f32_16x16x32_bf16 a[28:31], a[220:223], v[224:227], a[28:31]
    ds_read_b128 a[148:151], v5 offset:53248
    v_perm_b32 v209, v163, v162, s43
    v_smfmac_f32_16x16x64_bf16 v[28:31], v[24:27], v[224:231], v22
    ds_read_b128 a[152:155], v6 offset:53248
    v_mfma_f32_16x16x32_bf16 a[32:35], a[192:195], v[232:235], a[32:35]
    v_exp_f32 v164, v164
    v_mfma_f32_16x16x32_bf16 a[32:35], a[224:227], v[236:239], a[32:35]
    buffer_load_dwordx4 v18, s[8:11], s23 offen offset:2048 nt lds
    v_mfma_f32_16x16x32_bf16 a[36:39], a[228:231], v[236:239], a[36:39]
    v_exp_f32 v165, v165
    v_mfma_f32_16x16x32_bf16 a[36:39], a[196:199], v[232:235], a[36:39]
    ds_read_b128 a[156:159], v7 offset:53248
    v_perm_b32 v210, v165, v164, s43
    v_mfma_f32_16x16x32_bf16 a[40:43], a[200:203], v[232:235], a[40:43]
    v_exp_f32 v166, v166
    v_mfma_f32_16x16x32_bf16 a[40:43], a[232:235], v[236:239], a[40:43]
    ds_read_b128 a[160:163], v4 offset:57344
    v_mfma_f32_16x16x32_bf16 a[44:47], a[236:239], v[236:239], a[44:47]
    v_exp_f32 v167, v167
    v_mfma_f32_16x16x32_bf16 a[44:47], a[204:207], v[232:235], a[44:47]
    ds_read_b128 a[164:167], v5 offset:57344
    v_perm_b32 v211, v167, v166, s43
    v_mfma_f32_16x16x32_bf16 a[48:51], a[208:211], v[232:235], a[48:51]
    v_exp_f32 v168, v168
    v_mfma_f32_16x16x32_bf16 a[48:51], a[240:243], v[236:239], a[48:51]
    buffer_load_dwordx4 v19, s[8:11], s23 offen offset:3072 nt lds
    v_mfma_f32_16x16x32_bf16 a[52:55], a[244:247], v[236:239], a[52:55]
    v_exp_f32 v169, v169
    v_mfma_f32_16x16x32_bf16 a[52:55], a[212:215], v[232:235], a[52:55]
    ds_read_b128 a[168:171], v6 offset:57344
    v_perm_b32 v212, v169, v168, s43
    v_mfma_f32_16x16x32_bf16 a[56:59], a[216:219], v[232:235], a[56:59]
    v_exp_f32 v170, v170
    v_mfma_f32_16x16x32_bf16 a[56:59], a[248:251], v[236:239], a[56:59]
    ds_read_b128 a[172:175], v7 offset:57344
    v_mfma_f32_16x16x32_bf16 a[60:63], a[252:255], v[236:239], a[60:63]
    s_add_u32 m0, s26, 32768
    v_exp_f32 v171, v171
    v_mfma_f32_16x16x32_bf16 a[60:63], a[220:223], v[232:235], a[60:63]
    ds_read_b128 a[176:179], v4 offset:61440
    v_perm_b32 v213, v171, v170, s43
    v_smfmac_f32_16x16x64_bf16 v[32:35], v[24:27], v[232:239], v22
    buffer_load_dwordx4 v20, s[12:15], s24 offen offset:0 nt lds
    v_mfma_f32_16x16x32_bf16 a[64:67], a[192:195], v[240:243], a[64:67]
    v_exp_f32 v172, v172
    v_mfma_f32_16x16x32_bf16 a[64:67], a[224:227], v[244:247], a[64:67]
    ds_read_b128 a[180:183], v5 offset:61440
    v_mfma_f32_16x16x32_bf16 a[68:71], a[228:231], v[244:247], a[68:71]
    v_exp_f32 v173, v173
    v_mfma_f32_16x16x32_bf16 a[68:71], a[196:199], v[240:243], a[68:71]
    ds_read_b128 a[184:187], v6 offset:61440
    v_perm_b32 v214, v173, v172, s43
    v_mfma_f32_16x16x32_bf16 a[72:75], a[200:203], v[240:243], a[72:75]
    v_exp_f32 v174, v174
    v_mfma_f32_16x16x32_bf16 a[72:75], a[232:235], v[244:247], a[72:75]
    buffer_load_dwordx4 v21, s[12:15], s24 offen offset:1024 nt lds
    v_mfma_f32_16x16x32_bf16 a[76:79], a[236:239], v[244:247], a[76:79]
    v_exp_f32 v175, v175
    v_mfma_f32_16x16x32_bf16 a[76:79], a[204:207], v[240:243], a[76:79]
    ds_read_b128 a[188:191], v7 offset:61440
    v_perm_b32 v215, v175, v174, s43
    v_mfma_f32_16x16x32_bf16 a[80:83], a[208:211], v[240:243], a[80:83]
    v_exp_f32 v176, v176
    v_mfma_f32_16x16x32_bf16 a[80:83], a[240:243], v[244:247], a[80:83]
    v_mfma_f32_16x16x32_bf16 a[84:87], a[244:247], v[244:247], a[84:87]
    v_exp_f32 v177, v177
    v_mfma_f32_16x16x32_bf16 a[84:87], a[212:215], v[240:243], a[84:87]
    v_perm_b32 v216, v177, v176, s43
    v_mfma_f32_16x16x32_bf16 a[88:91], a[216:219], v[240:243], a[88:91]
    v_exp_f32 v178, v178
    v_mfma_f32_16x16x32_bf16 a[88:91], a[248:251], v[244:247], a[88:91]
    buffer_load_dwordx4 v1, s[12:15], s24 offen offset:2048 nt lds
    v_mfma_f32_16x16x32_bf16 a[92:95], a[252:255], v[244:247], a[92:95]
    v_exp_f32 v179, v179
    v_mfma_f32_16x16x32_bf16 a[92:95], a[220:223], v[240:243], a[92:95]
    v_perm_b32 v217, v179, v178, s43
    v_smfmac_f32_16x16x64_bf16 v[36:39], v[24:27], v[240:247], v22
    v_mfma_f32_16x16x32_bf16 a[96:99], a[192:195], v[248:251], a[96:99]
    v_exp_f32 v180, v180
    v_mfma_f32_16x16x32_bf16 a[96:99], a[224:227], v[252:255], a[96:99]
    buffer_load_dwordx4 v2, s[12:15], s24 offen offset:3072 nt lds
    v_mfma_f32_16x16x32_bf16 a[100:103], a[228:231], v[252:255], a[100:103]
    s_add_u32 s23, s23, s34
    v_exp_f32 v181, v181
    v_mfma_f32_16x16x32_bf16 a[100:103], a[196:199], v[248:251], a[100:103]
    v_perm_b32 v218, v181, v180, s43
    v_mfma_f32_16x16x32_bf16 a[104:107], a[200:203], v[248:251], a[104:107]
    s_add_u32 s24, s24, s35
    v_exp_f32 v182, v182
    v_mfma_f32_16x16x32_bf16 a[104:107], a[232:235], v[252:255], a[104:107]
    ds_read_b64_tr_b16 a[192:193], v8 offset:49152
    v_mfma_f32_16x16x32_bf16 a[108:111], a[236:239], v[252:255], a[108:111]
    s_bitset0_b32 s23, 19
    v_exp_f32 v183, v183
    v_mfma_f32_16x16x32_bf16 a[108:111], a[204:207], v[248:251], a[108:111]
    ds_read_b64_tr_b16 a[194:195], v8 offset:53248
    v_perm_b32 v219, v183, v182, s43
    v_mfma_f32_16x16x32_bf16 a[112:115], a[208:211], v[248:251], a[112:115]
    s_bitset0_b32 s24, 19
    v_exp_f32 v184, v184
    v_mfma_f32_16x16x32_bf16 a[112:115], a[240:243], v[252:255], a[112:115]
    ds_read_b64_tr_b16 a[224:225], v8 offset:57344
    v_mfma_f32_16x16x32_bf16 a[116:119], a[244:247], v[252:255], a[116:119]
    s_bitcmp1_b32 s62, s27
    v_exp_f32 v185, v185
    v_mfma_f32_16x16x32_bf16 a[116:119], a[212:215], v[248:251], a[116:119]
    ds_read_b64_tr_b16 a[226:227], v8 offset:61440
    v_perm_b32 v220, v185, v184, s43
    v_mfma_f32_16x16x32_bf16 a[120:123], a[216:219], v[248:251], a[120:123]
    v_exp_f32 v186, v186
    v_mfma_f32_16x16x32_bf16 a[120:123], a[248:251], v[252:255], a[120:123]
    ds_read_b64_tr_b16 a[196:197], v9 offset:49152
    v_mfma_f32_16x16x32_bf16 a[124:127], a[252:255], v[252:255], a[124:127]
    v_exp_f32 v187, v187
    v_mfma_f32_16x16x32_bf16 a[124:127], a[220:223], v[248:251], a[124:127]
    ds_read_b64_tr_b16 a[198:199], v9 offset:53248
    v_perm_b32 v221, v187, v186, s43
    v_smfmac_f32_16x16x64_bf16 v[40:43], v[24:27], v[248:255], v22
    s_waitcnt lgkmcnt(6)
    s_cbranch_scc1 L_disp2
L_ret2:
    v_mfma_f32_16x16x32_bf16 v[128:131], a[128:131], v[64:67], v[44:47]
    v_exp_f32 v188, v188
    v_mfma_f32_16x16x32_bf16 v[128:131], a[132:135], v[68:71], v[128:131]
    ds_read_b64_tr_b16 a[228:229], v9 offset:57344
    v_mfma_f32_16x16x32_bf16 v[128:131], a[136:139], v[72:75], v[128:131]
    v_exp_f32 v189, v189
    v_mfma_f32_16x16x32_bf16 v[128:131], a[140:143], v[76:79], v[128:131]
    ds_read_b64_tr_b16 a[230:231], v9 offset:61440
    v_perm_b32 v222, v189, v188, s43
    v_mfma_f32_16x16x32_bf16 v[132:135], a[156:159], v[76:79], v[44:47]
    v_exp_f32 v190, v190
    v_mfma_f32_16x16x32_bf16 v[132:135], a[152:155], v[72:75], v[132:135]
    ds_read_b64_tr_b16 a[200:201], v10 offset:49152
    v_mfma_f32_16x16x32_bf16 v[132:135], a[148:151], v[68:71], v[132:135]
    v_exp_f32 v191, v191
    v_mfma_f32_16x16x32_bf16 v[132:135], a[144:147], v[64:67], v[132:135]
    ds_read_b64_tr_b16 a[202:203], v10 offset:53248
    v_perm_b32 v223, v191, v190, s43
    v_mfma_f32_16x16x32_bf16 v[136:139], a[160:163], v[64:67], v[44:47]
    v_exp_f32 v128, v128
    v_mfma_f32_16x16x32_bf16 v[136:139], a[164:167], v[68:71], v[136:139]
    ds_read_b64_tr_b16 a[232:233], v10 offset:57344
    v_mfma_f32_16x16x32_bf16 v[136:139], a[168:171], v[72:75], v[136:139]
    v_exp_f32 v129, v129
    v_mfma_f32_16x16x32_bf16 v[136:139], a[172:175], v[76:79], v[136:139]
    ds_read_b64_tr_b16 a[234:235], v10 offset:61440
    v_perm_b32 v224, v129, v128, s43
    v_mfma_f32_16x16x32_bf16 v[140:143], a[188:191], v[76:79], v[44:47]
    v_exp_f32 v130, v130
    v_mfma_f32_16x16x32_bf16 v[140:143], a[184:187], v[72:75], v[140:143]
    ds_read_b64_tr_b16 a[204:205], v11 offset:49152
    v_mfma_f32_16x16x32_bf16 v[140:143], a[180:183], v[68:71], v[140:143]
    v_exp_f32 v131, v131
    v_mfma_f32_16x16x32_bf16 v[140:143], a[176:179], v[64:67], v[140:143]
    ds_read_b64_tr_b16 a[206:207], v11 offset:53248
    v_perm_b32 v225, v131, v130, s43
    v_mfma_f32_16x16x32_bf16 v[144:147], a[128:131], v[80:83], v[48:51]
    v_exp_f32 v132, v132
    v_mfma_f32_16x16x32_bf16 v[144:147], a[132:135], v[84:87], v[144:147]
    ds_read_b64_tr_b16 a[236:237], v11 offset:57344
    v_mfma_f32_16x16x32_bf16 v[144:147], a[136:139], v[88:91], v[144:147]
    v_exp_f32 v133, v133
    v_mfma_f32_16x16x32_bf16 v[144:147], a[140:143], v[92:95], v[144:147]
    ds_read_b64_tr_b16 a[238:239], v11 offset:61440
    v_perm_b32 v226, v133, v132, s43
    v_mfma_f32_16x16x32_bf16 v[148:151], a[156:159], v[92:95], v[48:51]
    v_exp_f32 v134, v134
    v_mfma_f32_16x16x32_bf16 v[148:151], a[152:155], v[88:91], v[148:151]
    ds_read_b64_tr_b16 a[208:209], v12 offset:49152
    v_mfma_f32_16x16x32_bf16 v[148:151], a[148:151], v[84:87], v[148:151]
    v_exp_f32 v135, v135
    v_mfma_f32_16x16x32_bf16 v[148:151], a[144:147], v[80:83], v[148:151]
    ds_read_b64_tr_b16 a[210:211], v12 offset:53248
    v_perm_b32 v227, v135, v134, s43
    v_mfma_f32_16x16x32_bf16 v[152:155], a[160:163], v[80:83], v[48:51]
    v_exp_f32 v136, v136
    v_mfma_f32_16x16x32_bf16 v[152:155], a[164:167], v[84:87], v[152:155]
    ds_read_b64_tr_b16 a[240:241], v12 offset:57344
    v_mfma_f32_16x16x32_bf16 v[152:155], a[168:171], v[88:91], v[152:155]
    v_exp_f32 v137, v137
    v_mfma_f32_16x16x32_bf16 v[152:155], a[172:175], v[92:95], v[152:155]
    ds_read_b64_tr_b16 a[242:243], v12 offset:61440
    v_perm_b32 v228, v137, v136, s43
    v_mfma_f32_16x16x32_bf16 v[156:159], a[188:191], v[92:95], v[48:51]
    v_exp_f32 v138, v138
    v_mfma_f32_16x16x32_bf16 v[156:159], a[184:187], v[88:91], v[156:159]
    ds_read_b64_tr_b16 a[212:213], v13 offset:49152
    v_mfma_f32_16x16x32_bf16 v[156:159], a[180:183], v[84:87], v[156:159]
    v_exp_f32 v139, v139
    v_mfma_f32_16x16x32_bf16 v[156:159], a[176:179], v[80:83], v[156:159]
    ds_read_b64_tr_b16 a[214:215], v13 offset:53248
    v_perm_b32 v229, v139, v138, s43
    v_mfma_f32_16x16x32_bf16 v[160:163], a[128:131], v[96:99], v[52:55]
    v_exp_f32 v140, v140
    v_mfma_f32_16x16x32_bf16 v[160:163], a[132:135], v[100:103], v[160:163]
    ds_read_b64_tr_b16 a[244:245], v13 offset:57344
    v_mfma_f32_16x16x32_bf16 v[160:163], a[136:139], v[104:107], v[160:163]
    v_exp_f32 v141, v141
    v_mfma_f32_16x16x32_bf16 v[160:163], a[140:143], v[108:111], v[160:163]
    ds_read_b64_tr_b16 a[246:247], v13 offset:61440
    v_perm_b32 v230, v141, v140, s43
    v_mfma_f32_16x16x32_bf16 v[164:167], a[156:159], v[108:111], v[52:55]
    v_exp_f32 v142, v142
    v_mfma_f32_16x16x32_bf16 v[164:167], a[152:155], v[104:107], v[164:167]
    ds_read_b64_tr_b16 a[216:217], v14 offset:49152
    v_mfma_f32_16x16x32_bf16 v[164:167], a[148:151], v[100:103], v[164:167]
    v_exp_f32 v143, v143
    v_mfma_f32_16x16x32_bf16 v[164:167], a[144:147], v[96:99], v[164:167]
    ds_read_b64_tr_b16 a[218:219], v14 offset:53248
    v_perm_b32 v231, v143, v142, s43
    v_mfma_f32_16x16x32_bf16 v[168:171], a[160:163], v[96:99], v[52:55]
    v_exp_f32 v144, v144
    v_mfma_f32_16x16x32_bf16 v[168:171], a[164:167], v[100:103], v[168:171]
    ds_read_b64_tr_b16 a[248:249], v14 offset:57344
    v_mfma_f32_16x16x32_bf16 v[168:171], a[168:171], v[104:107], v[168:171]
    v_exp_f32 v145, v145
    v_mfma_f32_16x16x32_bf16 v[168:171], a[172:175], v[108:111], v[168:171]
    ds_read_b64_tr_b16 a[250:251], v14 offset:61440
    v_perm_b32 v232, v145, v144, s43
    v_mfma_f32_16x16x32_bf16 v[172:175], a[188:191], v[108:111], v[52:55]
    v_exp_f32 v146, v146
    v_mfma_f32_16x16x32_bf16 v[172:175], a[184:187], v[104:107], v[172:175]
    ds_read_b64_tr_b16 a[220:221], v15 offset:49152
    v_mfma_f32_16x16x32_bf16 v[172:175], a[180:183], v[100:103], v[172:175]
    v_exp_f32 v147, v147
    v_mfma_f32_16x16x32_bf16 v[172:175], a[176:179], v[96:99], v[172:175]
    ds_read_b64_tr_b16 a[222:223], v15 offset:53248
    v_perm_b32 v233, v147, v146, s43
    v_mfma_f32_16x16x32_bf16 v[176:179], a[128:131], v[112:115], v[56:59]
    v_exp_f32 v148, v148
    v_mfma_f32_16x16x32_bf16 v[176:179], a[132:135], v[116:119], v[176:179]
    ds_read_b64_tr_b16 a[252:253], v15 offset:57344
    v_mfma_f32_16x16x32_bf16 v[176:179], a[136:139], v[120:123], v[176:179]
    v_exp_f32 v149, v149
    v_mfma_f32_16x16x32_bf16 v[176:179], a[140:143], v[124:127], v[176:179]
    ds_read_b64_tr_b16 a[254:255], v15 offset:61440
    v_perm_b32 v234, v149, v148, s43
    v_mfma_f32_16x16x32_bf16 v[180:183], a[156:159], v[124:127], v[56:59]
    v_exp_f32 v150, v150
    v_mfma_f32_16x16x32_bf16 v[180:183], a[152:155], v[120:123], v[180:183]
    v_mfma_f32_16x16x32_bf16 v[180:183], a[148:151], v[116:119], v[180:183]
    v_exp_f32 v151, v151
    v_mfma_f32_16x16x32_bf16 v[180:183], a[144:147], v[112:115], v[180:183]
    v_perm_b32 v235, v151, v150, s43
    v_mfma_f32_16x16x32_bf16 v[184:187], a[160:163], v[112:115], v[56:59]
    v_exp_f32 v152, v152
    v_mfma_f32_16x16x32_bf16 v[184:187], a[164:167], v[116:119], v[184:187]
    v_mfma_f32_16x16x32_bf16 v[184:187], a[168:171], v[120:123], v[184:187]
    v_exp_f32 v153, v153
    v_mfma_f32_16x16x32_bf16 v[184:187], a[172:175], v[124:127], v[184:187]
    v_perm_b32 v236, v153, v152, s43
    v_mfma_f32_16x16x32_bf16 v[188:191], a[188:191], v[124:127], v[56:59]
    s_cmp_eq_u32 s27, 7
    v_exp_f32 v154, v154
    v_mfma_f32_16x16x32_bf16 v[188:191], a[184:187], v[120:123], v[188:191]
    s_waitcnt vmcnt(16) lgkmcnt(0)
    v_mfma_f32_16x16x32_bf16 v[188:191], a[180:183], v[116:119], v[188:191]
    v_exp_f32 v155, v155
    v_mfma_f32_16x16x32_bf16 v[188:191], a[176:179], v[112:115], v[188:191]
    s_barrier
    s_cbranch_scc1 L_tail
    v_mfma_f32_16x16x32_bf16 a[0:3], a[192:195], v[192:195], a[0:3]
    v_exp_f32 v156, v156
    v_mfma_f32_16x16x32_bf16 a[0:3], a[224:227], v[196:199], a[0:3]
    ds_read_b128 a[128:131], v4 offset:0
    v_perm_b32 v237, v155, v154, s43
    v_mfma_f32_16x16x32_bf16 a[4:7], a[228:231], v[196:199], a[4:7]
    v_exp_f32 v157, v157
    v_mfma_f32_16x16x32_bf16 a[4:7], a[196:199], v[192:195], a[4:7]
    ds_read_b128 a[132:135], v5 offset:0
    v_perm_b32 v238, v157, v156, s43
    v_mfma_f32_16x16x32_bf16 a[8:11], a[200:203], v[192:195], a[8:11]
    v_exp_f32 v158, v158
    v_mfma_f32_16x16x32_bf16 a[8:11], a[232:235], v[196:199], a[8:11]
    ds_read_b128 a[136:139], v6 offset:0
    v_mfma_f32_16x16x32_bf16 a[12:15], a[236:239], v[196:199], a[12:15]
    v_exp_f32 v159, v159
    v_mfma_f32_16x16x32_bf16 a[12:15], a[204:207], v[192:195], a[12:15]
    ds_read_b128 a[140:143], v7 offset:0
    v_perm_b32 v239, v159, v158, s43
    v_mfma_f32_16x16x32_bf16 a[16:19], a[208:211], v[192:195], a[16:19]
    s_add_u32 m0, s25, 49152
    v_exp_f32 v160, v160
    v_mfma_f32_16x16x32_bf16 a[16:19], a[240:243], v[196:199], a[16:19]
    buffer_load_dwordx4 v16, s[8:11], s23 offen offset:0 nt lds
    v_mfma_f32_16x16x32_bf16 a[20:23], a[244:247], v[196:199], a[20:23]
    v_exp_f32 v161, v161
    v_mfma_f32_16x16x32_bf16 a[20:23], a[212:215], v[192:195], a[20:23]
    ds_read_b128 a[144:147], v4 offset:4096
    v_perm_b32 v240, v161, v160, s43
    v_mfma_f32_16x16x32_bf16 a[24:27], a[216:219], v[192:195], a[24:27]
    v_exp_f32 v162, v162
    v_mfma_f32_16x16x32_bf16 a[24:27], a[248:251], v[196:199], a[24:27]
    buffer_load_dwordx4 v17, s[8:11], s23 offen offset:1024 nt lds
    v_mfma_f32_16x16x32_bf16 a[28:31], a[252:255], v[196:199], a[28:31]
    v_exp_f32 v163, v163
    v_mfma_f32_16x16x32_bf16 a[28:31], a[220:223], v[192:195], a[28:31]
    ds_read_b128 a[148:151], v5 offset:4096
    v_perm_b32 v241, v163, v162, s43
    v_smfmac_f32_16x16x64_bf16 v[28:31], v[24:27], v[192:199], v22
    ds_read_b128 a[152:155], v6 offset:4096
    v_mfma_f32_16x16x32_bf16 a[32:35], a[192:195], v[200:203], a[32:35]
    v_exp_f32 v164, v164
    v_mfma_f32_16x16x32_bf16 a[32:35], a[224:227], v[204:207], a[32:35]
    buffer_load_dwordx4 v18, s[8:11], s23 offen offset:2048 nt lds
    v_mfma_f32_16x16x32_bf16 a[36:39], a[228:231], v[204:207], a[36:39]
    v_exp_f32 v165, v165
    v_mfma_f32_16x16x32_bf16 a[36:39], a[196:199], v[200:203], a[36:39]
    ds_read_b128 a[156:159], v7 offset:4096
    v_perm_b32 v242, v165, v164, s43
    v_mfma_f32_16x16x32_bf16 a[40:43], a[200:203], v[200:203], a[40:43]
    v_exp_f32 v166, v166
    v_mfma_f32_16x16x32_bf16 a[40:43], a[232:235], v[204:207], a[40:43]
    ds_read_b128 a[160:163], v4 offset:8192
    v_mfma_f32_16x16x32_bf16 a[44:47], a[236:239], v[204:207], a[44:47]
    v_exp_f32 v167, v167
    v_mfma_f32_16x16x32_bf16 a[44:47], a[204:207], v[200:203], a[44:47]
    ds_read_b128 a[164:167], v5 offset:8192
    v_perm_b32 v243, v167, v166, s43
    v_mfma_f32_16x16x32_bf16 a[48:51], a[208:211], v[200:203], a[48:51]
    v_exp_f32 v168, v168
    v_mfma_f32_16x16x32_bf16 a[48:51], a[240:243], v[204:207], a[48:51]
    buffer_load_dwordx4 v19, s[8:11], s23 offen offset:3072 nt lds
    v_mfma_f32_16x16x32_bf16 a[52:55], a[244:247], v[204:207], a[52:55]
    v_exp_f32 v169, v169
    v_mfma_f32_16x16x32_bf16 a[52:55], a[212:215], v[200:203], a[52:55]
    ds_read_b128 a[168:171], v6 offset:8192
    v_perm_b32 v244, v169, v168, s43
    v_mfma_f32_16x16x32_bf16 a[56:59], a[216:219], v[200:203], a[56:59]
    v_exp_f32 v170, v170
    v_mfma_f32_16x16x32_bf16 a[56:59], a[248:251], v[204:207], a[56:59]
    ds_read_b128 a[172:175], v7 offset:8192
    v_mfma_f32_16x16x32_bf16 a[60:63], a[252:255], v[204:207], a[60:63]
    s_add_u32 m0, s26, 49152
    v_exp_f32 v171, v171
    v_mfma_f32_16x16x32_bf16 a[60:63], a[220:223], v[200:203], a[60:63]
    ds_read_b128 a[176:179], v4 offset:12288
    v_perm_b32 v245, v171, v170, s43
    v_smfmac_f32_16x16x64_bf16 v[32:35], v[24:27], v[200:207], v22
    buffer_load_dwordx4 v20, s[12:15], s24 offen offset:0 nt lds
    v_mfma_f32_16x16x32_bf16 a[64:67], a[192:195], v[208:211], a[64:67]
    v_exp_f32 v172, v172
    v_mfma_f32_16x16x32_bf16 a[64:67], a[224:227], v[212:215], a[64:67]
    ds_read_b128 a[180:183], v5 offset:12288
    v_mfma_f32_16x16x32_bf16 a[68:71], a[228:231], v[212:215], a[68:71]
    v_exp_f32 v173, v173
    v_mfma_f32_16x16x32_bf16 a[68:71], a[196:199], v[208:211], a[68:71]
    ds_read_b128 a[184:187], v6 offset:12288
    v_perm_b32 v246, v173, v172, s43
    v_mfma_f32_16x16x32_bf16 a[72:75], a[200:203], v[208:211], a[72:75]
    v_exp_f32 v174, v174
    v_mfma_f32_16x16x32_bf16 a[72:75], a[232:235], v[212:215], a[72:75]
    buffer_load_dwordx4 v21, s[12:15], s24 offen offset:1024 nt lds
    v_mfma_f32_16x16x32_bf16 a[76:79], a[236:239], v[212:215], a[76:79]
    v_exp_f32 v175, v175
    v_mfma_f32_16x16x32_bf16 a[76:79], a[204:207], v[208:211], a[76:79]
    ds_read_b128 a[188:191], v7 offset:12288
    v_perm_b32 v247, v175, v174, s43
    v_mfma_f32_16x16x32_bf16 a[80:83], a[208:211], v[208:211], a[80:83]
    v_exp_f32 v176, v176
    v_mfma_f32_16x16x32_bf16 a[80:83], a[240:243], v[212:215], a[80:83]
    v_mfma_f32_16x16x32_bf16 a[84:87], a[244:247], v[212:215], a[84:87]
    v_exp_f32 v177, v177
    v_mfma_f32_16x16x32_bf16 a[84:87], a[212:215], v[208:211], a[84:87]
    v_perm_b32 v248, v177, v176, s43
    v_mfma_f32_16x16x32_bf16 a[88:91], a[216:219], v[208:211], a[88:91]
    v_exp_f32 v178, v178
    v_mfma_f32_16x16x32_bf16 a[88:91], a[248:251], v[212:215], a[88:91]
    buffer_load_dwordx4 v1, s[12:15], s24 offen offset:2048 nt lds
    v_mfma_f32_16x16x32_bf16 a[92:95], a[252:255], v[212:215], a[92:95]
    v_exp_f32 v179, v179
    v_mfma_f32_16x16x32_bf16 a[92:95], a[220:223], v[208:211], a[92:95]
    v_perm_b32 v249, v179, v178, s43
    v_smfmac_f32_16x16x64_bf16 v[36:39], v[24:27], v[208:215], v22
    v_mfma_f32_16x16x32_bf16 a[96:99], a[192:195], v[216:219], a[96:99]
    v_exp_f32 v180, v180
    v_mfma_f32_16x16x32_bf16 a[96:99], a[224:227], v[220:223], a[96:99]
    buffer_load_dwordx4 v2, s[12:15], s24 offen offset:3072 nt lds
    v_mfma_f32_16x16x32_bf16 a[100:103], a[228:231], v[220:223], a[100:103]
    s_add_u32 s23, s23, s34
    v_exp_f32 v181, v181
    v_mfma_f32_16x16x32_bf16 a[100:103], a[196:199], v[216:219], a[100:103]
    v_perm_b32 v250, v181, v180, s43
    v_mfma_f32_16x16x32_bf16 a[104:107], a[200:203], v[216:219], a[104:107]
    s_add_u32 s24, s24, s35
    v_exp_f32 v182, v182
    v_mfma_f32_16x16x32_bf16 a[104:107], a[232:235], v[220:223], a[104:107]
    ds_read_b64_tr_b16 a[192:193], v8 offset:0
    v_mfma_f32_16x16x32_bf16 a[108:111], a[236:239], v[220:223], a[108:111]
    s_bitset0_b32 s23, 19
    v_exp_f32 v183, v183
    v_mfma_f32_16x16x32_bf16 a[108:111], a[204:207], v[216:219], a[108:111]
    ds_read_b64_tr_b16 a[194:195], v8 offset:4096
    v_perm_b32 v251, v183, v182, s43
    v_mfma_f32_16x16x32_bf16 a[112:115], a[208:211], v[216:219], a[112:115]
    s_bitset0_b32 s24, 19
    v_exp_f32 v184, v184
    v_mfma_f32_16x16x32_bf16 a[112:115], a[240:243], v[220:223], a[112:115]
    ds_read_b64_tr_b16 a[224:225], v8 offset:8192
    v_mfma_f32_16x16x32_bf16 a[116:119], a[244:247], v[220:223], a[116:119]
    s_cmp_eq_u32 s27, 6
    v_exp_f32 v185, v185
    v_mfma_f32_16x16x32_bf16 a[116:119], a[212:215], v[216:219], a[116:119]
    ds_read_b64_tr_b16 a[226:227], v8 offset:12288
    v_perm_b32 v252, v185, v184, s43
    v_mfma_f32_16x16x32_bf16 a[120:123], a[216:219], v[216:219], a[120:123]
    v_exp_f32 v186, v186
    v_mfma_f32_16x16x32_bf16 a[120:123], a[248:251], v[220:223], a[120:123]
    ds_read_b64_tr_b16 a[196:197], v9 offset:0
    v_mfma_f32_16x16x32_bf16 a[124:127], a[252:255], v[220:223], a[124:127]
    v_exp_f32 v187, v187
    v_mfma_f32_16x16x32_bf16 a[124:127], a[220:223], v[216:219], a[124:127]
    ds_read_b64_tr_b16 a[198:199], v9 offset:4096
    v_perm_b32 v253, v187, v186, s43
    v_smfmac_f32_16x16x64_bf16 v[40:43], v[24:27], v[216:223], v22
    s_waitcnt lgkmcnt(6)
    s_cbranch_scc1 L_hook27
L_ret3:
    v_mfma_f32_16x16x32_bf16 v[128:131], a[128:131], v[64:67], v[44:47]
    v_exp_f32 v188, v188
    v_mfma_f32_16x16x32_bf16 v[128:131], a[132:135], v[68:71], v[128:131]
    ds_read_b64_tr_b16 a[228:229], v9 offset:8192
    v_mfma_f32_16x16x32_bf16 v[128:131], a[136:139], v[72:75], v[128:131]
    v_exp_f32 v189, v189
    v_mfma_f32_16x16x32_bf16 v[128:131], a[140:143], v[76:79], v[128:131]
    ds_read_b64_tr_b16 a[230:231], v9 offset:12288
    v_perm_b32 v254, v189, v188, s43
    v_mfma_f32_16x16x32_bf16 v[132:135], a[156:159], v[76:79], v[44:47]
    v_exp_f32 v190, v190
    v_mfma_f32_16x16x32_bf16 v[132:135], a[152:155], v[72:75], v[132:135]
    ds_read_b64_tr_b16 a[200:201], v10 offset:0
    v_mfma_f32_16x16x32_bf16 v[132:135], a[148:151], v[68:71], v[132:135]
    v_exp_f32 v191, v191
    v_mfma_f32_16x16x32_bf16 v[132:135], a[144:147], v[64:67], v[132:135]
    ds_read_b64_tr_b16 a[202:203], v10 offset:4096
    v_perm_b32 v255, v191, v190, s43
    v_mfma_f32_16x16x32_bf16 v[136:139], a[160:163], v[64:67], v[44:47]
    v_exp_f32 v128, v128
    v_mfma_f32_16x16x32_bf16 v[136:139], a[164:167], v[68:71], v[136:139]
    ds_read_b64_tr_b16 a[232:233], v10 offset:8192
    v_mfma_f32_16x16x32_bf16 v[136:139], a[168:171], v[72:75], v[136:139]
    v_exp_f32 v129, v129
    v_mfma_f32_16x16x32_bf16 v[136:139], a[172:175], v[76:79], v[136:139]
    ds_read_b64_tr_b16 a[234:235], v10 offset:12288
    v_perm_b32 v192, v129, v128, s43
    v_mfma_f32_16x16x32_bf16 v[140:143], a[188:191], v[76:79], v[44:47]
    v_exp_f32 v130, v130
    v_mfma_f32_16x16x32_bf16 v[140:143], a[184:187], v[72:75], v[140:143]
    ds_read_b64_tr_b16 a[204:205], v11 offset:0
    v_mfma_f32_16x16x32_bf16 v[140:143], a[180:183], v[68:71], v[140:143]
    v_exp_f32 v131, v131
    v_mfma_f32_16x16x32_bf16 v[140:143], a[176:179], v[64:67], v[140:143]
    ds_read_b64_tr_b16 a[206:207], v11 offset:4096
    v_perm_b32 v193, v131, v130, s43
    v_mfma_f32_16x16x32_bf16 v[144:147], a[128:131], v[80:83], v[48:51]
    v_exp_f32 v132, v132
    v_mfma_f32_16x16x32_bf16 v[144:147], a[132:135], v[84:87], v[144:147]
    ds_read_b64_tr_b16 a[236:237], v11 offset:8192
    v_mfma_f32_16x16x32_bf16 v[144:147], a[136:139], v[88:91], v[144:147]
    v_exp_f32 v133, v133
    v_mfma_f32_16x16x32_bf16 v[144:147], a[140:143], v[92:95], v[144:147]
    ds_read_b64_tr_b16 a[238:239], v11 offset:12288
    v_perm_b32 v194, v133, v132, s43
    v_mfma_f32_16x16x32_bf16 v[148:151], a[156:159], v[92:95], v[48:51]
    v_exp_f32 v134, v134
    v_mfma_f32_16x16x32_bf16 v[148:151], a[152:155], v[88:91], v[148:151]
    ds_read_b64_tr_b16 a[208:209], v12 offset:0
    v_mfma_f32_16x16x32_bf16 v[148:151], a[148:151], v[84:87], v[148:151]
    v_exp_f32 v135, v135
    v_mfma_f32_16x16x32_bf16 v[148:151], a[144:147], v[80:83], v[148:151]
    ds_read_b64_tr_b16 a[210:211], v12 offset:4096
    v_perm_b32 v195, v135, v134, s43
    v_mfma_f32_16x16x32_bf16 v[152:155], a[160:163], v[80:83], v[48:51]
    v_exp_f32 v136, v136
    v_mfma_f32_16x16x32_bf16 v[152:155], a[164:167], v[84:87], v[152:155]
    ds_read_b64_tr_b16 a[240:241], v12 offset:8192
    v_mfma_f32_16x16x32_bf16 v[152:155], a[168:171], v[88:91], v[152:155]
    v_exp_f32 v137, v137
    v_mfma_f32_16x16x32_bf16 v[152:155], a[172:175], v[92:95], v[152:155]
    ds_read_b64_tr_b16 a[242:243], v12 offset:12288
    v_perm_b32 v196, v137, v136, s43
    v_mfma_f32_16x16x32_bf16 v[156:159], a[188:191], v[92:95], v[48:51]
    v_exp_f32 v138, v138
    v_mfma_f32_16x16x32_bf16 v[156:159], a[184:187], v[88:91], v[156:159]
    ds_read_b64_tr_b16 a[212:213], v13 offset:0
    v_mfma_f32_16x16x32_bf16 v[156:159], a[180:183], v[84:87], v[156:159]
    v_exp_f32 v139, v139
    v_mfma_f32_16x16x32_bf16 v[156:159], a[176:179], v[80:83], v[156:159]
    ds_read_b64_tr_b16 a[214:215], v13 offset:4096
    v_perm_b32 v197, v139, v138, s43
    v_mfma_f32_16x16x32_bf16 v[160:163], a[128:131], v[96:99], v[52:55]
    v_exp_f32 v140, v140
    v_mfma_f32_16x16x32_bf16 v[160:163], a[132:135], v[100:103], v[160:163]
    ds_read_b64_tr_b16 a[244:245], v13 offset:8192
    v_mfma_f32_16x16x32_bf16 v[160:163], a[136:139], v[104:107], v[160:163]
    v_exp_f32 v141, v141
    v_mfma_f32_16x16x32_bf16 v[160:163], a[140:143], v[108:111], v[160:163]
    ds_read_b64_tr_b16 a[246:247], v13 offset:12288
    v_perm_b32 v198, v141, v140, s43
    v_mfma_f32_16x16x32_bf16 v[164:167], a[156:159], v[108:111], v[52:55]
    v_exp_f32 v142, v142
    v_mfma_f32_16x16x32_bf16 v[164:167], a[152:155], v[104:107], v[164:167]
    ds_read_b64_tr_b16 a[216:217], v14 offset:0
    v_mfma_f32_16x16x32_bf16 v[164:167], a[148:151], v[100:103], v[164:167]
    v_exp_f32 v143, v143
    v_mfma_f32_16x16x32_bf16 v[164:167], a[144:147], v[96:99], v[164:167]
    ds_read_b64_tr_b16 a[218:219], v14 offset:4096
    v_perm_b32 v199, v143, v142, s43
    v_mfma_f32_16x16x32_bf16 v[168:171], a[160:163], v[96:99], v[52:55]
    v_exp_f32 v144, v144
    v_mfma_f32_16x16x32_bf16 v[168:171], a[164:167], v[100:103], v[168:171]
    ds_read_b64_tr_b16 a[248:249], v14 offset:8192
    v_mfma_f32_16x16x32_bf16 v[168:171], a[168:171], v[104:107], v[168:171]
    v_exp_f32 v145, v145
    v_mfma_f32_16x16x32_bf16 v[168:171], a[172:175], v[108:111], v[168:171]
    ds_read_b64_tr_b16 a[250:251], v14 offset:12288
    v_perm_b32 v200, v145, v144, s43
    v_mfma_f32_16x16x32_bf16 v[172:175], a[188:191], v[108:111], v[52:55]
    v_exp_f32 v146, v146
    v_mfma_f32_16x16x32_bf16 v[172:175], a[184:187], v[104:107], v[172:175]
    ds_read_b64_tr_b16 a[220:221], v15 offset:0
    v_mfma_f32_16x16x32_bf16 v[172:175], a[180:183], v[100:103], v[172:175]
    v_exp_f32 v147, v147
    v_mfma_f32_16x16x32_bf16 v[172:175], a[176:179], v[96:99], v[172:175]
    ds_read_b64_tr_b16 a[222:223], v15 offset:4096
    v_perm_b32 v201, v147, v146, s43
    v_mfma_f32_16x16x32_bf16 v[176:179], a[128:131], v[112:115], v[56:59]
    v_exp_f32 v148, v148
    v_mfma_f32_16x16x32_bf16 v[176:179], a[132:135], v[116:119], v[176:179]
    ds_read_b64_tr_b16 a[252:253], v15 offset:8192
    v_mfma_f32_16x16x32_bf16 v[176:179], a[136:139], v[120:123], v[176:179]
    v_exp_f32 v149, v149
    v_mfma_f32_16x16x32_bf16 v[176:179], a[140:143], v[124:127], v[176:179]
    ds_read_b64_tr_b16 a[254:255], v15 offset:12288
    v_perm_b32 v202, v149, v148, s43
    v_mfma_f32_16x16x32_bf16 v[180:183], a[156:159], v[124:127], v[56:59]
    v_exp_f32 v150, v150
    v_mfma_f32_16x16x32_bf16 v[180:183], a[152:155], v[120:123], v[180:183]
    v_mfma_f32_16x16x32_bf16 v[180:183], a[148:151], v[116:119], v[180:183]
    v_exp_f32 v151, v151
    v_mfma_f32_16x16x32_bf16 v[180:183], a[144:147], v[112:115], v[180:183]
    v_perm_b32 v203, v151, v150, s43
    v_mfma_f32_16x16x32_bf16 v[184:187], a[160:163], v[112:115], v[56:59]
    v_exp_f32 v152, v152
    v_mfma_f32_16x16x32_bf16 v[184:187], a[164:167], v[116:119], v[184:187]
    v_mfma_f32_16x16x32_bf16 v[184:187], a[168:171], v[120:123], v[184:187]
    v_exp_f32 v153, v153
    v_mfma_f32_16x16x32_bf16 v[184:187], a[172:175], v[124:127], v[184:187]
    v_perm_b32 v204, v153, v152, s43
    v_mfma_f32_16x16x32_bf16 v[188:191], a[188:191], v[124:127], v[56:59]
    v_exp_f32 v154, v154
    v_mfma_f32_16x16x32_bf16 v[188:191], a[184:187], v[120:123], v[188:191]
    s_waitcnt vmcnt(16) lgkmcnt(0)
    v_mfma_f32_16x16x32_bf16 v[188:191], a[180:183], v[116:119], v[188:191]
    v_exp_f32 v155, v155
    v_mfma_f32_16x16x32_bf16 v[188:191], a[176:179], v[112:115], v[188:191]
    s_barrier
    v_mfma_f32_16x16x32_bf16 a[0:3], a[192:195], v[224:227], a[0:3]
    v_exp_f32 v156, v156
    v_mfma_f32_16x16x32_bf16 a[0:3], a[224:227], v[228:231], a[0:3]
    ds_read_b128 a[128:131], v4 offset:16384
    v_perm_b32 v205, v155, v154, s43
    v_mfma_f32_16x16x32_bf16 a[4:7], a[228:231], v[228:231], a[4:7]
    v_exp_f32 v157, v157
    v_mfma_f32_16x16x32_bf16 a[4:7], a[196:199], v[224:227], a[4:7]
    ds_read_b128 a[132:135], v5 offset:16384
    v_perm_b32 v206, v157, v156, s43
    v_mfma_f32_16x16x32_bf16 a[8:11], a[200:203], v[224:227], a[8:11]
    v_exp_f32 v158, v158
    v_mfma_f32_16x16x32_bf16 a[8:11], a[232:235], v[228:231], a[8:11]
    ds_read_b128 a[136:139], v6 offset:16384
    v_mfma_f32_16x16x32_bf16 a[12:15], a[236:239], v[228:231], a[12:15]
    v_exp_f32 v159, v159
    v_mfma_f32_16x16x32_bf16 a[12:15], a[204:207], v[224:227], a[12:15]
    ds_read_b128 a[140:143], v7 offset:16384
    v_perm_b32 v207, v159, v158, s43
    v_mfma_f32_16x16x32_bf16 a[16:19], a[208:211], v[224:227], a[16:19]
    s_add_u32 m0, s25, 0
    v_exp_f32 v160, v160
    v_mfma_f32_16x16x32_bf16 a[16:19], a[240:243], v[228:231], a[16:19]
    buffer_load_dwordx4 v16, s[8:11], s23 offen offset:0 nt lds
    v_mfma_f32_16x16x32_bf16 a[20:23], a[244:247], v[228:231], a[20:23]
    v_exp_f32 v161, v161
    v_mfma_f32_16x16x32_bf16 a[20:23], a[212:215], v[224:227], a[20:23]
    ds_read_b128 a[144:147], v4 offset:20480
    v_perm_b32 v208, v161, v160, s43
    v_mfma_f32_16x16x32_bf16 a[24:27], a[216:219], v[224:227], a[24:27]
    v_exp_f32 v162, v162
    v_mfma_f32_16x16x32_bf16 a[24:27], a[248:251], v[228:231], a[24:27]
    buffer_load_dwordx4 v17, s[8:11], s23 offen offset:1024 nt lds
    v_mfma_f32_16x16x32_bf16 a[28:31], a[252:255], v[228:231], a[28:31]
    v_exp_f32 v163, v163
    v_mfma_f32_16x16x32_bf16 a[28:31], a[220:223], v[224:227], a[28:31]
    ds_read_b128 a[148:151], v5 offset:20480
    v_perm_b32 v209, v163, v162, s43
    v_smfmac_f32_16x16x64_bf16 v[28:31], v[24:27], v[224:231], v22
    ds_read_b128 a[152:155], v6 offset:20480
    v_mfma_f32_16x16x32_bf16 a[32:35], a[192:195], v[232:235], a[32:35]
    v_exp_f32 v164, v164
    v_mfma_f32_16x16x32_bf16 a[32:35], a[224:227], v[236:239], a[32:35]
    buffer_load_dwordx4 v18, s[8:11], s23 offen offset:2048 nt lds
    v_mfma_f32_16x16x32_bf16 a[36:39], a[228:231], v[236:239], a[36:39]
    v_exp_f32 v165, v165
    v_mfma_f32_16x16x32_bf16 a[36:39], a[196:199], v[232:235], a[36:39]
    ds_read_b128 a[156:159], v7 offset:20480
    v_perm_b32 v210, v165, v164, s43
    v_mfma_f32_16x16x32_bf16 a[40:43], a[200:203], v[232:235], a[40:43]
    v_exp_f32 v166, v166
    v_mfma_f32_16x16x32_bf16 a[40:43], a[232:235], v[236:239], a[40:43]
    ds_read_b128 a[160:163], v4 offset:24576
    v_mfma_f32_16x16x32_bf16 a[44:47], a[236:239], v[236:239], a[44:47]
    v_exp_f32 v167, v167
    v_mfma_f32_16x16x32_bf16 a[44:47], a[204:207], v[232:235], a[44:47]
    ds_read_b128 a[164:167], v5 offset:24576
    v_perm_b32 v211, v167, v166, s43
    v_mfma_f32_16x16x32_bf16 a[48:51], a[208:211], v[232:235], a[48:51]
    v_exp_f32 v168, v168
    v_mfma_f32_16x16x32_bf16 a[48:51], a[240:243], v[236:239], a[48:51]
    buffer_load_dwordx4 v19, s[8:11], s23 offen offset:3072 nt lds
    v_mfma_f32_16x16x32_bf16 a[52:55], a[244:247], v[236:239], a[52:55]
    v_exp_f32 v169, v169
    v_mfma_f32_16x16x32_bf16 a[52:55], a[212:215], v[232:235], a[52:55]
    ds_read_b128 a[168:171], v6 offset:24576
    v_perm_b32 v212, v169, v168, s43
    v_mfma_f32_16x16x32_bf16 a[56:59], a[216:219], v[232:235], a[56:59]
    v_exp_f32 v170, v170
    v_mfma_f32_16x16x32_bf16 a[56:59], a[248:251], v[236:239], a[56:59]
    ds_read_b128 a[172:175], v7 offset:24576
    v_mfma_f32_16x16x32_bf16 a[60:63], a[252:255], v[236:239], a[60:63]
    s_add_u32 m0, s26, 0
    v_exp_f32 v171, v171
    v_mfma_f32_16x16x32_bf16 a[60:63], a[220:223], v[232:235], a[60:63]
    ds_read_b128 a[176:179], v4 offset:28672
    v_perm_b32 v213, v171, v170, s43
    v_smfmac_f32_16x16x64_bf16 v[32:35], v[24:27], v[232:239], v22
    buffer_load_dwordx4 v20, s[12:15], s24 offen offset:0 nt lds
    v_mfma_f32_16x16x32_bf16 a[64:67], a[192:195], v[240:243], a[64:67]
    v_exp_f32 v172, v172
    v_mfma_f32_16x16x32_bf16 a[64:67], a[224:227], v[244:247], a[64:67]
    ds_read_b128 a[180:183], v5 offset:28672
    v_mfma_f32_16x16x32_bf16 a[68:71], a[228:231], v[244:247], a[68:71]
    v_exp_f32 v173, v173
    v_mfma_f32_16x16x32_bf16 a[68:71], a[196:199], v[240:243], a[68:71]
    ds_read_b128 a[184:187], v6 offset:28672
    v_perm_b32 v214, v173, v172, s43
    v_mfma_f32_16x16x32_bf16 a[72:75], a[200:203], v[240:243], a[72:75]
    v_exp_f32 v174, v174
    v_mfma_f32_16x16x32_bf16 a[72:75], a[232:235], v[244:247], a[72:75]
    buffer_load_dwordx4 v21, s[12:15], s24 offen offset:1024 nt lds
    v_mfma_f32_16x16x32_bf16 a[76:79], a[236:239], v[244:247], a[76:79]
    v_exp_f32 v175, v175
    v_mfma_f32_16x16x32_bf16 a[76:79], a[204:207], v[240:243], a[76:79]
    ds_read_b128 a[188:191], v7 offset:28672
    v_perm_b32 v215, v175, v174, s43
    v_mfma_f32_16x16x32_bf16 a[80:83], a[208:211], v[240:243], a[80:83]
    v_exp_f32 v176, v176
    v_mfma_f32_16x16x32_bf16 a[80:83], a[240:243], v[244:247], a[80:83]
    v_mfma_f32_16x16x32_bf16 a[84:87], a[244:247], v[244:247], a[84:87]
    v_exp_f32 v177, v177
    v_mfma_f32_16x16x32_bf16 a[84:87], a[212:215], v[240:243], a[84:87]
    v_perm_b32 v216, v177, v176, s43
    v_mfma_f32_16x16x32_bf16 a[88:91], a[216:219], v[240:243], a[88:91]
    v_exp_f32 v178, v178
    v_mfma_f32_16x16x32_bf16 a[88:91], a[248:251], v[244:247], a[88:91]
    buffer_load_dwordx4 v1, s[12:15], s24 offen offset:2048 nt lds
    v_mfma_f32_16x16x32_bf16 a[92:95], a[252:255], v[244:247], a[92:95]
    v_exp_f32 v179, v179
    v_mfma_f32_16x16x32_bf16 a[92:95], a[220:223], v[240:243], a[92:95]
    v_perm_b32 v217, v179, v178, s43
    v_smfmac_f32_16x16x64_bf16 v[36:39], v[24:27], v[240:247], v22
    v_mfma_f32_16x16x32_bf16 a[96:99], a[192:195], v[248:251], a[96:99]
    v_exp_f32 v180, v180
    v_mfma_f32_16x16x32_bf16 a[96:99], a[224:227], v[252:255], a[96:99]
    buffer_load_dwordx4 v2, s[12:15], s24 offen offset:3072 nt lds
    v_mfma_f32_16x16x32_bf16 a[100:103], a[228:231], v[252:255], a[100:103]
    s_add_u32 s23, s23, s34
    v_exp_f32 v181, v181
    v_mfma_f32_16x16x32_bf16 a[100:103], a[196:199], v[248:251], a[100:103]
    v_perm_b32 v218, v181, v180, s43
    v_mfma_f32_16x16x32_bf16 a[104:107], a[200:203], v[248:251], a[104:107]
    s_add_u32 s24, s24, s35
    v_exp_f32 v182, v182
    v_mfma_f32_16x16x32_bf16 a[104:107], a[232:235], v[252:255], a[104:107]
    ds_read_b64_tr_b16 a[192:193], v8 offset:16384
    v_mfma_f32_16x16x32_bf16 a[108:111], a[236:239], v[252:255], a[108:111]
    s_bitset0_b32 s23, 19
    v_exp_f32 v183, v183
    v_mfma_f32_16x16x32_bf16 a[108:111], a[204:207], v[248:251], a[108:111]
    ds_read_b64_tr_b16 a[194:195], v8 offset:20480
    v_perm_b32 v219, v183, v182, s43
    v_mfma_f32_16x16x32_bf16 a[112:115], a[208:211], v[248:251], a[112:115]
    s_bitset0_b32 s24, 19
    v_exp_f32 v184, v184
    v_mfma_f32_16x16x32_bf16 a[112:115], a[240:243], v[252:255], a[112:115]
    ds_read_b64_tr_b16 a[224:225], v8 offset:24576
    v_mfma_f32_16x16x32_bf16 a[116:119], a[244:247], v[252:255], a[116:119]
    s_add_u32 s27, s27, 1
    v_exp_f32 v185, v185
    v_mfma_f32_16x16x32_bf16 a[116:119], a[212:215], v[248:251], a[116:119]
    ds_read_b64_tr_b16 a[226:227], v8 offset:28672
    v_perm_b32 v220, v185, v184, s43
    v_mfma_f32_16x16x32_bf16 a[120:123], a[216:219], v[248:251], a[120:123]
    s_bitcmp1_b32 s63, s27
    v_exp_f32 v186, v186
    v_mfma_f32_16x16x32_bf16 a[120:123], a[248:251], v[252:255], a[120:123]
    ds_read_b64_tr_b16 a[196:197], v9 offset:16384
    v_mfma_f32_16x16x32_bf16 a[124:127], a[252:255], v[252:255], a[124:127]
    v_exp_f32 v187, v187
    v_mfma_f32_16x16x32_bf16 a[124:127], a[220:223], v[248:251], a[124:127]
    ds_read_b64_tr_b16 a[198:199], v9 offset:20480
    v_perm_b32 v221, v187, v186, s43
    v_smfmac_f32_16x16x64_bf16 v[40:43], v[24:27], v[248:255], v22
    s_waitcnt lgkmcnt(6)
    s_cbranch_scc0 L_loop
L_disp4:
    s_cmp_eq_u32 s27, 1
    s_cbranch_scc1 L_hook4
    s_cmp_eq_u32 s27, 2
    s_cbranch_scc1 L_hook8
    s_cmp_eq_u32 s27, 3
    s_cbranch_scc1 L_hook12
    s_cmp_eq_u32 s27, 4
    s_cbranch_scc1 L_hook16
    s_cmp_eq_u32 s27, 6
    s_cbranch_scc1 L_hook24
    s_branch L_hook28
L_disp2:
    s_cmp_eq_u32 s27, 2
    s_cbranch_scc1 L_hook10
    s_cmp_eq_u32 s27, 3
    s_cbranch_scc1 L_hook14
    s_cmp_eq_u32 s27, 4
    s_cbranch_scc1 L_hook18
    s_cmp_eq_u32 s27, 5
    s_cbranch_scc1 L_hook22
L_hook2:
    s_add_u32 m0, s25, 0x20000
    s_add_u32 s3, s25, 16793600
    buffer_load_dwordx4 v3, s[16:19], s3 offen offset:0 sc1 lds
    buffer_load_dwordx4 v3, s[16:19], s3 offen offset:1024 sc1 lds
    buffer_load_dwordx4 v3, s[16:19], s3 offen offset:2048 sc1 lds
    buffer_load_dwordx4 v3, s[16:19], s3 offen offset:3072 sc1 lds
    s_branch L_ret2
L_hook4:
    v_add_u32 v229, 0x20000, v3
    s_waitcnt vmcnt(16)
    s_barrier
    ds_read_b128 v[128:131], v229 offset:0
    ds_read_b128 v[132:135], v229 offset:1024
    ds_read_b128 v[136:139], v229 offset:2048
    ds_read_b128 v[140:143], v229 offset:3072
    ds_read_b128 v[144:147], v229 offset:4096
    ds_read_b128 v[148:151], v229 offset:5120
    ds_read_b128 v[152:155], v229 offset:6144
    ds_read_b128 v[156:159], v229 offset:7168
    ds_read_b128 v[160:163], v229 offset:8192
    ds_read_b128 v[164:167], v229 offset:9216
    ds_read_b128 v[168:171], v229 offset:10240
    ds_read_b128 v[172:175], v229 offset:11264
    ds_read_b128 v[176:179], v229 offset:12288
    ds_read_b128 v[180:183], v229 offset:13312
    ds_read_b128 v[184:187], v229 offset:14336
    ds_read_b128 v[224:227], v229 offset:15360
    s_and_b32 s3, s2, 6
    s_lshl_b32 s3, s3, 1
    s_bfe_u32 s67, s2, 0x20003
    s_add_u32 s3, s3, s67
    s_lshl_b32 s3, s3, 2
    s_add_u32 s3, s3, s20
    s_lshl_b32 s3, s3, 8
    v_bfe_u32 v232, v0, 1, 4
    v_and_b32 v233, 1, v0
    v_lshlrev_b32 v233, 2, v233
    v_lshl_add_u32 v232, v232, 4, v233
    v_add_u32 v232, s3, v232
    v_add_u32 v233, 0x20000, v232
    ds_read_b32 v234, v233
    s_waitcnt lgkmcnt(0)
    v_mov_b32 v228, 0
    v_bitop3_b32 v228, v228, v130, s46 bitop3:0xf6
    v_bitop3_b32 v228, v228, v134, s46 bitop3:0xf6
    v_bitop3_b32 v228, v228, v138, s46 bitop3:0xf6
    v_bitop3_b32 v228, v228, v142, s46 bitop3:0xf6
    v_bitop3_b32 v228, v228, v146, s46 bitop3:0xf6
    v_bitop3_b32 v228, v228, v150, s46 bitop3:0xf6
    v_bitop3_b32 v228, v228, v154, s46 bitop3:0xf6
    v_bitop3_b32 v228, v228, v158, s46 bitop3:0xf6
    v_bitop3_b32 v228, v228, v162, s46 bitop3:0xf6
    v_bitop3_b32 v228, v228, v166, s46 bitop3:0xf6
    v_bitop3_b32 v228, v228, v170, s46 bitop3:0xf6
    v_bitop3_b32 v228, v228, v174, s46 bitop3:0xf6
    v_bitop3_b32 v228, v228, v178, s46 bitop3:0xf6
    v_bitop3_b32 v228, v228, v182, s46 bitop3:0xf6
    v_bitop3_b32 v228, v228, v186, s46 bitop3:0xf6
    v_bitop3_b32 v228, v228, v226, s46 bitop3:0xf6
    v_cmp_ne_u32 vcc, 0, v228
    s_cbranch_vccnz L_key_retry
L_key_ok:
    v_mov_b32 v235, v234
    v_max_u32 v228, v128, v129
    v_max3_u32 v228, v228, v132, v133
    v_max3_u32 v228, v228, v136, v137
    v_max_u32_dpp v235, v235, v235 quad_perm:[1,0,3,2] row_mask:0xf bank_mask:0xf
    v_max3_u32 v228, v228, v140, v141
    v_max3_u32 v228, v228, v144, v145
    v_max_u32_dpp v235, v235, v235 quad_perm:[2,3,0,1] row_mask:0xf bank_mask:0xf
    v_max3_u32 v228, v228, v148, v149
    v_max3_u32 v228, v228, v152, v153
    v_max_u32_dpp v235, v235, v235 row_half_mirror row_mask:0xf bank_mask:0xf
    v_max3_u32 v228, v228, v156, v157
    v_max3_u32 v228, v228, v160, v161
    v_max_u32_dpp v235, v235, v235 row_mirror row_mask:0xf bank_mask:0xf
    v_max3_u32 v228, v228, v164, v165
    v_max3_u32 v228, v228, v168, v169
    v_max3_u32 v228, v228, v172, v173
    v_max3_u32 v228, v228, v176, v177
    v_max3_u32 v228, v228, v180, v181
    v_max3_u32 v228, v228, v184, v185
    v_max3_u32 v228, v228, v224, v225
    v_readlane_b32 s3, v235, 0
    v_readlane_b32 s67, v235, 16
    s_max_u32 s64, s3, s67
    v_cmp_lt_u32 vcc, s64, v228
    s_bcnt1_i32_b64 s3, vcc
    s_cmp_lt_u32 s3, 8
    s_cbranch_scc1 L_rank
L_rank_done:
    s_branch L_loop
L_hook8:
    v_and_b32 v128, 7, v0
    v_lshlrev_b32 v128, 3, v128
    v_add_u32 v128, 16809984, v128
    buffer_load_dwordx2 v[60:61], v128, s[16:19], 0 offen sc1
    s_cmp_eq_u32 s69, -1
    s_cbranch_scc1 L_wp0
    s_mul_i32 s3, s20, 458752
    s_lshl_b32 s67, s69, 5
    s_add_u32 s3, s3, s67
    v_lshrrev_b32 v184, 1, v0
    v_and_b32 v185, 8, v184
    v_xor_b32 v185, v185, v0
    v_lshrrev_b32 v184, 1, v185
    v_mul_u32_u24 v184, 3584, v184
    v_and_b32 v185, 16, v3
    v_add3_u32 v184, v184, v185, s3
    s_add_u32 m0, s25, 147456
    s_nop 0
    global_load_lds_dwordx4 v184, s[50:51]
    s_add_u32 m0, s25, 148480
    v_add_u32 v184, 114688, v184
    global_load_lds_dwordx4 v184, s[50:51]
    s_add_u32 m0, s25, 149504
    v_add_u32 v184, 114688, v184
    global_load_lds_dwordx4 v184, s[50:51]
    s_add_u32 m0, s25, 150528
    v_add_u32 v184, 114688, v184
    global_load_lds_dwordx4 v184, s[50:51]
L_wp0:
    s_branch L_loop
L_hook10:
    s_waitcnt vmcnt(16)
    v_cmp_ne_u32 vcc, s46, v61
    s_cbranch_vccnz L_sel_retry
L_sel_ok:
    v_and_b32 v128, 0xffff, v60
    v_and_b32 v129, 48, v0
    v_bfe_u32 v130, v0, 3, 1
    v_lshl_add_u32 v129, v130, 6, v129
    v_lshl_add_u32 v128, v128, 10, v129
    s_lshl_b32 s3, s20, 8
    s_add_u32 s3, s3, 18874368
    s_lshr_b32 s68, s25, 1
    s_add_u32 m0, s68, 0x20000
    s_add_u32 s67, s3, 128
    buffer_load_dwordx4 v128, s[16:19], s3 offen sc1 lds
    s_add_u32 m0, s68, 0x20400
    s_nop 0
    buffer_load_dwordx4 v128, s[16:19], s67 offen sc1 lds
    s_branch L_ret2
L_hook12:
    v_and_b32 v224, 48, v0
    v_and_b32 v225, 15, v0
    v_lshlrev_b32 v225, 3, v225
    v_lshl_add_u32 v224, v224, 4, v225
    v_and_b32 v225, 16, v0
    v_lshl_add_u32 v224, v225, 3, v224
    s_add_u32 s3, s25, 0x24000
    v_add_u32 v224, s3, v224
    v_xor_b32 v225, 128, v224
    s_lshr_b32 s68, s25, 1
    v_and_b32 v226, 0x370, v3
    s_add_u32 s3, s68, 0x20000
    v_add_u32 v226, s3, v226
    s_waitcnt vmcnt(16)
    ds_read_b64_tr_b16 v[128:129], v224 offset:0
    ds_read_b64_tr_b16 v[130:131], v225 offset:0
    ds_read_b128 v[144:147], v226 offset:0
    ds_read_b64_tr_b16 v[132:133], v224 offset:1024
    ds_read_b64_tr_b16 v[134:135], v225 offset:1024
    ds_read_b128 v[148:151], v226 offset:128
    ds_read_b64_tr_b16 v[136:137], v224 offset:2048
    ds_read_b64_tr_b16 v[138:139], v225 offset:2048
    ds_read_b128 v[152:155], v226 offset:1024
    ds_read_b64_tr_b16 v[140:141], v224 offset:3072
    ds_read_b64_tr_b16 v[142:143], v225 offset:3072
    ds_read_b128 v[156:159], v226 offset:1152
    s_lshr_b32 s68, s25, 2
    s_add_u32 s68, s68, 139264
    v_add_u32 v227, s68, v3
    s_mul_i32 s3, s20, 458752
    s_lshl_b32 s67, s69, 5
    s_add_u32 s3, s3, s67
    v_lshrrev_b32 v184, 1, v0
    v_and_b32 v185, 8, v184
    v_xor_b32 v185, v185, v0
    v_lshrrev_b32 v184, 1, v185
    v_mul_u32_u24 v184, 3584, v184
    v_and_b32 v185, 16, v3
    v_add3_u32 v184, v184, v185, s3
    s_waitcnt lgkmcnt(0)
    v_mfma_f32_16x16x32_bf16 v[160:163], v[128:131], v[144:147], 0
    v_mfma_f32_16x16x32_bf16 v[160:163], v[132:135], v[148:151], v[160:163]
    v_mfma_f32_16x16x32_bf16 v[160:163], v[136:139], v[152:155], v[160:163]
    v_mfma_f32_16x16x32_bf16 v[160:163], v[140:143], v[156:159], v[160:163]
    s_add_u32 m0, s25, 147456
    s_nop 0
    global_load_lds_dwordx4 v184, s[52:53]
    s_add_u32 m0, s25, 148480
    v_add_u32 v184, 114688, v184
    global_load_lds_dwordx4 v184, s[52:53]
    s_add_u32 m0, s25, 149504
    v_add_u32 v184, 114688, v184
    global_load_lds_dwordx4 v184, s[52:53]
    s_add_u32 m0, s25, 150528
    v_add_u32 v184, 114688, v184
    global_load_lds_dwordx4 v184, s[52:53]
    ds_write_b128 v227, v[160:163]
    s_branch L_loop
L_hook14:
    v_and_b32 v224, 48, v0
    v_and_b32 v225, 15, v0
    v_lshlrev_b32 v225, 3, v225
    v_lshl_add_u32 v224, v224, 4, v225
    v_and_b32 v225, 16, v0
    v_lshl_add_u32 v224, v225, 3, v224
    s_add_u32 s3, s25, 0x24000
    v_add_u32 v224, s3, v224
    v_xor_b32 v225, 128, v224
    s_lshr_b32 s68, s25, 1
    v_and_b32 v226, 0x370, v3
    s_add_u32 s3, s68, 0x20000
    v_add_u32 v226, s3, v226
    s_waitcnt vmcnt(16)
    ds_read_b64_tr_b16 v[128:129], v224 offset:0
    ds_read_b64_tr_b16 v[130:131], v225 offset:0
    ds_read_b128 v[144:147], v226 offset:0
    ds_read_b64_tr_b16 v[132:133], v224 offset:1024
    ds_read_b64_tr_b16 v[134:135], v225 offset:1024
    ds_read_b128 v[148:151], v226 offset:128
    ds_read_b64_tr_b16 v[136:137], v224 offset:2048
    ds_read_b64_tr_b16 v[138:139], v225 offset:2048
    ds_read_b128 v[152:155], v226 offset:1024
    ds_read_b64_tr_b16 v[140:141], v224 offset:3072
    ds_read_b64_tr_b16 v[142:143], v225 offset:3072
    ds_read_b128 v[156:159], v226 offset:1152
    s_lshr_b32 s68, s25, 2
    s_add_u32 s68, s68, 143360
    v_add_u32 v227, s68, v3
    s_lshl_b32 s3, s69, 14
    s_lshl_b32 s67, s20, 8
    s_add_u32 s3, s3, s67
    v_and_b32 v184, 0xff, v20
    v_and_b32 v185, 48, v0
    v_lshl_add_u32 v184, v185, 6, v184
    v_add_u32 v184, s3, v184
    v_xor_b32 v185, 128, v184
    v_add_u32 v185, 0x1000, v185
    s_waitcnt lgkmcnt(0)
    v_mfma_f32_16x16x32_bf16 v[160:163], v[128:131], v[144:147], 0
    v_mfma_f32_16x16x32_bf16 v[160:163], v[132:135], v[148:151], v[160:163]
    v_mfma_f32_16x16x32_bf16 v[160:163], v[136:139], v[152:155], v[160:163]
    v_mfma_f32_16x16x32_bf16 v[160:163], v[140:143], v[156:159], v[160:163]
    s_add_u32 m0, s25, 147456
    s_nop 0
    global_load_lds_dwordx4 v184, s[54:55]
    s_add_u32 m0, s25, 148480
    s_nop 0
    global_load_lds_dwordx4 v185, s[54:55]
    s_add_u32 m0, s25, 149504
    v_add_u32 v184, 0x2000, v184
    global_load_lds_dwordx4 v184, s[54:55]
    s_add_u32 m0, s25, 150528
    v_add_u32 v185, 0x2000, v185
    global_load_lds_dwordx4 v185, s[54:55]
    ds_write_b128 v227, v[160:163]
    s_branch L_ret2
L_hook16:
    v_add_u32 v224, 0x22000, v3
    s_add_u32 s3, s25, 81920
    ds_read_b128 v[128:131], v224 offset:0
    ds_read_b128 v[132:135], v224 offset:1024
    ds_read_b128 v[136:139], v224 offset:2048
    ds_read_b128 v[140:143], v224 offset:3072
    ds_read_b128 v[144:147], v224 offset:4096
    ds_read_b128 v[148:151], v224 offset:5120
    ds_read_b128 v[152:155], v224 offset:6144
    ds_read_b128 v[156:159], v224 offset:7168
    v_add_u32 v228, s3, v8
    v_add_u32 v229, s3, v9
    v_add_u32 v230, s3, v10
    v_add_u32 v231, s3, v11
    v_add_u32 v232, s3, v12
    v_add_u32 v233, s3, v13
    v_add_u32 v234, s3, v14
    v_add_u32 v235, s3, v15
    s_waitcnt vmcnt(16)
    ds_read_b64_tr_b16 v[164:165], v228
    ds_read_b64_tr_b16 v[166:167], v229
    ds_read_b64_tr_b16 v[168:169], v230
    ds_read_b64_tr_b16 v[170:171], v231
    ds_read_b64_tr_b16 v[172:173], v232
    ds_read_b64_tr_b16 v[174:175], v233
    ds_read_b64_tr_b16 v[176:177], v234
    ds_read_b64_tr_b16 v[178:179], v235
    v_and_b32 v225, 0x70, v3
    v_and_b32 v226, 48, v0
    v_lshl_add_u32 v225, v226, 3, v225
    v_and_b32 v226, 8, v0
    v_lshl_add_u32 v225, v226, 6, v225
    v_cmp_eq_u32 vcc, 0, v226
    s_lshl_b32 s3, s69, 14
    s_add_u32 s3, s3, s25
    s_add_u32 s3, s3, 20971520
    s_waitcnt lgkmcnt(8)
    v_add_f32 v128, v128, v132
    v_add_f32 v136, v136, v140
    v_add_f32 v129, v129, v133
    v_add_f32 v137, v137, v141
    v_add_f32 v130, v130, v134
    v_add_f32 v138, v138, v142
    v_add_f32 v131, v131, v135
    v_add_f32 v139, v139, v143
    v_add_f32 v128, v128, v136
    v_add_f32 v129, v129, v137
    v_add_f32 v130, v130, v138
    v_add_f32 v131, v131, v139
    v_cvt_pk_bf16_f32 v132, v128, v129
    v_cvt_pk_bf16_f32 v133, v130, v131
    v_lshlrev_b32 v128, 16, v132
    v_and_b32 v129, 0xffff0000, v132
    v_lshlrev_b32 v130, 16, v133
    v_and_b32 v131, 0xffff0000, v133
    v_add_f32 v144, v144, v148
    v_add_f32 v152, v152, v156
    v_add_f32 v145, v145, v149
    v_add_f32 v153, v153, v157
    v_add_f32 v146, v146, v150
    v_add_f32 v154, v154, v158
    v_add_f32 v147, v147, v151
    v_add_f32 v155, v155, v159
    v_add_f32 v144, v144, v152
    v_add_f32 v145, v145, v153
    v_add_f32 v146, v146, v154
    v_add_f32 v147, v147, v155
    v_cvt_pk_bf16_f32 v148, v144, v145
    v_cvt_pk_bf16_f32 v149, v146, v147
    v_lshlrev_b32 v144, 16, v148
    v_and_b32 v145, 0xffff0000, v148
    v_lshlrev_b32 v146, 16, v149
    v_and_b32 v147, 0xffff0000, v149
    v_mul_f32 v132, 0xbfb8aa3b, v128
    v_mul_f32 v133, 0xbfb8aa3b, v129
    v_mul_f32 v134, 0xbfb8aa3b, v130
    v_mul_f32 v135, 0xbfb8aa3b, v131
    v_exp_f32 v132, v132
    v_exp_f32 v133, v133
    v_exp_f32 v134, v134
    v_exp_f32 v135, v135
    v_add_f32 v132, 1.0, v132
    v_add_f32 v133, 1.0, v133
    v_add_f32 v134, 1.0, v134
    v_add_f32 v135, 1.0, v135
    v_rcp_f32 v132, v132
    v_rcp_f32 v133, v133
    v_rcp_f32 v134, v134
    v_rcp_f32 v135, v135
    v_mul_f32 v128, v128, v132
    v_mul_f32 v129, v129, v133
    v_mul_f32 v130, v130, v134
    v_mul_f32 v131, v131, v135
    v_cvt_pk_bf16_f32 v132, v128, v129
    v_cvt_pk_bf16_f32 v133, v130, v131
    v_lshlrev_b32 v128, 16, v132
    v_and_b32 v129, 0xffff0000, v132
    v_lshlrev_b32 v130, 16, v133
    v_and_b32 v131, 0xffff0000, v133
    v_mul_f32 v128, v128, v144
    v_mul_f32 v129, v129, v145
    v_mul_f32 v130, v130, v146
    v_mul_f32 v131, v131, v147
    v_cvt_pk_bf16_f32 v146, v128, v129
    v_cvt_pk_bf16_f32 v147, v130, v131
    v_cndmask_b32 v144, 0, v146, vcc
    v_cndmask_b32 v145, 0, v147, vcc
    v_cndmask_b32 v146, v146, 0, vcc
    v_cndmask_b32 v147, v147, 0, vcc
    s_waitcnt lgkmcnt(0)
    v_mfma_f32_16x16x16_bf16 v[128:131], v[164:165], v[144:145], 0
    v_mfma_f32_16x16x16_bf16 v[128:131], v[166:167], v[146:147], v[128:131]
    v_mfma_f32_16x16x16_bf16 v[132:135], v[168:169], v[144:145], 0
    v_mfma_f32_16x16x16_bf16 v[132:135], v[170:171], v[146:147], v[132:135]
    v_mfma_f32_16x16x16_bf16 v[136:139], v[172:173], v[144:145], 0
    v_mfma_f32_16x16x16_bf16 v[136:139], v[174:175], v[146:147], v[136:139]
    v_mfma_f32_16x16x16_bf16 v[140:143], v[176:177], v[144:145], 0
    v_mfma_f32_16x16x16_bf16 v[140:143], v[178:179], v[146:147], v[140:143]
    s_nop 4
    buffer_store_dwordx4 v[128:131], v225, s[16:19], s3 offen offset:0 sc1
    buffer_store_dwordx4 v[132:135], v225, s[16:19], s3 offen offset:1024 sc1
    buffer_store_dwordx4 v[136:139], v225, s[16:19], s3 offen offset:2048 sc1
    buffer_store_dwordx4 v[140:143], v225, s[16:19], s3 offen offset:3072 sc1
    s_nop 0
    s_branch L_loop
L_hook18:
    s_lshl_b32 s3, s20, 7
    s_add_u32 s3, s3, s69
    s_lshl_b32 s3, s3, 2
    s_add_u32 s3, s3, 16814080
    v_mov_b32 v128, s46
    s_waitcnt vmcnt(16)
    s_mov_b64 exec, 1
    buffer_store_dword v128, off, s[16:19], s3 sc1
    s_mov_b64 exec, -1
    s_branch L_ret2
L_hook22:
    v_min_u32 v128, 55, v0
    v_lshlrev_b32 v128, 3, v128
    s_lshr_b32 s3, s2, 6
    s_lshl_b32 s3, s3, 9
    s_add_u32 s3, s3, 16814080
    buffer_load_dwordx2 v[62:63], v128, s[16:19], s3 offen sc1
    s_branch L_ret2
L_hook24:
    s_waitcnt vmcnt(16)
    v_xor_b32 v129, s46, v62
    v_bitop3_b32 v129, v129, v63, s46 bitop3:0xf6
    v_cmp_ne_u32 vcc, 0, v129
    s_cbranch_vccnz L_fc_retry
L_fc_ok:
    v_lshrrev_b32 v128, 3, v0
    v_xor_b32 v129, v128, v0
    v_and_b32 v129, 7, v129
    v_lshlrev_b32 v129, 4, v129
    v_lshl_add_u32 v128, v128, 14, v129
    s_lshr_b32 s3, s2, 1
    s_lshl_b32 s3, s3, 7
    s_lshl_b32 s67, s20, 17
    s_add_u32 s3, s3, s67
    s_add_u32 s3, s3, 20971520
    s_lshr_b32 s68, s25, 2
    s_add_u32 m0, s68, 131072
    s_add_u32 s67, s3, 0
    buffer_load_dwordx4 v128, s[16:19], s67 offen sc1 lds
    s_add_u32 m0, s68, 135168
    s_add_u32 s67, s3, 524288
    buffer_load_dwordx4 v128, s[16:19], s67 offen sc1 lds
    s_add_u32 m0, s68, 139264
    s_add_u32 s67, s3, 1048576
    buffer_load_dwordx4 v128, s[16:19], s67 offen sc1 lds
    s_add_u32 m0, s68, 143360
    s_add_u32 s67, s3, 1572864
    s_cmp_lt_u32 s20, 2
    s_cselect_b32 s67, s67, 0x40000000
    buffer_load_dwordx4 v128, s[16:19], s67 offen sc1 lds
    s_branch L_loop
L_hook27:
    v_lshrrev_b32 v180, 3, v0
    v_and_b32 v181, 7, v0
    v_lshrrev_b32 v182, 1, v180
    v_lshlrev_b32 v182, 1, v182
    v_xor_b32 v182, v182, v181
    v_lshlrev_b32 v182, 4, v182
    v_lshl_add_u32 v16, v180, 10, v182
    v_add_u32 v17, 7168, v16
    v_add_u32 v18, 14336, v16
    v_add_u32 v19, 21504, v16
    s_mov_b32 s8, s28
    s_mov_b32 s9, s29
    s_mov_b32 s10, s30
    s_mov_b32 s23, 0
    s_mov_b32 s34, 0x8000
    s_or_b32 s3, s0, s66
    s_cbranch_scc1 L_s4_done
    s_lshl_b32 s68, s20, 1
    v_lshrrev_b32 v145, 5, v0
    v_add_u32 v145, s68, v145
    v_xor_b32 v144, v145, v0
    v_and_b32 v144, 7, v144
    v_and_b32 v146, 31, v0
    v_lshl_add_u32 v144, v146, 3, v144
    v_lshlrev_b32 v144, 4, v144
    v_add_u32 v144, 0x20000, v144
    ds_read_b128 v[128:131], v144 offset:0
    ds_read_b128 v[132:135], v144 offset:4096
    ds_read_b128 v[136:139], v144 offset:8192
    ds_read_b128 v[140:143], v144 offset:12288
    v_lshlrev_b32 v146, 2, v145
    ds_bpermute_b32 v147, v146, v60
    v_lshlrev_b32 v145, 11, v145
    s_lshr_b32 s3, s2, 1
    s_lshl_b32 s3, s3, 4
    s_add_u32 s3, s3, 16826368
    s_waitcnt lgkmcnt(0)
    v_add_f32 v128, v128, v132
    v_add_f32 v136, v136, v140
    v_add_f32 v129, v129, v133
    v_add_f32 v137, v137, v141
    v_add_f32 v130, v130, v134
    v_add_f32 v138, v138, v142
    v_add_f32 v131, v131, v135
    v_add_f32 v139, v139, v143
    v_add_f32 v128, v128, v136
    v_add_f32 v129, v129, v137
    v_add_f32 v130, v130, v138
    v_add_f32 v131, v131, v139
    v_add_f32_dpp v128, v128, v128 quad_perm:[1,0,3,2] row_mask:0xf bank_mask:0xf
    v_add_f32_dpp v129, v129, v129 quad_perm:[1,0,3,2] row_mask:0xf bank_mask:0xf
    v_add_f32_dpp v130, v130, v130 quad_perm:[1,0,3,2] row_mask:0xf bank_mask:0xf
    v_add_f32_dpp v131, v131, v131 quad_perm:[1,0,3,2] row_mask:0xf bank_mask:0xf
    v_add_f32_dpp v128, v128, v128 quad_perm:[2,3,0,1] row_mask:0xf bank_mask:0xf
    v_add_f32_dpp v129, v129, v129 quad_perm:[2,3,0,1] row_mask:0xf bank_mask:0xf
    v_add_f32_dpp v130, v130, v130 quad_perm:[2,3,0,1] row_mask:0xf bank_mask:0xf
    v_add_f32_dpp v131, v131, v131 quad_perm:[2,3,0,1] row_mask:0xf bank_mask:0xf
    v_add_f32_dpp v128, v128, v128 row_half_mirror row_mask:0xf bank_mask:0xf
    v_add_f32_dpp v129, v129, v129 row_half_mirror row_mask:0xf bank_mask:0xf
    v_add_f32_dpp v130, v130, v130 row_half_mirror row_mask:0xf bank_mask:0xf
    v_add_f32_dpp v131, v131, v131 row_half_mirror row_mask:0xf bank_mask:0xf
    v_add_f32_dpp v128, v128, v128 row_mirror row_mask:0xf bank_mask:0xf
    v_add_f32_dpp v129, v129, v129 row_mirror row_mask:0xf bank_mask:0xf
    v_add_f32_dpp v130, v130, v130 row_mirror row_mask:0xf bank_mask:0xf
    v_add_f32_dpp v131, v131, v131 row_mirror row_mask:0xf bank_mask:0xf
    v_add_f32_dpp v128, v128, v128 row_bcast:15 row_mask:0xa bank_mask:0xf
    v_add_f32_dpp v129, v129, v129 row_bcast:15 row_mask:0xa bank_mask:0xf
    v_add_f32_dpp v130, v130, v130 row_bcast:15 row_mask:0xa bank_mask:0xf
    v_add_f32_dpp v131, v131, v131 row_bcast:15 row_mask:0xa bank_mask:0xf
    v_and_b32 v147, 0xffff0000, v147
    v_cvt_pk_bf16_f32 v132, v128, v129
    v_cvt_pk_bf16_f32 v133, v130, v131
    v_lshlrev_b32 v128, 16, v132
    v_and_b32 v129, 0xffff0000, v132
    v_lshlrev_b32 v130, 16, v133
    v_and_b32 v131, 0xffff0000, v133
    v_mul_f32 v128, v147, v128
    v_mul_f32 v129, v147, v129
    v_mul_f32 v130, v147, v130
    v_mul_f32 v131, v147, v131
    v_cvt_pk_bf16_f32 v132, v128, v129
    v_cvt_pk_bf16_f32 v133, v130, v131
    v_mov_b32 v134, s46
    v_mov_b32 v135, s46
    s_mov_b32 exec_lo, 0x80000000
    s_mov_b32 exec_hi, 0x80000000
    buffer_store_dwordx4 v[132:135], v145, s[16:19], s3 offen sc1
    s_mov_b64 exec, -1
L_s4_done:
    s_andn2_b32 s3, 4, s2
    s_add_u32 s3, s3, s20
    s_lshl_b32 s3, s3, 9
    s_and_b32 s67, s2, 0xf8
    s_add_u32 s3, s3, s67
    s_add_u32 s3, s3, 0
    s_lshl_b32 s3, s3, 10
    v_lshl_add_u32 v180, v0, 7, s3
    global_load_dword v23, v180, s[44:45]
    s_branch L_ret3
L_hook28:
    v_mov_b32 v20, v16
    v_mov_b32 v21, v17
    v_mov_b32 v1, v18
    v_mov_b32 v2, v19
    s_mov_b32 s12, s28
    s_mov_b32 s13, s29
    s_mov_b32 s14, s30
    s_mov_b32 s24, 0x10000
    s_mov_b32 s34, 0x10000
    s_mov_b32 s35, 0x10000
    s_andn2_b32 s3, 4, s2
    s_add_u32 s3, s3, s20
    s_lshl_b32 s3, s3, 9
    s_and_b32 s67, s2, 0xf8
    s_add_u32 s3, s3, s67
    s_add_u32 s3, s3, 256
    s_lshl_b32 s3, s3, 10
    v_lshl_add_u32 v180, v0, 7, s3
    global_load_dword v23, v180, s[44:45]
    s_branch L_loop
.p2align 12
L_tail:
    v_mfma_f32_16x16x32_bf16 a[0:3], a[192:195], v[192:195], a[0:3]
    s_mov_b32 s35, 163840
    ds_read_b64_tr_b16 a[128:129], v8 offset:0
    ds_read_b64_tr_b16 a[130:131], v8 offset:4096
    v_mfma_f32_16x16x32_bf16 a[0:3], a[224:227], v[196:199], a[0:3]
    s_lshl_b32 s3, s22, 2
    ds_read_b64_tr_b16 a[160:161], v8 offset:8192
    ds_read_b64_tr_b16 a[162:163], v8 offset:12288
    v_mfma_f32_16x16x32_bf16 a[4:7], a[228:231], v[196:199], a[4:7]
    s_add_u32 s3, s3, s20
    ds_read_b64_tr_b16 a[132:133], v9 offset:0
    ds_read_b64_tr_b16 a[134:135], v9 offset:4096
    v_mfma_f32_16x16x32_bf16 a[4:7], a[196:199], v[192:195], a[4:7]
    s_lshl_b32 s69, s3, 5
    s_add_u32 m0, s25, 49152
    s_nop 0
    buffer_load_dwordx4 v16, s[28:31], s35 offen offset:0 lds
    ds_read_b64_tr_b16 a[164:165], v9 offset:8192
    ds_read_b64_tr_b16 a[166:167], v9 offset:12288
    v_mfma_f32_16x16x32_bf16 a[8:11], a[200:203], v[192:195], a[8:11]
    s_add_u32 s69, s69, s21
    ds_read_b64_tr_b16 a[136:137], v10 offset:0
    ds_read_b64_tr_b16 a[138:139], v10 offset:4096
    v_mfma_f32_16x16x32_bf16 a[8:11], a[232:235], v[196:199], a[8:11]
    s_lshl_b32 s69, s69, 7
    ds_read_b64_tr_b16 a[168:169], v10 offset:8192
    ds_read_b64_tr_b16 a[170:171], v10 offset:12288
    v_mfma_f32_16x16x32_bf16 a[12:15], a[236:239], v[196:199], a[12:15]
    s_add_u32 s69, s69, 16842752
    ds_read_b64_tr_b16 a[140:141], v11 offset:0
    ds_read_b64_tr_b16 a[142:143], v11 offset:4096
    v_mfma_f32_16x16x32_bf16 a[12:15], a[204:207], v[192:195], a[12:15]
    s_mul_i32 s3, s3, 671744
    buffer_load_dwordx4 v17, s[28:31], s35 offen offset:1024 lds
    ds_read_b64_tr_b16 a[172:173], v11 offset:8192
    ds_read_b64_tr_b16 a[174:175], v11 offset:12288
    v_mfma_f32_16x16x32_bf16 a[16:19], a[208:211], v[192:195], a[16:19]
    s_lshl_b32 s68, s21, 12
    ds_read_b64_tr_b16 a[144:145], v12 offset:0
    ds_read_b64_tr_b16 a[146:147], v12 offset:4096
    v_mfma_f32_16x16x32_bf16 a[16:19], a[240:243], v[196:199], a[16:19]
    s_add_u32 s68, s68, s3
    ds_read_b64_tr_b16 a[176:177], v12 offset:8192
    ds_read_b64_tr_b16 a[178:179], v12 offset:12288
    v_mfma_f32_16x16x32_bf16 a[20:23], a[244:247], v[196:199], a[20:23]
    s_add_u32 s68, s68, 33554432
    ds_read_b64_tr_b16 a[148:149], v13 offset:0
    ds_read_b64_tr_b16 a[150:151], v13 offset:4096
    v_mfma_f32_16x16x32_bf16 a[20:23], a[212:215], v[192:195], a[20:23]
    s_andn2_b32 s1, 4, s2
    buffer_load_dwordx4 v18, s[28:31], s35 offen offset:2048 lds
    ds_read_b64_tr_b16 a[180:181], v13 offset:8192
    ds_read_b64_tr_b16 a[182:183], v13 offset:12288
    v_mfma_f32_16x16x32_bf16 a[24:27], a[216:219], v[192:195], a[24:27]
    s_add_u32 s1, s1, s20
    ds_read_b64_tr_b16 a[152:153], v14 offset:0
    ds_read_b64_tr_b16 a[154:155], v14 offset:4096
    v_mfma_f32_16x16x32_bf16 a[24:27], a[248:251], v[196:199], a[24:27]
    s_lshl_b32 s1, s1, 2
    ds_read_b64_tr_b16 a[184:185], v14 offset:8192
    ds_read_b64_tr_b16 a[186:187], v14 offset:12288
    v_mfma_f32_16x16x32_bf16 a[28:31], a[252:255], v[196:199], a[28:31]
    ds_read_b64_tr_b16 a[156:157], v15 offset:0
    ds_read_b64_tr_b16 a[158:159], v15 offset:4096
    v_mfma_f32_16x16x32_bf16 a[28:31], a[220:223], v[192:195], a[28:31]
    buffer_load_dwordx4 v19, s[28:31], s35 offen offset:3072 lds
    s_add_u32 s35, s35, 0x8000
    ds_read_b64_tr_b16 a[188:189], v15 offset:8192
    ds_read_b64_tr_b16 a[190:191], v15 offset:12288
    v_smfmac_f32_16x16x64_bf16 v[28:31], v[24:27], v[192:199], v22
    v_perm_b32 v237, v155, v154, s43
    v_mov_b32 v4, v3
    v_smfmac_f32_16x16x64_bf16 v[28:31], v[24:27], v[224:231], v22
    s_waitcnt lgkmcnt(14)
    v_exp_f32 v156, v156
    v_mfma_f32_16x16x32_bf16 a[0:3], a[128:131], v[224:227], a[0:3]
    v_exp_f32 v157, v157
    v_mfma_f32_16x16x32_bf16 a[0:3], a[160:163], v[228:231], a[0:3]
    s_add_u32 m0, s25, 114688
    s_nop 0
    buffer_load_dwordx4 v16, s[28:31], s35 offen offset:0 lds
    v_mfma_f32_16x16x32_bf16 a[4:7], a[164:167], v[228:231], a[4:7]
    v_exp_f32 v158, v158
    v_mfma_f32_16x16x32_bf16 a[4:7], a[132:135], v[224:227], a[4:7]
    s_waitcnt lgkmcnt(14)
    v_perm_b32 v238, v157, v156, s43
    v_mfma_f32_16x16x32_bf16 a[8:11], a[136:139], v[224:227], a[8:11]
    v_exp_f32 v159, v159
    v_mfma_f32_16x16x32_bf16 a[8:11], a[168:171], v[228:231], a[8:11]
    buffer_load_dwordx4 v17, s[28:31], s35 offen offset:1024 lds
    v_mfma_f32_16x16x32_bf16 a[12:15], a[172:175], v[228:231], a[12:15]
    v_perm_b32 v239, v159, v158, s43
    v_add_u32 v5, 167936, v3
    v_mfma_f32_16x16x32_bf16 a[12:15], a[140:143], v[224:227], a[12:15]
    s_waitcnt lgkmcnt(0)
    v_add_u32 v6, 335872, v3
    v_add_u32 v7, 503808, v3
    v_mfma_f32_16x16x32_bf16 a[16:19], a[144:147], v[224:227], a[16:19]
    v_and_b32 v3, 3, v0
    v_add_f32 v28, v28, v29
    v_mfma_f32_16x16x32_bf16 a[16:19], a[176:179], v[228:231], a[16:19]
    buffer_load_dwordx4 v18, s[28:31], s35 offen offset:2048 lds
    v_mfma_f32_16x16x32_bf16 a[20:23], a[180:183], v[228:231], a[20:23]
    v_rcp_f32 v60, v28
    v_mfma_f32_16x16x32_bf16 a[20:23], a[148:151], v[224:227], a[20:23]
    v_and_b32 v154, 7, v0
    v_lshlrev_b32 v154, 3, v154
    v_mfma_f32_16x16x32_bf16 a[24:27], a[152:155], v[224:227], a[24:27]
    v_add_u32 v154, 16809984, v154
    v_mfma_f32_16x16x32_bf16 a[24:27], a[184:187], v[228:231], a[24:27]
    buffer_load_dwordx4 v19, s[28:31], s35 offen offset:3072 lds
    s_add_u32 s35, s35, 0x8000
    v_mfma_f32_16x16x32_bf16 a[28:31], a[188:191], v[228:231], a[28:31]
    buffer_load_dwordx2 v[152:153], v154, s[16:19], 0 offen sc1
    v_mfma_f32_16x16x32_bf16 a[28:31], a[156:159], v[224:227], a[28:31]
    s_lshl_b32 s3, s47, 2
    s_add_u32 s3, s3, s20
    s_lshl_b32 s3, s3, 4
    v_smfmac_f32_16x16x64_bf16 v[32:35], v[24:27], v[200:207], v22
    v_lshrrev_b32 v12, 2, v0
    v_add_u32 v12, s3, v12
    v_smfmac_f32_16x16x64_bf16 v[32:35], v[24:27], v[232:239], v22
    v_lshlrev_b32 v14, 3, v12
    v_add_u32 v14, 16777216, v14
    s_lshl_b32 s3, s32, 7
    v_lshl_add_u32 v10, v3, 4, s3
    v_lshl_add_u32 v45, v12, 10, v10
    v_mov_b32 v13, s46
    global_load_dwordx4 v[144:147], v45, s[36:37]
    global_load_dwordx4 v[148:151], v45, s[36:37] offset:64
    buffer_load_dwordx2 v[46:47], v14, s[16:19], 0 offen sc1
    v_accvgpr_read_b32 v128, a0
    v_mfma_f32_16x16x32_bf16 a[32:35], a[192:195], v[200:203], a[32:35]
    v_accvgpr_read_b32 v129, a1
    v_mfma_f32_16x16x32_bf16 a[32:35], a[224:227], v[204:207], a[32:35]
    v_exp_f32 v160, v160
    v_mfma_f32_16x16x32_bf16 a[32:35], a[128:131], v[232:235], a[32:35]
    v_accvgpr_read_b32 v130, a2
    v_accvgpr_read_b32 v131, a3
    v_mfma_f32_16x16x32_bf16 a[32:35], a[160:163], v[236:239], a[32:35]
    v_accvgpr_read_b32 v132, a4
    v_exp_f32 v161, v161
    v_accvgpr_read_b32 v133, a5
    v_accvgpr_read_b32 v134, a6
    v_accvgpr_read_b32 v135, a7
    v_mul_f32 v128, v60, v128
    v_exp_f32 v162, v162
    v_mul_f32 v129, v60, v129
    v_mul_f32 v130, v60, v130
    s_add_u32 m0, s25, 131072
    s_nop 0
    buffer_load_dwordx4 v16, s[28:31], s35 offen offset:0 lds
    v_mfma_f32_16x16x32_bf16 a[36:39], a[164:167], v[236:239], a[36:39]
    v_mul_f32 v131, v60, v131
    v_perm_b32 v240, v161, v160, s43
    v_mfma_f32_16x16x32_bf16 a[36:39], a[132:135], v[232:235], a[36:39]
    v_mul_f32 v132, v60, v132
    v_mul_f32 v133, v60, v133
    v_mfma_f32_16x16x32_bf16 a[36:39], a[228:231], v[204:207], a[36:39]
    v_mul_f32 v134, v60, v134
    v_mul_f32 v135, v60, v135
    v_mfma_f32_16x16x32_bf16 a[36:39], a[196:199], v[200:203], a[36:39]
    v_exp_f32 v163, v163
    v_cvt_pk_bf16_f32 v136, v128, v129
    v_cvt_pk_bf16_f32 v137, v130, v131
    v_cvt_pk_bf16_f32 v138, v132, v133
    v_exp_f32 v164, v164
    v_cvt_pk_bf16_f32 v139, v134, v135
    buffer_store_dwordx4 v[136:139], v4, s[16:19], s68 offen offset:0 sc1
    v_accvgpr_read_b32 v128, a8
    v_accvgpr_read_b32 v129, a9
    v_perm_b32 v241, v163, v162, s43
    v_mfma_f32_16x16x32_bf16 a[40:43], a[200:203], v[200:203], a[40:43]
    v_accvgpr_read_b32 v130, a10
    v_accvgpr_read_b32 v131, a11
    v_mfma_f32_16x16x32_bf16 a[40:43], a[232:235], v[204:207], a[40:43]
    v_accvgpr_read_b32 v132, a12
    v_mfma_f32_16x16x32_bf16 a[40:43], a[136:139], v[232:235], a[40:43]
    v_exp_f32 v165, v165
    v_mfma_f32_16x16x32_bf16 a[40:43], a[168:171], v[236:239], a[40:43]
    v_accvgpr_read_b32 v133, a13
    v_accvgpr_read_b32 v134, a14
    v_accvgpr_read_b32 v135, a15
    v_mul_f32 v128, v60, v128
    v_exp_f32 v166, v166
    v_mul_f32 v129, v60, v129
    v_mul_f32 v130, v60, v130
    buffer_load_dwordx4 v17, s[28:31], s35 offen offset:1024 lds
    v_mul_f32 v131, v60, v131
    v_perm_b32 v242, v165, v164, s43
    v_mul_f32 v132, v60, v132
    v_mfma_f32_16x16x32_bf16 a[44:47], a[172:175], v[236:239], a[44:47]
    v_mul_f32 v133, v60, v133
    v_mul_f32 v134, v60, v134
    v_mfma_f32_16x16x32_bf16 a[44:47], a[140:143], v[232:235], a[44:47]
    v_mul_f32 v135, v60, v135
    v_mfma_f32_16x16x32_bf16 a[44:47], a[236:239], v[204:207], a[44:47]
    v_exp_f32 v167, v167
    v_mfma_f32_16x16x32_bf16 a[44:47], a[204:207], v[200:203], a[44:47]
    v_cvt_pk_bf16_f32 v140, v128, v129
    v_cvt_pk_bf16_f32 v141, v130, v131
    v_cvt_pk_bf16_f32 v142, v132, v133
    v_exp_f32 v168, v168
    v_cvt_pk_bf16_f32 v143, v134, v135
    buffer_store_dwordx4 v[140:143], v4, s[16:19], s68 offen offset:1024 sc1
    v_accvgpr_read_b32 v128, a16
    v_accvgpr_read_b32 v129, a17
    v_perm_b32 v243, v167, v166, s43
    v_accvgpr_read_b32 v130, a18
    v_mfma_f32_16x16x32_bf16 a[48:51], a[208:211], v[200:203], a[48:51]
    v_accvgpr_read_b32 v131, a19
    v_accvgpr_read_b32 v132, a20
    v_mfma_f32_16x16x32_bf16 a[48:51], a[240:243], v[204:207], a[48:51]
    v_exp_f32 v169, v169
    v_mfma_f32_16x16x32_bf16 a[48:51], a[144:147], v[232:235], a[48:51]
    v_accvgpr_read_b32 v133, a21
    v_accvgpr_read_b32 v134, a22
    v_mfma_f32_16x16x32_bf16 a[48:51], a[176:179], v[236:239], a[48:51]
    v_accvgpr_read_b32 v135, a23
    v_mul_f32 v128, v60, v128
    v_exp_f32 v170, v170
    v_mul_f32 v129, v60, v129
    v_mul_f32 v130, v60, v130
    buffer_load_dwordx4 v18, s[28:31], s35 offen offset:2048 lds
    v_mul_f32 v131, v60, v131
    v_perm_b32 v244, v169, v168, s43
    v_mul_f32 v132, v60, v132
    v_mul_f32 v133, v60, v133
    v_mfma_f32_16x16x32_bf16 a[52:55], a[180:183], v[236:239], a[52:55]
    v_mul_f32 v134, v60, v134
    v_mul_f32 v135, v60, v135
    v_mfma_f32_16x16x32_bf16 a[52:55], a[148:151], v[232:235], a[52:55]
    v_exp_f32 v171, v171
    v_mfma_f32_16x16x32_bf16 a[52:55], a[244:247], v[204:207], a[52:55]
    v_cvt_pk_bf16_f32 v136, v128, v129
    v_cvt_pk_bf16_f32 v137, v130, v131
    v_mfma_f32_16x16x32_bf16 a[52:55], a[212:215], v[200:203], a[52:55]
    v_cvt_pk_bf16_f32 v138, v132, v133
    v_exp_f32 v172, v172
    v_cvt_pk_bf16_f32 v139, v134, v135
    buffer_store_dwordx4 v[136:139], v4, s[16:19], s68 offen offset:2048 sc1
    v_accvgpr_read_b32 v128, a24
    v_accvgpr_read_b32 v129, a25
    v_perm_b32 v245, v171, v170, s43
    v_accvgpr_read_b32 v130, a26
    v_accvgpr_read_b32 v131, a27
    v_mfma_f32_16x16x32_bf16 a[56:59], a[216:219], v[200:203], a[56:59]
    v_accvgpr_read_b32 v132, a28
    v_mfma_f32_16x16x32_bf16 a[56:59], a[248:251], v[204:207], a[56:59]
    v_exp_f32 v173, v173
    v_mfma_f32_16x16x32_bf16 a[56:59], a[152:155], v[232:235], a[56:59]
    v_accvgpr_read_b32 v133, a29
    v_accvgpr_read_b32 v134, a30
    v_mfma_f32_16x16x32_bf16 a[56:59], a[184:187], v[236:239], a[56:59]
    v_accvgpr_read_b32 v135, a31
    v_mul_f32 v128, v60, v128
    v_exp_f32 v174, v174
    v_mul_f32 v129, v60, v129
    v_mul_f32 v130, v60, v130
    buffer_load_dwordx4 v19, s[28:31], s35 offen offset:3072 lds
    s_add_u32 s35, s35, 0x8000
    v_mul_f32 v131, v60, v131
    v_perm_b32 v246, v173, v172, s43
    v_mul_f32 v132, v60, v132
    v_mfma_f32_16x16x32_bf16 a[60:63], a[188:191], v[236:239], a[60:63]
    v_mul_f32 v133, v60, v133
    v_mul_f32 v134, v60, v134
    v_mfma_f32_16x16x32_bf16 a[60:63], a[156:159], v[232:235], a[60:63]
    v_mul_f32 v135, v60, v135
    v_mfma_f32_16x16x32_bf16 a[60:63], a[252:255], v[204:207], a[60:63]
    v_exp_f32 v175, v175
    v_mfma_f32_16x16x32_bf16 a[60:63], a[220:223], v[200:203], a[60:63]
    v_cvt_pk_bf16_f32 v140, v128, v129
    v_cvt_pk_bf16_f32 v141, v130, v131
    v_cvt_pk_bf16_f32 v142, v132, v133
    v_perm_b32 v247, v175, v174, s43
    v_cvt_pk_bf16_f32 v143, v134, v135
    buffer_store_dwordx4 v[140:143], v4, s[16:19], s68 offen offset:3072 sc1
    v_add_f32 v32, v32, v33
    v_rcp_f32 v61, v32
    v_smfmac_f32_16x16x64_bf16 v[36:39], v[24:27], v[208:215], v22
    v_accvgpr_read_b32 v128, a32
    v_lshrrev_b32 v1, 4, v0
    v_smfmac_f32_16x16x64_bf16 v[36:39], v[24:27], v[240:247], v22
    v_accvgpr_read_b32 v129, a33
    v_exp_f32 v176, v176
    v_accvgpr_read_b32 v130, a34
    v_and_b32 v2, 15, v0
    v_accvgpr_read_b32 v131, a35
    v_accvgpr_read_b32 v132, a36
    v_bfe_u32 v9, v0, 3, 2
    v_exp_f32 v177, v177
    v_accvgpr_read_b32 v133, a37
    v_accvgpr_read_b32 v134, a38
    v_lshrrev_b32 v8, 2, v2
    v_accvgpr_read_b32 v135, a39
    v_mul_f32 v128, v61, v128
    v_lshl_add_u32 v8, v1, 2, v8
    v_mfma_f32_16x16x32_bf16 a[64:67], a[192:195], v[208:211], a[64:67]
    v_exp_f32 v178, v178
    v_mfma_f32_16x16x32_bf16 a[64:67], a[224:227], v[212:215], a[64:67]
    v_mul_f32 v129, v61, v129
    v_mul_f32 v130, v61, v130
    v_mfma_f32_16x16x32_bf16 a[64:67], a[128:131], v[240:243], a[64:67]
    v_bfe_u32 v10, v8, 1, 2
    v_mul_f32 v131, v61, v131
    v_mfma_f32_16x16x32_bf16 a[64:67], a[160:163], v[244:247], a[64:67]
    v_perm_b32 v248, v177, v176, s43
    v_lshlrev_b32 v8, 7, v8
    v_mul_f32 v132, v61, v132
    v_mul_f32 v133, v61, v133
    v_lshl_add_u32 v8, v3, 3, v8
    v_mul_f32 v134, v61, v134
    v_mul_f32 v135, v61, v135
    v_exp_f32 v179, v179
    v_add_u32 v8, s25, v8
    v_cvt_pk_bf16_f32 v136, v128, v129
    v_cvt_pk_bf16_f32 v137, v130, v131
    v_xor_b32 v11, 0, v10
    v_cvt_pk_bf16_f32 v138, v132, v133
    v_mfma_f32_16x16x32_bf16 a[68:71], a[164:167], v[244:247], a[68:71]
    v_exp_f32 v180, v180
    v_mfma_f32_16x16x32_bf16 a[68:71], a[132:135], v[240:243], a[68:71]
    v_cvt_pk_bf16_f32 v139, v134, v135
    v_lshl_add_u32 v48, v11, 5, v8
    v_mfma_f32_16x16x32_bf16 a[68:71], a[228:231], v[212:215], a[68:71]
    v_mfma_f32_16x16x32_bf16 a[68:71], a[196:199], v[208:211], a[68:71]
    buffer_store_dwordx4 v[136:139], v5, s[16:19], s68 offen offset:0 sc1
    v_accvgpr_read_b32 v128, a40
    v_add_u32 v52, 0x10000, v48
    v_accvgpr_read_b32 v129, a41
    v_perm_b32 v249, v179, v178, s43
    v_accvgpr_read_b32 v130, a42
    v_add_u32 v56, 0x20000, v48
    v_accvgpr_read_b32 v131, a43
    v_accvgpr_read_b32 v132, a44
    v_xor_b32 v11, 1, v10
    v_exp_f32 v181, v181
    v_accvgpr_read_b32 v133, a45
    v_accvgpr_read_b32 v134, a46
    v_lshl_add_u32 v49, v11, 5, v8
    v_mfma_f32_16x16x32_bf16 a[72:75], a[200:203], v[208:211], a[72:75]
    v_accvgpr_read_b32 v135, a47
    v_mul_f32 v128, v61, v128
    v_mfma_f32_16x16x32_bf16 a[72:75], a[232:235], v[212:215], a[72:75]
    v_add_u32 v53, 0x10000, v49
    v_mfma_f32_16x16x32_bf16 a[72:75], a[136:139], v[240:243], a[72:75]
    v_exp_f32 v182, v182
    v_mfma_f32_16x16x32_bf16 a[72:75], a[168:171], v[244:247], a[72:75]
    v_mul_f32 v129, v61, v129
    v_mul_f32 v130, v61, v130
    v_add_u32 v57, 0x20000, v49
    v_mul_f32 v131, v61, v131
    v_perm_b32 v250, v181, v180, s43
    v_xor_b32 v11, 2, v10
    v_mul_f32 v132, v61, v132
    v_mul_f32 v133, v61, v133
    v_lshl_add_u32 v50, v11, 5, v8
    v_mul_f32 v134, v61, v134
    v_mul_f32 v135, v61, v135
    v_exp_f32 v183, v183
    v_add_u32 v54, 0x10000, v50
    v_cvt_pk_bf16_f32 v140, v128, v129
    v_mfma_f32_16x16x32_bf16 a[76:79], a[172:175], v[244:247], a[76:79]
    v_cvt_pk_bf16_f32 v141, v130, v131
    v_add_u32 v58, 0x20000, v50
    v_mfma_f32_16x16x32_bf16 a[76:79], a[140:143], v[240:243], a[76:79]
    v_cvt_pk_bf16_f32 v142, v132, v133
    v_mfma_f32_16x16x32_bf16 a[76:79], a[236:239], v[212:215], a[76:79]
    v_exp_f32 v184, v184
    v_mfma_f32_16x16x32_bf16 a[76:79], a[204:207], v[208:211], a[76:79]
    v_cvt_pk_bf16_f32 v143, v134, v135
    v_xor_b32 v11, 3, v10
    buffer_store_dwordx4 v[140:143], v5, s[16:19], s68 offen offset:1024 sc1
    v_accvgpr_read_b32 v128, a48
    v_lshl_add_u32 v51, v11, 5, v8
    v_accvgpr_read_b32 v129, a49
    v_perm_b32 v251, v183, v182, s43
    v_accvgpr_read_b32 v130, a50
    v_add_u32 v55, 0x10000, v51
    v_accvgpr_read_b32 v131, a51
    v_accvgpr_read_b32 v132, a52
    v_add_u32 v59, 0x20000, v51
    v_exp_f32 v185, v185
    v_mfma_f32_16x16x32_bf16 a[80:83], a[208:211], v[208:211], a[80:83]
    v_accvgpr_read_b32 v133, a53
    v_accvgpr_read_b32 v134, a54
    v_mfma_f32_16x16x32_bf16 a[80:83], a[240:243], v[212:215], a[80:83]
    s_lshl_b32 s67, s1, 12
    v_accvgpr_read_b32 v135, a55
    v_mul_f32 v128, v61, v128
    v_mfma_f32_16x16x32_bf16 a[80:83], a[144:147], v[240:243], a[80:83]
    s_add_u32 s67, s67, 33554432
    v_exp_f32 v186, v186
    v_mfma_f32_16x16x32_bf16 a[80:83], a[176:179], v[244:247], a[80:83]
    v_mul_f32 v129, v61, v129
    v_mul_f32 v130, v61, v130
    s_xor_b32 s3, s47, 1
    v_mul_f32 v131, v61, v131
    v_perm_b32 v252, v185, v184, s43
    s_mul_i32 s3, s3, 671744
    v_mul_f32 v132, v61, v132
    v_mul_f32 v133, v61, v133
    s_add_u32 s63, s3, s67
    v_mul_f32 v134, v61, v134
    v_mul_f32 v135, v61, v135
    v_exp_f32 v187, v187
    s_mul_i32 s3, s47, 671744
    v_mfma_f32_16x16x32_bf16 a[84:87], a[180:183], v[244:247], a[84:87]
    v_cvt_pk_bf16_f32 v136, v128, v129
    v_cvt_pk_bf16_f32 v137, v130, v131
    v_mfma_f32_16x16x32_bf16 a[84:87], a[148:151], v[240:243], a[84:87]
    s_add_u32 s65, s3, s67
    v_cvt_pk_bf16_f32 v138, v132, v133
    v_mfma_f32_16x16x32_bf16 a[84:87], a[244:247], v[212:215], a[84:87]
    v_exp_f32 v188, v188
    v_mfma_f32_16x16x32_bf16 a[84:87], a[212:215], v[208:211], a[84:87]
    v_cvt_pk_bf16_f32 v139, v134, v135
    s_and_b32 s3, s47, 30
    buffer_store_dwordx4 v[136:139], v5, s[16:19], s68 offen offset:2048 sc1
    v_accvgpr_read_b32 v128, a56
    s_lshl_b32 s3, s3, 5
    v_accvgpr_read_b32 v129, a57
    v_perm_b32 v253, v187, v186, s43
    v_accvgpr_read_b32 v130, a58
    s_add_u32 s3, s3, s1
    v_accvgpr_read_b32 v131, a59
    v_accvgpr_read_b32 v132, a60
    v_and_or_b32 v9, v0, 32, v9
    v_mfma_f32_16x16x32_bf16 a[88:91], a[216:219], v[208:211], a[88:91]
    v_exp_f32 v189, v189
    v_mfma_f32_16x16x32_bf16 a[88:91], a[248:251], v[212:215], a[88:91]
    v_accvgpr_read_b32 v133, a61
    v_accvgpr_read_b32 v134, a62
    v_mfma_f32_16x16x32_bf16 a[88:91], a[152:155], v[240:243], a[88:91]
    v_add_u32 v9, s3, v9
    v_accvgpr_read_b32 v135, a63
    v_mfma_f32_16x16x32_bf16 a[88:91], a[184:187], v[244:247], a[88:91]
    v_mul_f32 v128, v61, v128
    v_lshlrev_b32 v44, 7, v9
    v_exp_f32 v190, v190
    v_mul_f32 v129, v61, v129
    v_mul_f32 v130, v61, v130
    v_add_u32 v44, 16842756, v44
    v_mul_f32 v131, v61, v131
    v_perm_b32 v254, v189, v188, s43
    s_lshl_b32 s3, s20, 2
    v_mul_f32 v132, v61, v132
    v_mul_f32 v133, v61, v133
    s_add_u32 s3, s3, 0x24000
    v_mfma_f32_16x16x32_bf16 a[92:95], a[188:191], v[244:247], a[92:95]
    v_mul_f32 v134, v61, v134
    v_mul_f32 v135, v61, v135
    v_mfma_f32_16x16x32_bf16 a[92:95], a[156:159], v[240:243], a[92:95]
    v_exp_f32 v191, v191
    v_mfma_f32_16x16x32_bf16 a[92:95], a[252:255], v[212:215], a[92:95]
    v_lshl_add_u32 v192, v3, 12, s3
    v_cvt_pk_bf16_f32 v140, v128, v129
    v_mfma_f32_16x16x32_bf16 a[92:95], a[220:223], v[208:211], a[92:95]
    v_cvt_pk_bf16_f32 v141, v130, v131
    s_add_u32 s3, s25, 0x24000
    v_cvt_pk_bf16_f32 v142, v132, v133
    v_perm_b32 v255, v191, v190, s43
    v_cvt_pk_bf16_f32 v143, v134, v135
    v_mov_b32 v193, s3
    buffer_store_dwordx4 v[140:143], v5, s[16:19], s68 offen offset:3072 sc1
    v_add_f32 v36, v36, v37
    v_rcp_f32 v62, v36
    v_smfmac_f32_16x16x64_bf16 v[40:43], v[24:27], v[216:223], v22
    v_accvgpr_read_b32 v128, a64
    v_accvgpr_read_b32 v129, a65
    v_smfmac_f32_16x16x64_bf16 v[40:43], v[24:27], v[248:255], v22
    v_accvgpr_read_b32 v130, a66
    v_accvgpr_read_b32 v131, a67
    v_accvgpr_read_b32 v132, a68
    v_accvgpr_read_b32 v133, a69
    v_accvgpr_read_b32 v134, a70
    v_accvgpr_read_b32 v135, a71
    v_mul_f32 v128, v62, v128
    v_mul_f32 v129, v62, v129
    s_nop 0
    v_mfma_f32_16x16x32_bf16 a[96:99], a[192:195], v[216:219], a[96:99]
    s_nop 0
    v_mfma_f32_16x16x32_bf16 a[96:99], a[224:227], v[220:223], a[96:99]
    v_add_f32 v40, v40, v41
    v_mfma_f32_16x16x32_bf16 a[96:99], a[128:131], v[248:251], a[96:99]
    v_rcp_f32 v63, v40
    v_mfma_f32_16x16x32_bf16 a[96:99], a[160:163], v[252:255], a[96:99]
    v_add_f32 v194, v28, v32
    v_add_f32 v195, v36, v40
    v_add_f32 v194, v194, v195
    v_cmp_ngt_f32 vcc, 0x5f800000, v194
    s_or_b32 s3, vcc_lo, vcc_hi
    v_mov_b32 v194, s3
    ds_write_b32 v192, v194
    v_mul_f32 v130, v62, v130
    v_mul_f32 v131, v62, v131
    v_mul_f32 v132, v62, v132
    v_mfma_f32_16x16x32_bf16 a[100:103], a[164:167], v[252:255], a[100:103]
    v_mul_f32 v133, v62, v133
    v_mul_f32 v134, v62, v134
    v_mfma_f32_16x16x32_bf16 a[100:103], a[132:135], v[248:251], a[100:103]
    v_mul_f32 v135, v62, v135
    v_cvt_pk_bf16_f32 v136, v128, v129
    v_mfma_f32_16x16x32_bf16 a[100:103], a[228:231], v[220:223], a[100:103]
    v_cvt_pk_bf16_f32 v137, v130, v131
    v_cvt_pk_bf16_f32 v138, v132, v133
    v_mfma_f32_16x16x32_bf16 a[100:103], a[196:199], v[216:219], a[100:103]
    v_cvt_pk_bf16_f32 v139, v134, v135
    buffer_store_dwordx4 v[136:139], v6, s[16:19], s68 offen offset:0 sc1
    v_accvgpr_read_b32 v128, a72
    v_accvgpr_read_b32 v129, a73
    v_accvgpr_read_b32 v130, a74
    v_accvgpr_read_b32 v131, a75
    v_accvgpr_read_b32 v132, a76
    v_accvgpr_read_b32 v133, a77
    v_accvgpr_read_b32 v134, a78
    v_mfma_f32_16x16x32_bf16 a[104:107], a[200:203], v[216:219], a[104:107]
    v_accvgpr_read_b32 v135, a79
    v_mul_f32 v128, v62, v128
    v_mfma_f32_16x16x32_bf16 a[104:107], a[232:235], v[220:223], a[104:107]
    v_mfma_f32_16x16x32_bf16 a[104:107], a[136:139], v[248:251], a[104:107]
    v_mfma_f32_16x16x32_bf16 a[104:107], a[168:171], v[252:255], a[104:107]
    s_waitcnt lgkmcnt(0)
    s_barrier
    ds_read_b128 v[196:199], v193
    v_mul_f32 v129, v62, v129
    v_mul_f32 v130, v62, v130
    v_mul_f32 v131, v62, v131
    v_mul_f32 v132, v62, v132
    v_mul_f32 v133, v62, v133
    v_mul_f32 v134, v62, v134
    v_mul_f32 v135, v62, v135
    v_cvt_pk_bf16_f32 v140, v128, v129
    v_mfma_f32_16x16x32_bf16 a[108:111], a[172:175], v[252:255], a[108:111]
    v_cvt_pk_bf16_f32 v141, v130, v131
    v_cvt_pk_bf16_f32 v142, v132, v133
    v_mfma_f32_16x16x32_bf16 a[108:111], a[140:143], v[248:251], a[108:111]
    v_cvt_pk_bf16_f32 v143, v134, v135
    v_mfma_f32_16x16x32_bf16 a[108:111], a[236:239], v[220:223], a[108:111]
    v_mfma_f32_16x16x32_bf16 a[108:111], a[204:207], v[216:219], a[108:111]
    buffer_store_dwordx4 v[140:143], v6, s[16:19], s68 offen offset:1024 sc1
    v_accvgpr_read_b32 v128, a80
    v_accvgpr_read_b32 v129, a81
    v_accvgpr_read_b32 v130, a82
    v_accvgpr_read_b32 v131, a83
    v_accvgpr_read_b32 v132, a84
    v_accvgpr_read_b32 v133, a85
    v_accvgpr_read_b32 v134, a86
    v_accvgpr_read_b32 v135, a87
    v_mul_f32 v128, v62, v128
    v_mfma_f32_16x16x32_bf16 a[112:115], a[208:211], v[216:219], a[112:115]
    v_mul_f32 v129, v62, v129
    s_waitcnt lgkmcnt(0)
    v_mfma_f32_16x16x32_bf16 a[112:115], a[240:243], v[220:223], a[112:115]
    v_or3_b32 v196, v196, v197, v198
    v_or_b32 v196, v196, v199
    v_mfma_f32_16x16x32_bf16 a[112:115], a[144:147], v[248:251], a[112:115]
    v_cmp_ne_u32 vcc, 0, v196
    s_cbranch_vccnz L_fallback
L_safe:
    v_mfma_f32_16x16x32_bf16 a[112:115], a[176:179], v[252:255], a[112:115]
    v_mul_f32 v130, v62, v130
    v_mul_f32 v131, v62, v131
    s_waitcnt vmcnt(46)
    v_mul_f32 v132, v62, v132
    v_mul_f32 v133, v62, v133
    v_mul_f32 v134, v62, v134
    ds_read_b64_tr_b16 v[64:65], v48 offset:0
    ds_read_b64_tr_b16 v[66:67], v48 offset:2048
    v_mul_f32 v135, v62, v135
    v_cvt_pk_bf16_f32 v136, v128, v129
    v_mfma_f32_16x16x32_bf16 a[116:119], a[180:183], v[252:255], a[116:119]
    v_cvt_pk_bf16_f32 v137, v130, v131
    v_mfma_f32_16x16x32_bf16 a[116:119], a[148:151], v[248:251], a[116:119]
    ds_read_b64_tr_b16 v[80:81], v49 offset:0
    ds_read_b64_tr_b16 v[82:83], v49 offset:2048
    v_mfma_f32_16x16x32_bf16 a[116:119], a[244:247], v[220:223], a[116:119]
    v_cvt_pk_bf16_f32 v138, v132, v133
    v_cvt_pk_bf16_f32 v139, v134, v135
    v_mfma_f32_16x16x32_bf16 a[116:119], a[212:215], v[216:219], a[116:119]
    buffer_store_dwordx4 v[136:139], v6, s[16:19], s68 offen offset:2048 sc1
    ds_read_b64_tr_b16 v[96:97], v50 offset:0
    ds_read_b64_tr_b16 v[98:99], v50 offset:2048
    v_accvgpr_read_b32 v128, a88
    v_accvgpr_read_b32 v129, a89
    v_accvgpr_read_b32 v130, a90
    ds_read_b64_tr_b16 v[112:113], v51 offset:0
    ds_read_b64_tr_b16 v[114:115], v51 offset:2048
    v_accvgpr_read_b32 v131, a91
    v_mfma_f32_16x16x32_bf16 a[120:123], a[216:219], v[216:219], a[120:123]
    v_accvgpr_read_b32 v132, a92
    v_accvgpr_read_b32 v133, a93
    v_mfma_f32_16x16x32_bf16 a[120:123], a[248:251], v[220:223], a[120:123]
    v_accvgpr_read_b32 v134, a94
    s_waitcnt vmcnt(39)
    v_mfma_f32_16x16x32_bf16 a[120:123], a[152:155], v[248:251], a[120:123]
    v_accvgpr_read_b32 v135, a95
    v_mul_f32 v128, v62, v128
    v_mfma_f32_16x16x32_bf16 a[120:123], a[184:187], v[252:255], a[120:123]
    v_mul_f32 v129, v62, v129
    ds_read_b64_tr_b16 v[68:69], v48 offset:16384
    ds_read_b64_tr_b16 v[70:71], v48 offset:18432
    v_mul_f32 v130, v62, v130
    v_mul_f32 v131, v62, v131
    v_mul_f32 v132, v62, v132
    ds_read_b64_tr_b16 v[84:85], v49 offset:16384
    ds_read_b64_tr_b16 v[86:87], v49 offset:18432
    v_mul_f32 v133, v62, v133
    v_mfma_f32_16x16x32_bf16 a[124:127], a[188:191], v[252:255], a[124:127]
    v_mul_f32 v134, v62, v134
    v_mul_f32 v135, v62, v135
    v_mfma_f32_16x16x32_bf16 a[124:127], a[156:159], v[248:251], a[124:127]
    ds_read_b64_tr_b16 v[100:101], v50 offset:16384
    ds_read_b64_tr_b16 v[102:103], v50 offset:18432
    v_mfma_f32_16x16x32_bf16 a[124:127], a[252:255], v[220:223], a[124:127]
    v_cvt_pk_bf16_f32 v140, v128, v129
    v_cvt_pk_bf16_f32 v141, v130, v131
    v_mfma_f32_16x16x32_bf16 a[124:127], a[220:223], v[216:219], a[124:127]
    v_cvt_pk_bf16_f32 v142, v132, v133
    ds_read_b64_tr_b16 v[116:117], v51 offset:16384
    ds_read_b64_tr_b16 v[118:119], v51 offset:18432
    v_cvt_pk_bf16_f32 v143, v134, v135
    buffer_store_dwordx4 v[140:143], v6, s[16:19], s68 offen offset:3072 sc1
    v_accvgpr_read_b32 v128, a96
    v_accvgpr_read_b32 v129, a97
    s_waitcnt vmcnt(36)
    v_accvgpr_read_b32 v130, a98
    v_accvgpr_read_b32 v131, a99
    v_accvgpr_read_b32 v132, a100
    ds_read_b64_tr_b16 v[72:73], v52 offset:16384
    ds_read_b64_tr_b16 v[74:75], v52 offset:18432
    v_accvgpr_read_b32 v133, a101
    v_accvgpr_read_b32 v134, a102
    v_accvgpr_read_b32 v135, a103
    v_pk_mul_f32 v[128:129], v[128:129], v[62:63] op_sel:[0,1] op_sel_hi:[1,1]
    ds_read_b64_tr_b16 v[88:89], v53 offset:16384
    ds_read_b64_tr_b16 v[90:91], v53 offset:18432
    v_pk_mul_f32 v[130:131], v[130:131], v[62:63] op_sel:[0,1] op_sel_hi:[1,1]
    v_pk_mul_f32 v[132:133], v[132:133], v[62:63] op_sel:[0,1] op_sel_hi:[1,1]
    v_pk_mul_f32 v[134:135], v[134:135], v[62:63] op_sel:[0,1] op_sel_hi:[1,1]
    ds_read_b64_tr_b16 v[104:105], v54 offset:16384
    ds_read_b64_tr_b16 v[106:107], v54 offset:18432
    v_cvt_pk_bf16_f32 v136, v128, v129
    v_cvt_pk_bf16_f32 v137, v130, v131
    v_cvt_pk_bf16_f32 v138, v132, v133
    ds_read_b64_tr_b16 v[120:121], v55 offset:16384
    ds_read_b64_tr_b16 v[122:123], v55 offset:18432
    v_cvt_pk_bf16_f32 v139, v134, v135
    buffer_store_dwordx4 v[136:139], v7, s[16:19], s68 offen offset:0 sc1
    v_accvgpr_read_b32 v128, a104
    v_accvgpr_read_b32 v129, a105
    s_waitcnt vmcnt(33)
    v_accvgpr_read_b32 v130, a106
    v_accvgpr_read_b32 v131, a107
    v_accvgpr_read_b32 v132, a108
    ds_read_b64_tr_b16 v[76:77], v48 offset:32768
    ds_read_b64_tr_b16 v[78:79], v48 offset:34816
    v_accvgpr_read_b32 v133, a109
    v_accvgpr_read_b32 v134, a110
    v_accvgpr_read_b32 v135, a111
    v_pk_mul_f32 v[128:129], v[128:129], v[62:63] op_sel:[0,1] op_sel_hi:[1,1]
    ds_read_b64_tr_b16 v[92:93], v49 offset:32768
    ds_read_b64_tr_b16 v[94:95], v49 offset:34816
    v_pk_mul_f32 v[130:131], v[130:131], v[62:63] op_sel:[0,1] op_sel_hi:[1,1]
    v_pk_mul_f32 v[132:133], v[132:133], v[62:63] op_sel:[0,1] op_sel_hi:[1,1]
    v_pk_mul_f32 v[134:135], v[134:135], v[62:63] op_sel:[0,1] op_sel_hi:[1,1]
    ds_read_b64_tr_b16 v[108:109], v50 offset:32768
    ds_read_b64_tr_b16 v[110:111], v50 offset:34816
    v_cvt_pk_bf16_f32 v140, v128, v129
    v_cvt_pk_bf16_f32 v141, v130, v131
    v_cvt_pk_bf16_f32 v142, v132, v133
    ds_read_b64_tr_b16 v[124:125], v51 offset:32768
    ds_read_b64_tr_b16 v[126:127], v51 offset:34816
    v_cvt_pk_bf16_f32 v143, v134, v135
    buffer_store_dwordx4 v[140:143], v7, s[16:19], s68 offen offset:1024 sc1
    v_accvgpr_read_b32 v128, a112
    v_accvgpr_read_b32 v129, a113
    s_waitcnt vmcnt(30)
    v_accvgpr_read_b32 v130, a114
    v_accvgpr_read_b32 v131, a115
    v_accvgpr_read_b32 v132, a116
    ds_read_b64_tr_b16 a[0:1], v52 offset:32768
    ds_read_b64_tr_b16 a[2:3], v52 offset:34816
    v_accvgpr_read_b32 v133, a117
    v_accvgpr_read_b32 v134, a118
    v_accvgpr_read_b32 v135, a119
    v_pk_mul_f32 v[128:129], v[128:129], v[62:63] op_sel:[0,1] op_sel_hi:[1,1]
    ds_read_b64_tr_b16 a[16:17], v53 offset:32768
    ds_read_b64_tr_b16 a[18:19], v53 offset:34816
    v_pk_mul_f32 v[130:131], v[130:131], v[62:63] op_sel:[0,1] op_sel_hi:[1,1]
    v_pk_mul_f32 v[132:133], v[132:133], v[62:63] op_sel:[0,1] op_sel_hi:[1,1]
    v_pk_mul_f32 v[134:135], v[134:135], v[62:63] op_sel:[0,1] op_sel_hi:[1,1]
    ds_read_b64_tr_b16 a[32:33], v54 offset:32768
    ds_read_b64_tr_b16 a[34:35], v54 offset:34816
    v_cvt_pk_bf16_f32 v136, v128, v129
    v_cvt_pk_bf16_f32 v137, v130, v131
    v_cvt_pk_bf16_f32 v138, v132, v133
    ds_read_b64_tr_b16 a[48:49], v55 offset:32768
    ds_read_b64_tr_b16 a[50:51], v55 offset:34816
    v_cvt_pk_bf16_f32 v139, v134, v135
    buffer_store_dwordx4 v[136:139], v7, s[16:19], s68 offen offset:2048 sc1
    v_accvgpr_read_b32 v128, a120
    v_accvgpr_read_b32 v129, a121
    s_waitcnt vmcnt(27)
    v_accvgpr_read_b32 v130, a122
    v_accvgpr_read_b32 v131, a123
    v_accvgpr_read_b32 v132, a124
    ds_read_b64_tr_b16 a[4:5], v48 offset:49152
    ds_read_b64_tr_b16 a[6:7], v48 offset:51200
    v_accvgpr_read_b32 v133, a125
    v_accvgpr_read_b32 v134, a126
    v_accvgpr_read_b32 v135, a127
    v_pk_mul_f32 v[128:129], v[128:129], v[62:63] op_sel:[0,1] op_sel_hi:[1,1]
    ds_read_b64_tr_b16 a[20:21], v49 offset:49152
    ds_read_b64_tr_b16 a[22:23], v49 offset:51200
    v_pk_mul_f32 v[130:131], v[130:131], v[62:63] op_sel:[0,1] op_sel_hi:[1,1]
    v_pk_mul_f32 v[132:133], v[132:133], v[62:63] op_sel:[0,1] op_sel_hi:[1,1]
    v_pk_mul_f32 v[134:135], v[134:135], v[62:63] op_sel:[0,1] op_sel_hi:[1,1]
    ds_read_b64_tr_b16 a[36:37], v50 offset:49152
    ds_read_b64_tr_b16 a[38:39], v50 offset:51200
    v_cvt_pk_bf16_f32 v140, v128, v129
    v_cvt_pk_bf16_f32 v141, v130, v131
    v_cvt_pk_bf16_f32 v142, v132, v133
    ds_read_b64_tr_b16 a[52:53], v51 offset:49152
    ds_read_b64_tr_b16 a[54:55], v51 offset:51200
    v_cvt_pk_bf16_f32 v143, v134, v135
    buffer_store_dwordx4 v[140:143], v7, s[16:19], s68 offen offset:3072 sc1
    s_add_u32 m0, s25, 65536
    s_nop 0
    buffer_load_dwordx4 v16, s[28:31], s35 offen offset:0 lds
    s_waitcnt vmcnt(24)
    v_cmp_ne_u32 vcc, s46, v153
    s_cbranch_vccnz L_sel2_retry
L_sel2_ok:
    v_and_b32 v152, 0xffff, v152
    v_mov_b32 v15, 0x200000
    v_readlane_b32 s4, v152, 0
    v_readlane_b32 s5, v152, 1
    buffer_load_dwordx4 v17, s[28:31], s35 offen offset:1024 lds
    v_readlane_b32 s6, v152, 2
    v_readlane_b32 s7, v152, 3
    v_readlane_b32 s42, v152, 4
    v_readlane_b32 s43, v152, 5
    v_readlane_b32 s48, v152, 6
    v_readlane_b32 s49, v152, 7
    v_cmp_eq_u32 vcc, s4, v12
    v_mov_b32 v10, 0
    buffer_load_dwordx4 v18, s[28:31], s35 offen offset:2048 lds
    v_cndmask_b32 v15, v15, v10, vcc
    v_cmp_eq_u32 vcc, s5, v12
    v_mov_b32 v10, 64
    s_nop 0
    v_cndmask_b32 v15, v15, v10, vcc
    v_cmp_eq_u32 vcc, s6, v12
    v_mov_b32 v10, 128
    s_nop 0
    v_cndmask_b32 v15, v15, v10, vcc
    v_cmp_eq_u32 vcc, s7, v12
    buffer_load_dwordx4 v19, s[28:31], s35 offen offset:3072 lds
    v_mov_b32 v10, 192
    v_cndmask_b32 v15, v15, v10, vcc
    v_cmp_eq_u32 vcc, s42, v12
    v_mov_b32 v10, 256
    s_nop 0
    v_cndmask_b32 v15, v15, v10, vcc
    v_cmp_eq_u32 vcc, s43, v12
    v_mov_b32 v10, 320
    s_nop 0
    v_cndmask_b32 v15, v15, v10, vcc
    s_add_u32 s35, s35, 0x8000
    s_add_u32 m0, s25, 147456
    s_nop 0
    buffer_load_dwordx4 v16, s[28:31], s35 offen offset:0 lds
    v_cmp_eq_u32 vcc, s48, v12
    v_mov_b32 v10, 384
    s_nop 0
    v_cndmask_b32 v15, v15, v10, vcc
    v_cmp_eq_u32 vcc, s49, v12
    v_mov_b32 v10, 448
    s_nop 0
    v_cndmask_b32 v15, v15, v10, vcc
    v_cmp_gt_u32 vcc, 0x1000, v15
    v_add_u32 v15, v15, v3
    buffer_load_dwordx4 v17, s[28:31], s35 offen offset:1024 lds
    v_lshlrev_b32 v15, 5, v15
    v_cndmask_b32 v11, 0, v13, vcc
    v_mov_b32 v10, 0x40000000
    v_cndmask_b32 v15, v10, v15, vcc
    s_lshl_b32 s67, s32, 8
    s_add_u32 s67, s67, 16826368
    v_mov_b32 v160, 0
    v_mov_b32 v161, 0
    buffer_load_dwordx4 v18, s[28:31], s35 offen offset:2048 lds
    v_mov_b32 v162, 0
    v_mov_b32 v164, 0
    v_mov_b32 v165, 0
    v_mov_b32 v166, 0
    v_mov_b32 v168, 0
    v_mov_b32 v169, 0
    v_mov_b32 v170, 0
    v_mov_b32 v172, 0
    buffer_load_dwordx4 v19, s[28:31], s35 offen offset:3072 lds
    v_mov_b32 v173, 0
    v_mov_b32 v174, 0
    s_cbranch_vccz L_noupd
    buffer_load_dwordx4 v[160:163], v15, s[16:19], s67 offen offset:0 sc1
    buffer_load_dwordx4 v[164:167], v15, s[16:19], s67 offen offset:16 sc1
    buffer_load_dwordx4 v[168:171], v15, s[16:19], s67 offen offset:128 sc1
    buffer_load_dwordx4 v[172:175], v15, s[16:19], s67 offen offset:144 sc1
L_noupd:
    s_waitcnt vmcnt(8)
    s_mov_b64 exec, 255
    buffer_store_dwordx4 v[12:15], v4, s[16:19], s69 offen sc1
    s_mov_b64 exec, -1
    s_waitcnt lgkmcnt(14)
    s_add_u32 s35, s35, 0x8000
    s_add_u32 m0, s25, 0
    s_nop 0
    buffer_load_dwordx4 v16, s[28:31], s35 offen offset:0 lds
    buffer_load_dwordx4 v17, s[28:31], s35 offen offset:1024 lds
    buffer_load_dwordx4 v18, s[28:31], s35 offen offset:2048 lds
    buffer_load_dwordx4 v19, s[28:31], s35 offen offset:3072 lds
    s_waitcnt lgkmcnt(14)
    s_add_u32 s35, s35, 0x8000
    s_add_u32 m0, s25, 16384
    s_nop 0
    buffer_load_dwordx4 v16, s[28:31], s35 offen offset:0 lds
    buffer_load_dwordx4 v17, s[28:31], s35 offen offset:1024 lds
    buffer_load_dwordx4 v18, s[28:31], s35 offen offset:2048 lds
    buffer_load_dwordx4 v19, s[28:31], s35 offen offset:3072 lds
    s_waitcnt vmcnt(41)
    ds_read_b64_tr_b16 a[8:9], v52 offset:49152
    ds_read_b64_tr_b16 a[10:11], v52 offset:51200
    ds_read_b64_tr_b16 a[24:25], v53 offset:49152
    ds_read_b64_tr_b16 a[26:27], v53 offset:51200
    ds_read_b64_tr_b16 a[40:41], v54 offset:49152
    ds_read_b64_tr_b16 a[42:43], v54 offset:51200
    ds_read_b64_tr_b16 a[56:57], v55 offset:49152
    ds_read_b64_tr_b16 a[58:59], v55 offset:51200
    s_waitcnt lgkmcnt(14)
    s_add_u32 s35, s35, 0x8000
    s_add_u32 m0, s25, 81920
    s_nop 0
    buffer_load_dwordx4 v16, s[28:31], s35 offen offset:0 lds
    buffer_load_dwordx4 v17, s[28:31], s35 offen offset:1024 lds
    buffer_load_dwordx4 v18, s[28:31], s35 offen offset:2048 lds
    buffer_load_dwordx4 v19, s[28:31], s35 offen offset:3072 lds
    buffer_load_dword v2, v44, s[16:19], 0 offen sc1
    s_waitcnt vmcnt(35)
    ds_read_b64_tr_b16 a[12:13], v56 offset:0
    ds_read_b64_tr_b16 a[14:15], v56 offset:2048
    ds_read_b64_tr_b16 a[28:29], v57 offset:0
    ds_read_b64_tr_b16 a[30:31], v57 offset:2048
    ds_read_b64_tr_b16 a[44:45], v58 offset:0
    ds_read_b64_tr_b16 a[46:47], v58 offset:2048
    ds_read_b64_tr_b16 a[60:61], v59 offset:0
    ds_read_b64_tr_b16 a[62:63], v59 offset:2048
    s_waitcnt lgkmcnt(14)
    s_add_u32 s35, s35, 0x8000
    s_add_u32 m0, s25, 32768
    s_nop 0
    buffer_load_dwordx4 v16, s[28:31], s35 offen offset:0 lds
    buffer_load_dwordx4 v17, s[28:31], s35 offen offset:1024 lds
    buffer_load_dwordx4 v18, s[28:31], s35 offen offset:2048 lds
    buffer_load_dwordx4 v19, s[28:31], s35 offen offset:3072 lds
    s_waitcnt vmcnt(22)
    ds_read_b64_tr_b16 a[192:193], v52 offset:0
    ds_read_b64_tr_b16 a[194:195], v52 offset:2048
    ds_read_b64_tr_b16 a[208:209], v53 offset:0
    ds_read_b64_tr_b16 a[210:211], v53 offset:2048
    ds_read_b64_tr_b16 a[224:225], v54 offset:0
    ds_read_b64_tr_b16 a[226:227], v54 offset:2048
    ds_read_b64_tr_b16 a[240:241], v55 offset:0
    ds_read_b64_tr_b16 a[242:243], v55 offset:2048
    s_waitcnt lgkmcnt(14)
    s_add_u32 s35, s35, 0x8000
    s_add_u32 m0, s25, 98304
    s_nop 0
    buffer_load_dwordx4 v16, s[28:31], s35 offen offset:0 lds
    buffer_load_dwordx4 v17, s[28:31], s35 offen offset:1024 lds
    buffer_load_dwordx4 v18, s[28:31], s35 offen offset:2048 lds
    buffer_load_dwordx4 v19, s[28:31], s35 offen offset:3072 lds
    s_waitcnt vmcnt(22)
    ds_read_b64_tr_b16 a[196:197], v56 offset:16384
    ds_read_b64_tr_b16 a[198:199], v56 offset:18432
    ds_read_b64_tr_b16 a[212:213], v57 offset:16384
    ds_read_b64_tr_b16 a[214:215], v57 offset:18432
    ds_read_b64_tr_b16 a[228:229], v58 offset:16384
    ds_read_b64_tr_b16 a[230:231], v58 offset:18432
    ds_read_b64_tr_b16 a[244:245], v59 offset:16384
    ds_read_b64_tr_b16 a[246:247], v59 offset:18432
    s_waitcnt lgkmcnt(14)
    s_add_u32 s35, s35, 0x8000
    s_add_u32 m0, s25, 49152
    s_nop 0
    buffer_load_dwordx4 v16, s[28:31], s35 offen offset:0 lds
    buffer_load_dwordx4 v17, s[28:31], s35 offen offset:1024 lds
    buffer_load_dwordx4 v18, s[28:31], s35 offen offset:2048 lds
    buffer_load_dwordx4 v19, s[28:31], s35 offen offset:3072 lds
    s_add_u32 s35, s35, 0x8000
    s_waitcnt vmcnt(21)
    ds_read_b64_tr_b16 a[200:201], v48 offset:0
    ds_read_b64_tr_b16 a[202:203], v48 offset:2048
    ds_read_b64_tr_b16 a[216:217], v49 offset:0
    ds_read_b64_tr_b16 a[218:219], v49 offset:2048
    ds_read_b64_tr_b16 a[232:233], v50 offset:0
    ds_read_b64_tr_b16 a[234:235], v50 offset:2048
    ds_read_b64_tr_b16 a[248:249], v51 offset:0
    ds_read_b64_tr_b16 a[250:251], v51 offset:2048
    s_waitcnt vmcnt(12)
L_oflag:
    v_cmp_ne_u32 vcc, s46, v2
    s_cbranch_vccz L_oflag_ok
    s_cmp_eq_u32 s33, 0
    s_cbranch_scc1 L_oflag_ok
    s_sub_u32 s33, s33, 1
    buffer_load_dword v2, v44, s[16:19], 0 offen sc1
    s_waitcnt vmcnt(0)
    s_branch L_oflag
L_oflag_ok:
    buffer_load_dwordx4 a[64:67], v4, s[16:19], s63 offen offset:0 sc1
    buffer_load_dwordx4 a[68:71], v4, s[16:19], s63 offen offset:1024 sc1
    buffer_load_dwordx4 a[72:75], v4, s[16:19], s63 offen offset:2048 sc1
    buffer_load_dwordx4 a[76:79], v4, s[16:19], s63 offen offset:3072 sc1
    s_add_u32 s63, s63, 4096
    s_waitcnt vmcnt(21)
    ds_read_b64_tr_b16 a[204:205], v48 offset:16384
    ds_read_b64_tr_b16 a[206:207], v48 offset:18432
    ds_read_b64_tr_b16 a[220:221], v49 offset:16384
    ds_read_b64_tr_b16 a[222:223], v49 offset:18432
    ds_read_b64_tr_b16 a[236:237], v50 offset:16384
    ds_read_b64_tr_b16 a[238:239], v50 offset:18432
    ds_read_b64_tr_b16 a[252:253], v51 offset:16384
    ds_read_b64_tr_b16 a[254:255], v51 offset:18432
    buffer_load_dwordx4 a[80:83], v4, s[16:19], s63 offen offset:0 sc1
    buffer_load_dwordx4 a[84:87], v4, s[16:19], s63 offen offset:1024 sc1
    buffer_load_dwordx4 a[88:91], v4, s[16:19], s63 offen offset:2048 sc1
    buffer_load_dwordx4 a[92:95], v4, s[16:19], s63 offen offset:3072 sc1
    s_add_u32 s63, s63, 4096
    s_waitcnt vmcnt(21)
    ds_read_b64_tr_b16 v[192:193], v52 offset:16384
    ds_read_b64_tr_b16 v[194:195], v52 offset:18432
    ds_read_b64_tr_b16 v[208:209], v53 offset:16384
    ds_read_b64_tr_b16 v[210:211], v53 offset:18432
    ds_read_b64_tr_b16 v[224:225], v54 offset:16384
    ds_read_b64_tr_b16 v[226:227], v54 offset:18432
    ds_read_b64_tr_b16 v[240:241], v55 offset:16384
    ds_read_b64_tr_b16 v[242:243], v55 offset:18432
    buffer_load_dwordx4 a[96:99], v4, s[16:19], s63 offen offset:0 sc1
    buffer_load_dwordx4 a[100:103], v4, s[16:19], s63 offen offset:1024 sc1
    buffer_load_dwordx4 a[104:107], v4, s[16:19], s63 offen offset:2048 sc1
    buffer_load_dwordx4 a[108:111], v4, s[16:19], s63 offen offset:3072 sc1
    s_add_u32 s63, s63, 4096
    s_waitcnt vmcnt(20)
    ds_read_b64_tr_b16 v[196:197], v48 offset:32768
    ds_read_b64_tr_b16 v[198:199], v48 offset:34816
    ds_read_b64_tr_b16 v[212:213], v49 offset:32768
    ds_read_b64_tr_b16 v[214:215], v49 offset:34816
    ds_read_b64_tr_b16 v[228:229], v50 offset:32768
    ds_read_b64_tr_b16 v[230:231], v50 offset:34816
    ds_read_b64_tr_b16 v[244:245], v51 offset:32768
    ds_read_b64_tr_b16 v[246:247], v51 offset:34816
    buffer_load_dwordx4 a[112:115], v4, s[16:19], s63 offen offset:0 sc1
    buffer_load_dwordx4 a[116:119], v4, s[16:19], s63 offen offset:1024 sc1
    buffer_load_dwordx4 a[120:123], v4, s[16:19], s63 offen offset:2048 sc1
    buffer_load_dwordx4 a[124:127], v4, s[16:19], s63 offen offset:3072 sc1
    s_add_u32 s63, s63, 155648
    s_waitcnt vmcnt(20)
    ds_read_b64_tr_b16 v[200:201], v52 offset:32768
    ds_read_b64_tr_b16 v[202:203], v52 offset:34816
    ds_read_b64_tr_b16 v[216:217], v53 offset:32768
    ds_read_b64_tr_b16 v[218:219], v53 offset:34816
    ds_read_b64_tr_b16 v[232:233], v54 offset:32768
    ds_read_b64_tr_b16 v[234:235], v54 offset:34816
    ds_read_b64_tr_b16 v[248:249], v55 offset:32768
    ds_read_b64_tr_b16 v[250:251], v55 offset:34816
    buffer_load_dwordx4 a[160:163], v4, s[16:19], s63 offen offset:0 sc1
    buffer_load_dwordx4 a[164:167], v4, s[16:19], s63 offen offset:1024 sc1
    buffer_load_dwordx4 a[168:171], v4, s[16:19], s63 offen offset:2048 sc1
    buffer_load_dwordx4 a[172:175], v4, s[16:19], s63 offen offset:3072 sc1
    s_add_u32 s63, s63, 4096
    s_waitcnt vmcnt(20)
    ds_read_b64_tr_b16 v[204:205], v48 offset:49152
    ds_read_b64_tr_b16 v[206:207], v48 offset:51200
    ds_read_b64_tr_b16 v[220:221], v49 offset:49152
    ds_read_b64_tr_b16 v[222:223], v49 offset:51200
    ds_read_b64_tr_b16 v[236:237], v50 offset:49152
    ds_read_b64_tr_b16 v[238:239], v50 offset:51200
    ds_read_b64_tr_b16 v[252:253], v51 offset:49152
    ds_read_b64_tr_b16 v[254:255], v51 offset:51200
    s_waitcnt vmcnt(16) lgkmcnt(14)
    v_mfma_f32_16x16x32_bf16 a[128:131], v[64:67], a[64:67], 0
    v_and_b32 v32, 32, v0
    v_lshlrev_b32 v32, 1, v32
    v_mfma_f32_16x16x32_bf16 a[128:131], v[68:71], a[68:71], a[128:131]
    v_xor_b32 v32, v32, v4
    v_add_u32 v32, s25, v32
    v_mfma_f32_16x16x32_bf16 a[128:131], v[72:75], a[72:75], a[128:131]
    v_xor_b32 v33, 1152, v32
    v_xor_b32 v34, 2048, v32
    v_mfma_f32_16x16x32_bf16 a[128:131], v[76:79], a[76:79], a[128:131]
    buffer_load_dwordx4 a[176:179], v4, s[16:19], s63 offen offset:0 sc1
    v_mfma_f32_16x16x32_bf16 a[132:135], v[92:95], a[76:79], 0
    v_xor_b32 v35, 3200, v32
    v_lshrrev_b32 v31, 2, v0
    v_mfma_f32_16x16x32_bf16 a[132:135], v[88:91], a[72:75], a[132:135]
    v_lshlrev_b32 v30, 2, v3
    v_xor_b32 v31, v31, v30
    v_mfma_f32_16x16x32_bf16 a[132:135], v[84:87], a[68:71], a[132:135]
    v_lshlrev_b32 v31, 4, v31
    v_lshl_add_u32 v31, v3, 9, v31
    v_mfma_f32_16x16x32_bf16 a[132:135], v[80:83], a[64:67], a[132:135]
    buffer_load_dwordx4 a[180:183], v4, s[16:19], s63 offen offset:1024 sc1
    v_mfma_f32_16x16x32_bf16 a[136:139], v[96:99], a[64:67], 0
    s_lshl_b32 s3, s20, 14
    v_add_u32 v31, s3, v31
    v_mov_b32 v29, 0xffffff00
    v_mfma_f32_16x16x32_bf16 a[136:139], v[100:103], a[68:71], a[136:139]
    s_bfe_u32 s4, s46, 0x80000
    s_bfe_u32 s5, s46, 0x80008
    s_bfe_u32 s6, s46, 0x80010
    v_mfma_f32_16x16x32_bf16 a[136:139], v[104:107], a[72:75], a[136:139]
    s_bfe_u32 s7, s46, 0x80018
    s_lshl_b32 s42, s2, 14
    s_add_u32 s42, s42, s25
    v_mfma_f32_16x16x32_bf16 a[136:139], v[108:111], a[76:79], a[136:139]
    buffer_load_dwordx4 a[184:187], v4, s[16:19], s63 offen offset:2048 sc1
    v_mfma_f32_16x16x32_bf16 a[140:143], v[124:127], a[76:79], 0
    s_add_u32 s42, s42, 25165824
    s_xor_b32 s43, s42, 0x10000
    v_xor_b32 v10, s46, v47
    v_mfma_f32_16x16x32_bf16 a[140:143], v[120:123], a[72:75], a[140:143]
    v_bitop3_b32 v10, v10, v162, v11 bitop3:0xf6
    v_bitop3_b32 v10, v10, v166, v11 bitop3:0xf6
    v_mfma_f32_16x16x32_bf16 a[140:143], v[116:119], a[68:71], a[140:143]
    v_bitop3_b32 v10, v10, v170, v11 bitop3:0xf6
    v_bitop3_b32 v10, v10, v174, v11 bitop3:0xf6
    v_mfma_f32_16x16x32_bf16 a[140:143], v[112:115], a[64:67], a[140:143]
    buffer_load_dwordx4 a[188:191], v4, s[16:19], s63 offen offset:3072 sc1
    s_add_u32 s63, s63, 4096
    s_waitcnt vmcnt(16) lgkmcnt(14)
    v_mfma_f32_16x16x32_bf16 a[128:131], a[0:3], a[80:83], a[128:131]
    v_cmp_ne_u32 vcc, 0, v10
    s_cbranch_vccnz L_stf_retry
L_stf_ok:
    v_mfma_f32_16x16x32_bf16 a[128:131], a[4:7], a[84:87], a[128:131]
    v_and_b32 v47, 0xffff0000, v46
    v_lshlrev_b32 v46, 16, v46
    v_mfma_f32_16x16x32_bf16 a[128:131], a[8:11], a[88:91], a[128:131]
    v_rcp_f32 v47, v47
    v_mfma_f32_16x16x32_bf16 a[128:131], a[12:15], a[92:95], a[128:131]
    buffer_load_dwordx4 a[64:67], v4, s[16:19], s63 offen offset:0 sc1
    v_mfma_f32_16x16x32_bf16 a[132:135], a[28:31], a[92:95], a[132:135]
    v_lshlrev_b32 v36, 16, v144
    v_and_b32 v37, 0xffff0000, v144
    v_mfma_f32_16x16x32_bf16 a[132:135], a[24:27], a[88:91], a[132:135]
    v_lshlrev_b32 v38, 16, v145
    v_and_b32 v39, 0xffff0000, v145
    v_mfma_f32_16x16x32_bf16 a[132:135], a[20:23], a[84:87], a[132:135]
    v_lshlrev_b32 v40, 16, v146
    v_and_b32 v41, 0xffff0000, v146
    v_mfma_f32_16x16x32_bf16 a[132:135], a[16:19], a[80:83], a[132:135]
    buffer_load_dwordx4 a[68:71], v4, s[16:19], s63 offen offset:1024 sc1
    v_mfma_f32_16x16x32_bf16 a[136:139], a[32:35], a[80:83], a[136:139]
    v_lshlrev_b32 v42, 16, v147
    v_and_b32 v43, 0xffff0000, v147
    v_mfma_f32_16x16x32_bf16 a[136:139], a[36:39], a[84:87], a[136:139]
    v_sub_f32 v36, v36, v46
    v_sub_f32 v37, v37, v46
    v_mfma_f32_16x16x32_bf16 a[136:139], a[40:43], a[88:91], a[136:139]
    v_sub_f32 v38, v38, v46
    v_sub_f32 v39, v39, v46
    v_mfma_f32_16x16x32_bf16 a[136:139], a[44:47], a[92:95], a[136:139]
    buffer_load_dwordx4 a[72:75], v4, s[16:19], s63 offen offset:2048 sc1
    v_mfma_f32_16x16x32_bf16 a[140:143], a[60:63], a[92:95], a[140:143]
    v_sub_f32 v40, v40, v46
    v_sub_f32 v41, v41, v46
    v_mfma_f32_16x16x32_bf16 a[140:143], a[56:59], a[88:91], a[140:143]
    v_sub_f32 v42, v42, v46
    v_sub_f32 v43, v43, v46
    v_mfma_f32_16x16x32_bf16 a[140:143], a[52:55], a[84:87], a[140:143]
    v_cvt_pk_bf16_f32 v8, v36, v37
    v_cvt_pk_bf16_f32 v9, v38, v39
    v_mfma_f32_16x16x32_bf16 a[140:143], a[48:51], a[80:83], a[140:143]
    buffer_load_dwordx4 a[76:79], v4, s[16:19], s63 offen offset:3072 sc1
    s_add_u32 s63, s63, 4096
    s_waitcnt vmcnt(16) lgkmcnt(14)
    v_mfma_f32_16x16x32_bf16 a[128:131], a[192:195], a[96:99], a[128:131]
    v_cvt_pk_bf16_f32 v10, v40, v41
    v_cvt_pk_bf16_f32 v11, v42, v43
    v_mfma_f32_16x16x32_bf16 a[128:131], a[196:199], a[100:103], a[128:131]
    v_lshlrev_b32 v36, 16, v8
    v_and_b32 v37, 0xffff0000, v8
    v_mfma_f32_16x16x32_bf16 a[128:131], a[200:203], a[104:107], a[128:131]
    v_lshlrev_b32 v38, 16, v9
    v_and_b32 v39, 0xffff0000, v9
    v_mfma_f32_16x16x32_bf16 a[128:131], a[204:207], a[108:111], a[128:131]
    buffer_load_dwordx4 a[80:83], v4, s[16:19], s63 offen offset:0 sc1
    v_mfma_f32_16x16x32_bf16 a[132:135], a[220:223], a[108:111], a[132:135]
    v_lshlrev_b32 v40, 16, v10
    v_and_b32 v41, 0xffff0000, v10
    v_mfma_f32_16x16x32_bf16 a[132:135], a[216:219], a[104:107], a[132:135]
    v_lshlrev_b32 v42, 16, v11
    v_and_b32 v43, 0xffff0000, v11
    v_mfma_f32_16x16x32_bf16 a[132:135], a[212:215], a[100:103], a[132:135]
    v_mul_f32 v36, v36, v47
    v_mul_f32 v37, v37, v47
    v_mfma_f32_16x16x32_bf16 a[132:135], a[208:211], a[96:99], a[132:135]
    buffer_load_dwordx4 a[84:87], v4, s[16:19], s63 offen offset:1024 sc1
    v_mfma_f32_16x16x32_bf16 a[136:139], a[224:227], a[96:99], a[136:139]
    v_mul_f32 v38, v38, v47
    v_mul_f32 v39, v39, v47
    v_mfma_f32_16x16x32_bf16 a[136:139], a[228:231], a[100:103], a[136:139]
    v_mul_f32 v40, v40, v47
    v_mul_f32 v41, v41, v47
    v_mfma_f32_16x16x32_bf16 a[136:139], a[232:235], a[104:107], a[136:139]
    v_mul_f32 v42, v42, v47
    v_mul_f32 v43, v43, v47
    v_mfma_f32_16x16x32_bf16 a[136:139], a[236:239], a[108:111], a[136:139]
    buffer_load_dwordx4 a[88:91], v4, s[16:19], s63 offen offset:2048 sc1
    v_mfma_f32_16x16x32_bf16 a[140:143], a[252:255], a[108:111], a[140:143]
    v_cvt_pk_bf16_f32 v8, v36, v37
    v_cvt_pk_bf16_f32 v9, v38, v39
    v_mfma_f32_16x16x32_bf16 a[140:143], a[248:251], a[104:107], a[140:143]
    v_cvt_pk_bf16_f32 v10, v40, v41
    v_cvt_pk_bf16_f32 v11, v42, v43
    v_mfma_f32_16x16x32_bf16 a[140:143], a[244:247], a[100:103], a[140:143]
    v_lshlrev_b32 v36, 16, v8
    v_and_b32 v37, 0xffff0000, v8
    v_mfma_f32_16x16x32_bf16 a[140:143], a[240:243], a[96:99], a[140:143]
    buffer_load_dwordx4 a[92:95], v4, s[16:19], s63 offen offset:3072 sc1
    s_add_u32 s63, s63, 155648
    s_waitcnt vmcnt(16) lgkmcnt(0)
    v_mfma_f32_16x16x32_bf16 a[128:131], v[192:195], a[112:115], a[128:131]
    v_lshlrev_b32 v38, 16, v9
    v_and_b32 v39, 0xffff0000, v9
    v_mfma_f32_16x16x32_bf16 a[128:131], v[196:199], a[116:119], a[128:131]
    v_lshlrev_b32 v40, 16, v10
    v_and_b32 v41, 0xffff0000, v10
    v_mfma_f32_16x16x32_bf16 a[128:131], v[200:203], a[120:123], a[128:131]
    v_lshlrev_b32 v42, 16, v11
    v_and_b32 v43, 0xffff0000, v11
    v_mfma_f32_16x16x32_bf16 a[128:131], v[204:207], a[124:127], a[128:131]
    buffer_load_dwordx4 a[96:99], v4, s[16:19], s63 offen offset:0 sc1
    v_mfma_f32_16x16x32_bf16 a[132:135], v[220:223], a[124:127], a[132:135]
    v_lshlrev_b32 v8, 16, v160
    v_and_b32 v9, 0xffff0000, v160
    v_mfma_f32_16x16x32_bf16 a[132:135], v[216:219], a[120:123], a[132:135]
    v_lshlrev_b32 v10, 16, v161
    v_and_b32 v11, 0xffff0000, v161
    v_mfma_f32_16x16x32_bf16 a[132:135], v[212:215], a[116:119], a[132:135]
    v_lshlrev_b32 v12, 16, v164
    v_and_b32 v13, 0xffff0000, v164
    v_mfma_f32_16x16x32_bf16 a[132:135], v[208:211], a[112:115], a[132:135]
    buffer_load_dwordx4 a[100:103], v4, s[16:19], s63 offen offset:1024 sc1
    v_mfma_f32_16x16x32_bf16 a[136:139], v[224:227], a[112:115], a[136:139]
    v_lshlrev_b32 v14, 16, v165
    v_and_b32 v15, 0xffff0000, v165
    v_mfma_f32_16x16x32_bf16 a[136:139], v[228:231], a[116:119], a[136:139]
    v_add_f32 v36, v36, v8
    v_add_f32 v37, v37, v9
    v_mfma_f32_16x16x32_bf16 a[136:139], v[232:235], a[120:123], a[136:139]
    v_add_f32 v38, v38, v10
    v_add_f32 v39, v39, v11
    v_mfma_f32_16x16x32_bf16 a[136:139], v[236:239], a[124:127], a[136:139]
    buffer_load_dwordx4 a[104:107], v4, s[16:19], s63 offen offset:2048 sc1
    v_mfma_f32_16x16x32_bf16 a[140:143], v[252:255], a[124:127], a[140:143]
    v_add_f32 v40, v40, v12
    v_add_f32 v41, v41, v13
    v_mfma_f32_16x16x32_bf16 a[140:143], v[248:251], a[120:123], a[140:143]
    v_add_f32 v42, v42, v14
    v_add_f32 v43, v43, v15
    v_mfma_f32_16x16x32_bf16 a[140:143], v[244:247], a[116:119], a[140:143]
    v_cvt_pk_bf16_f32 v8, v36, v37
    v_cvt_pk_bf16_f32 v9, v38, v39
    v_mfma_f32_16x16x32_bf16 a[140:143], v[240:243], a[112:115], a[140:143]
    buffer_load_dwordx4 a[108:111], v4, s[16:19], s63 offen offset:3072 sc1
    s_add_u32 s63, s63, 4096
    s_waitcnt vmcnt(16)
    v_mfma_f32_16x16x32_bf16 a[144:147], v[64:67], a[160:163], 0
    v_cvt_pk_bf16_f32 v10, v40, v41
    v_cvt_pk_bf16_f32 v11, v42, v43
    v_mfma_f32_16x16x32_bf16 a[144:147], v[68:71], a[164:167], a[144:147]
    v_lshlrev_b32 v36, 16, v8
    v_and_b32 v37, 0xffff0000, v8
    v_mfma_f32_16x16x32_bf16 a[144:147], v[72:75], a[168:171], a[144:147]
    v_lshlrev_b32 v38, 16, v9
    v_and_b32 v39, 0xffff0000, v9
    v_mfma_f32_16x16x32_bf16 a[144:147], v[76:79], a[172:175], a[144:147]
    ds_write_b128 v32, a[128:131] offset:0
    buffer_load_dwordx4 a[112:115], v4, s[16:19], s63 offen offset:0 sc1
    v_mfma_f32_16x16x32_bf16 a[148:151], v[92:95], a[172:175], 0
    v_lshlrev_b32 v40, 16, v10
    v_and_b32 v41, 0xffff0000, v10
    v_mfma_f32_16x16x32_bf16 a[148:151], v[88:91], a[168:171], a[148:151]
    v_lshlrev_b32 v42, 16, v11
    v_and_b32 v43, 0xffff0000, v11
    v_mfma_f32_16x16x32_bf16 a[148:151], v[84:87], a[164:167], a[148:151]
    v_mul_f32 v8, 0xbfb8aa3b, v36
    v_mul_f32 v9, 0xbfb8aa3b, v37
    v_mfma_f32_16x16x32_bf16 a[148:151], v[80:83], a[160:163], a[148:151]
    ds_write_b128 v33, a[132:135] offset:0
    buffer_load_dwordx4 a[116:119], v4, s[16:19], s63 offen offset:1024 sc1
    v_mfma_f32_16x16x32_bf16 a[152:155], v[96:99], a[160:163], 0
    v_mul_f32 v10, 0xbfb8aa3b, v38
    v_mul_f32 v11, 0xbfb8aa3b, v39
    v_mfma_f32_16x16x32_bf16 a[152:155], v[100:103], a[164:167], a[152:155]
    v_mul_f32 v12, 0xbfb8aa3b, v40
    v_mul_f32 v13, 0xbfb8aa3b, v41
    v_mfma_f32_16x16x32_bf16 a[152:155], v[104:107], a[168:171], a[152:155]
    v_mul_f32 v14, 0xbfb8aa3b, v42
    v_mul_f32 v15, 0xbfb8aa3b, v43
    v_mfma_f32_16x16x32_bf16 a[152:155], v[108:111], a[172:175], a[152:155]
    ds_write_b128 v34, a[136:139] offset:0
    buffer_load_dwordx4 a[120:123], v4, s[16:19], s63 offen offset:2048 sc1
    v_mfma_f32_16x16x32_bf16 a[156:159], v[124:127], a[172:175], 0
    v_exp_f32 v8, v8
    v_mfma_f32_16x16x32_bf16 a[156:159], v[120:123], a[168:171], a[156:159]
    v_exp_f32 v9, v9
    v_mfma_f32_16x16x32_bf16 a[156:159], v[116:119], a[164:167], a[156:159]
    v_exp_f32 v10, v10
    v_mfma_f32_16x16x32_bf16 a[156:159], v[112:115], a[160:163], a[156:159]
    ds_write_b128 v35, a[140:143] offset:0
    buffer_load_dwordx4 a[124:127], v4, s[16:19], s63 offen offset:3072 sc1
    s_add_u32 s63, s63, 4096
    s_waitcnt vmcnt(16)
    v_mfma_f32_16x16x32_bf16 a[144:147], a[0:3], a[176:179], a[144:147]
    v_exp_f32 v11, v11
    v_mfma_f32_16x16x32_bf16 a[144:147], a[4:7], a[180:183], a[144:147]
    v_exp_f32 v12, v12
    v_mfma_f32_16x16x32_bf16 a[144:147], a[8:11], a[184:187], a[144:147]
    v_exp_f32 v13, v13
    v_mfma_f32_16x16x32_bf16 a[144:147], a[12:15], a[188:191], a[144:147]
    buffer_load_dwordx4 a[160:163], v4, s[16:19], s63 offen offset:0 sc1
    v_mfma_f32_16x16x32_bf16 a[148:151], a[28:31], a[188:191], a[148:151]
    v_exp_f32 v14, v14
    v_mfma_f32_16x16x32_bf16 a[148:151], a[24:27], a[184:187], a[148:151]
    v_exp_f32 v15, v15
    v_mfma_f32_16x16x32_bf16 a[148:151], a[20:23], a[180:183], a[148:151]
    v_add_f32 v8, 1.0, v8
    v_add_f32 v9, 1.0, v9
    v_mfma_f32_16x16x32_bf16 a[148:151], a[16:19], a[176:179], a[148:151]
    buffer_load_dwordx4 a[164:167], v4, s[16:19], s63 offen offset:1024 sc1
    v_mfma_f32_16x16x32_bf16 a[152:155], a[32:35], a[176:179], a[152:155]
    v_add_f32 v10, 1.0, v10
    v_add_f32 v11, 1.0, v11
    v_mfma_f32_16x16x32_bf16 a[152:155], a[36:39], a[180:183], a[152:155]
    v_add_f32 v12, 1.0, v12
    v_add_f32 v13, 1.0, v13
    v_mfma_f32_16x16x32_bf16 a[152:155], a[40:43], a[184:187], a[152:155]
    v_add_f32 v14, 1.0, v14
    v_add_f32 v15, 1.0, v15
    v_mfma_f32_16x16x32_bf16 a[152:155], a[44:47], a[188:191], a[152:155]
    buffer_load_dwordx4 a[168:171], v4, s[16:19], s63 offen offset:2048 sc1
    v_mfma_f32_16x16x32_bf16 a[156:159], a[60:63], a[188:191], a[156:159]
    v_rcp_f32 v8, v8
    v_mfma_f32_16x16x32_bf16 a[156:159], a[56:59], a[184:187], a[156:159]
    v_rcp_f32 v9, v9
    v_mfma_f32_16x16x32_bf16 a[156:159], a[52:55], a[180:183], a[156:159]
    v_rcp_f32 v10, v10
    v_mfma_f32_16x16x32_bf16 a[156:159], a[48:51], a[176:179], a[156:159]
    buffer_load_dwordx4 a[172:175], v4, s[16:19], s63 offen offset:3072 sc1
    s_add_u32 s63, s63, 4096
    s_waitcnt vmcnt(16)
    v_mfma_f32_16x16x32_bf16 a[144:147], a[192:195], a[64:67], a[144:147]
    v_rcp_f32 v11, v11
    v_mfma_f32_16x16x32_bf16 a[144:147], a[196:199], a[68:71], a[144:147]
    v_rcp_f32 v12, v12
    v_mfma_f32_16x16x32_bf16 a[144:147], a[200:203], a[72:75], a[144:147]
    v_rcp_f32 v13, v13
    v_mfma_f32_16x16x32_bf16 a[144:147], a[204:207], a[76:79], a[144:147]
    buffer_load_dwordx4 a[176:179], v4, s[16:19], s63 offen offset:0 sc1
    v_mfma_f32_16x16x32_bf16 a[148:151], a[220:223], a[76:79], a[148:151]
    v_rcp_f32 v14, v14
    v_mfma_f32_16x16x32_bf16 a[148:151], a[216:219], a[72:75], a[148:151]
    v_rcp_f32 v15, v15
    v_mfma_f32_16x16x32_bf16 a[148:151], a[212:215], a[68:71], a[148:151]
    v_mul_f32 v36, v36, v8
    v_mul_f32 v37, v37, v9
    v_mfma_f32_16x16x32_bf16 a[148:151], a[208:211], a[64:67], a[148:151]
    buffer_load_dwordx4 a[180:183], v4, s[16:19], s63 offen offset:1024 sc1
    v_mfma_f32_16x16x32_bf16 a[152:155], a[224:227], a[64:67], a[152:155]
    v_mul_f32 v38, v38, v10
    v_mul_f32 v39, v39, v11
    v_mfma_f32_16x16x32_bf16 a[152:155], a[228:231], a[68:71], a[152:155]
    v_mul_f32 v40, v40, v12
    v_mul_f32 v41, v41, v13
    v_mfma_f32_16x16x32_bf16 a[152:155], a[232:235], a[72:75], a[152:155]
    v_mul_f32 v42, v42, v14
    v_mul_f32 v43, v43, v15
    v_mfma_f32_16x16x32_bf16 a[152:155], a[236:239], a[76:79], a[152:155]
    buffer_load_dwordx4 a[184:187], v4, s[16:19], s63 offen offset:2048 sc1
    v_mfma_f32_16x16x32_bf16 a[156:159], a[252:255], a[76:79], a[156:159]
    v_cvt_pk_bf16_f32 v8, v36, v37
    v_cvt_pk_bf16_f32 v9, v38, v39
    v_mfma_f32_16x16x32_bf16 a[156:159], a[248:251], a[72:75], a[156:159]
    v_cvt_pk_bf16_f32 v10, v40, v41
    v_cvt_pk_bf16_f32 v11, v42, v43
    v_mfma_f32_16x16x32_bf16 a[156:159], a[244:247], a[68:71], a[156:159]
    v_lshlrev_b32 v176, 16, v8
    v_and_b32 v177, 0xffff0000, v8
    v_mfma_f32_16x16x32_bf16 a[156:159], a[240:243], a[64:67], a[156:159]
    buffer_load_dwordx4 a[188:191], v4, s[16:19], s63 offen offset:3072 sc1
    s_add_u32 s63, s63, 155648
    s_waitcnt vmcnt(16)
    v_mfma_f32_16x16x32_bf16 a[144:147], v[192:195], a[80:83], a[144:147]
    v_lshlrev_b32 v178, 16, v9
    v_and_b32 v179, 0xffff0000, v9
    v_mfma_f32_16x16x32_bf16 a[144:147], v[196:199], a[84:87], a[144:147]
    v_lshlrev_b32 v180, 16, v10
    v_and_b32 v181, 0xffff0000, v10
    v_mfma_f32_16x16x32_bf16 a[144:147], v[200:203], a[88:91], a[144:147]
    v_lshlrev_b32 v182, 16, v11
    v_and_b32 v183, 0xffff0000, v11
    v_mfma_f32_16x16x32_bf16 a[144:147], v[204:207], a[92:95], a[144:147]
    buffer_load_dwordx4 a[64:67], v4, s[16:19], s63 offen offset:0 sc1
    v_mfma_f32_16x16x32_bf16 a[148:151], v[220:223], a[92:95], a[148:151]
    v_lshlrev_b32 v36, 16, v148
    v_and_b32 v37, 0xffff0000, v148
    v_mfma_f32_16x16x32_bf16 a[148:151], v[216:219], a[88:91], a[148:151]
    v_lshlrev_b32 v38, 16, v149
    v_and_b32 v39, 0xffff0000, v149
    v_mfma_f32_16x16x32_bf16 a[148:151], v[212:215], a[84:87], a[148:151]
    v_lshlrev_b32 v40, 16, v150
    v_and_b32 v41, 0xffff0000, v150
    v_mfma_f32_16x16x32_bf16 a[148:151], v[208:211], a[80:83], a[148:151]
    buffer_load_dwordx4 a[68:71], v4, s[16:19], s63 offen offset:1024 sc1
    v_mfma_f32_16x16x32_bf16 a[152:155], v[224:227], a[80:83], a[152:155]
    v_lshlrev_b32 v42, 16, v151
    v_and_b32 v43, 0xffff0000, v151
    v_mfma_f32_16x16x32_bf16 a[152:155], v[228:231], a[84:87], a[152:155]
    v_sub_f32 v36, v36, v46
    v_sub_f32 v37, v37, v46
    v_mfma_f32_16x16x32_bf16 a[152:155], v[232:235], a[88:91], a[152:155]
    v_sub_f32 v38, v38, v46
    v_sub_f32 v39, v39, v46
    v_mfma_f32_16x16x32_bf16 a[152:155], v[236:239], a[92:95], a[152:155]
    buffer_load_dwordx4 a[72:75], v4, s[16:19], s63 offen offset:2048 sc1
    v_mfma_f32_16x16x32_bf16 a[156:159], v[252:255], a[92:95], a[156:159]
    v_sub_f32 v40, v40, v46
    v_sub_f32 v41, v41, v46
    v_mfma_f32_16x16x32_bf16 a[156:159], v[248:251], a[88:91], a[156:159]
    v_sub_f32 v42, v42, v46
    v_sub_f32 v43, v43, v46
    v_mfma_f32_16x16x32_bf16 a[156:159], v[244:247], a[84:87], a[156:159]
    v_cvt_pk_bf16_f32 v8, v36, v37
    v_cvt_pk_bf16_f32 v9, v38, v39
    v_mfma_f32_16x16x32_bf16 a[156:159], v[240:243], a[80:83], a[156:159]
    buffer_load_dwordx4 a[76:79], v4, s[16:19], s63 offen offset:3072 sc1
    s_add_u32 s63, s63, 4096
    s_waitcnt vmcnt(16)
    v_mfma_f32_16x16x32_bf16 a[128:131], v[64:67], a[96:99], 0
    v_cvt_pk_bf16_f32 v10, v40, v41
    v_cvt_pk_bf16_f32 v11, v42, v43
    v_mfma_f32_16x16x32_bf16 a[128:131], v[68:71], a[100:103], a[128:131]
    v_lshlrev_b32 v36, 16, v8
    v_and_b32 v37, 0xffff0000, v8
    v_mfma_f32_16x16x32_bf16 a[128:131], v[72:75], a[104:107], a[128:131]
    v_lshlrev_b32 v38, 16, v9
    v_and_b32 v39, 0xffff0000, v9
    v_mfma_f32_16x16x32_bf16 a[128:131], v[76:79], a[108:111], a[128:131]
    ds_write_b128 v32, a[144:147] offset:16384
    buffer_load_dwordx4 a[80:83], v4, s[16:19], s63 offen offset:0 sc1
    v_mfma_f32_16x16x32_bf16 a[132:135], v[92:95], a[108:111], 0
    v_lshlrev_b32 v40, 16, v10
    v_and_b32 v41, 0xffff0000, v10
    v_mfma_f32_16x16x32_bf16 a[132:135], v[88:91], a[104:107], a[132:135]
    v_lshlrev_b32 v42, 16, v11
    v_and_b32 v43, 0xffff0000, v11
    v_mfma_f32_16x16x32_bf16 a[132:135], v[84:87], a[100:103], a[132:135]
    v_mul_f32 v36, v36, v47
    v_mul_f32 v37, v37, v47
    v_mfma_f32_16x16x32_bf16 a[132:135], v[80:83], a[96:99], a[132:135]
    ds_write_b128 v33, a[148:151] offset:16384
    buffer_load_dwordx4 a[84:87], v4, s[16:19], s63 offen offset:1024 sc1
    v_mfma_f32_16x16x32_bf16 a[136:139], v[96:99], a[96:99], 0
    v_mul_f32 v38, v38, v47
    v_mul_f32 v39, v39, v47
    v_mfma_f32_16x16x32_bf16 a[136:139], v[100:103], a[100:103], a[136:139]
    v_mul_f32 v40, v40, v47
    v_mul_f32 v41, v41, v47
    v_mfma_f32_16x16x32_bf16 a[136:139], v[104:107], a[104:107], a[136:139]
    v_mul_f32 v42, v42, v47
    v_mul_f32 v43, v43, v47
    v_mfma_f32_16x16x32_bf16 a[136:139], v[108:111], a[108:111], a[136:139]
    ds_write_b128 v34, a[152:155] offset:16384
    buffer_load_dwordx4 a[88:91], v4, s[16:19], s63 offen offset:2048 sc1
    v_mfma_f32_16x16x32_bf16 a[140:143], v[124:127], a[108:111], 0
    v_cvt_pk_bf16_f32 v8, v36, v37
    v_cvt_pk_bf16_f32 v9, v38, v39
    v_mfma_f32_16x16x32_bf16 a[140:143], v[120:123], a[104:107], a[140:143]
    v_cvt_pk_bf16_f32 v10, v40, v41
    v_cvt_pk_bf16_f32 v11, v42, v43
    v_mfma_f32_16x16x32_bf16 a[140:143], v[116:119], a[100:103], a[140:143]
    v_lshlrev_b32 v36, 16, v8
    v_and_b32 v37, 0xffff0000, v8
    v_mfma_f32_16x16x32_bf16 a[140:143], v[112:115], a[96:99], a[140:143]
    ds_write_b128 v35, a[156:159] offset:16384
    buffer_load_dwordx4 a[92:95], v4, s[16:19], s63 offen offset:3072 sc1
    s_add_u32 s63, s63, 4096
    s_waitcnt vmcnt(16)
    v_mfma_f32_16x16x32_bf16 a[128:131], a[0:3], a[112:115], a[128:131]
    v_lshlrev_b32 v38, 16, v9
    v_and_b32 v39, 0xffff0000, v9
    v_mfma_f32_16x16x32_bf16 a[128:131], a[4:7], a[116:119], a[128:131]
    v_lshlrev_b32 v40, 16, v10
    v_and_b32 v41, 0xffff0000, v10
    v_mfma_f32_16x16x32_bf16 a[128:131], a[8:11], a[120:123], a[128:131]
    v_lshlrev_b32 v42, 16, v11
    v_and_b32 v43, 0xffff0000, v11
    v_mfma_f32_16x16x32_bf16 a[128:131], a[12:15], a[124:127], a[128:131]
    buffer_load_dwordx4 a[96:99], v4, s[16:19], s63 offen offset:0 sc1
    v_mfma_f32_16x16x32_bf16 a[132:135], a[28:31], a[124:127], a[132:135]
    v_lshlrev_b32 v8, 16, v168
    v_and_b32 v9, 0xffff0000, v168
    v_mfma_f32_16x16x32_bf16 a[132:135], a[24:27], a[120:123], a[132:135]
    v_lshlrev_b32 v10, 16, v169
    v_and_b32 v11, 0xffff0000, v169
    v_mfma_f32_16x16x32_bf16 a[132:135], a[20:23], a[116:119], a[132:135]
    v_lshlrev_b32 v12, 16, v172
    v_and_b32 v13, 0xffff0000, v172
    v_mfma_f32_16x16x32_bf16 a[132:135], a[16:19], a[112:115], a[132:135]
    buffer_load_dwordx4 a[100:103], v4, s[16:19], s63 offen offset:1024 sc1
    v_mfma_f32_16x16x32_bf16 a[136:139], a[32:35], a[112:115], a[136:139]
    v_lshlrev_b32 v14, 16, v173
    v_and_b32 v15, 0xffff0000, v173
    v_mfma_f32_16x16x32_bf16 a[136:139], a[36:39], a[116:119], a[136:139]
    v_add_f32 v36, v36, v8
    v_add_f32 v37, v37, v9
    v_mfma_f32_16x16x32_bf16 a[136:139], a[40:43], a[120:123], a[136:139]
    v_add_f32 v38, v38, v10
    v_add_f32 v39, v39, v11
    v_mfma_f32_16x16x32_bf16 a[136:139], a[44:47], a[124:127], a[136:139]
    buffer_load_dwordx4 a[104:107], v4, s[16:19], s63 offen offset:2048 sc1
    v_mfma_f32_16x16x32_bf16 a[140:143], a[60:63], a[124:127], a[140:143]
    v_add_f32 v40, v40, v12
    v_add_f32 v41, v41, v13
    v_mfma_f32_16x16x32_bf16 a[140:143], a[56:59], a[120:123], a[140:143]
    v_add_f32 v42, v42, v14
    v_add_f32 v43, v43, v15
    v_mfma_f32_16x16x32_bf16 a[140:143], a[52:55], a[116:119], a[140:143]
    v_cvt_pk_bf16_f32 v8, v36, v37
    v_cvt_pk_bf16_f32 v9, v38, v39
    v_mfma_f32_16x16x32_bf16 a[140:143], a[48:51], a[112:115], a[140:143]
    buffer_load_dwordx4 a[108:111], v4, s[16:19], s63 offen offset:3072 sc1
    s_add_u32 s63, s63, 4096
    s_waitcnt vmcnt(16)
    v_mfma_f32_16x16x32_bf16 a[128:131], a[192:195], a[160:163], a[128:131]
    v_cvt_pk_bf16_f32 v10, v40, v41
    v_cvt_pk_bf16_f32 v11, v42, v43
    v_mfma_f32_16x16x32_bf16 a[128:131], a[196:199], a[164:167], a[128:131]
    v_lshlrev_b32 v36, 16, v8
    v_and_b32 v37, 0xffff0000, v8
    v_mfma_f32_16x16x32_bf16 a[128:131], a[200:203], a[168:171], a[128:131]
    v_lshlrev_b32 v38, 16, v9
    v_and_b32 v39, 0xffff0000, v9
    v_mfma_f32_16x16x32_bf16 a[128:131], a[204:207], a[172:175], a[128:131]
    buffer_load_dwordx4 a[112:115], v4, s[16:19], s63 offen offset:0 sc1
    v_mfma_f32_16x16x32_bf16 a[132:135], a[220:223], a[172:175], a[132:135]
    v_lshlrev_b32 v40, 16, v10
    v_and_b32 v41, 0xffff0000, v10
    v_mfma_f32_16x16x32_bf16 a[132:135], a[216:219], a[168:171], a[132:135]
    v_lshlrev_b32 v42, 16, v11
    v_and_b32 v43, 0xffff0000, v11
    v_mfma_f32_16x16x32_bf16 a[132:135], a[212:215], a[164:167], a[132:135]
    v_mul_f32 v8, 0xbfb8aa3b, v36
    v_mul_f32 v9, 0xbfb8aa3b, v37
    v_mfma_f32_16x16x32_bf16 a[132:135], a[208:211], a[160:163], a[132:135]
    buffer_load_dwordx4 a[116:119], v4, s[16:19], s63 offen offset:1024 sc1
    v_mfma_f32_16x16x32_bf16 a[136:139], a[224:227], a[160:163], a[136:139]
    v_mul_f32 v10, 0xbfb8aa3b, v38
    v_mul_f32 v11, 0xbfb8aa3b, v39
    v_mfma_f32_16x16x32_bf16 a[136:139], a[228:231], a[164:167], a[136:139]
    v_mul_f32 v12, 0xbfb8aa3b, v40
    v_mul_f32 v13, 0xbfb8aa3b, v41
    v_mfma_f32_16x16x32_bf16 a[136:139], a[232:235], a[168:171], a[136:139]
    v_mul_f32 v14, 0xbfb8aa3b, v42
    v_mul_f32 v15, 0xbfb8aa3b, v43
    v_mfma_f32_16x16x32_bf16 a[136:139], a[236:239], a[172:175], a[136:139]
    buffer_load_dwordx4 a[120:123], v4, s[16:19], s63 offen offset:2048 sc1
    v_mfma_f32_16x16x32_bf16 a[140:143], a[252:255], a[172:175], a[140:143]
    v_exp_f32 v8, v8
    v_mfma_f32_16x16x32_bf16 a[140:143], a[248:251], a[168:171], a[140:143]
    v_exp_f32 v9, v9
    v_mfma_f32_16x16x32_bf16 a[140:143], a[244:247], a[164:167], a[140:143]
    v_exp_f32 v10, v10
    v_mfma_f32_16x16x32_bf16 a[140:143], a[240:243], a[160:163], a[140:143]
    buffer_load_dwordx4 a[124:127], v4, s[16:19], s63 offen offset:3072 sc1
    s_mov_b32 s63, s65
    s_waitcnt vmcnt(16)
    v_mfma_f32_16x16x32_bf16 a[128:131], v[192:195], a[176:179], a[128:131]
    v_exp_f32 v11, v11
    v_mfma_f32_16x16x32_bf16 a[128:131], v[196:199], a[180:183], a[128:131]
    v_exp_f32 v12, v12
    v_mfma_f32_16x16x32_bf16 a[128:131], v[200:203], a[184:187], a[128:131]
    v_exp_f32 v13, v13
    v_mfma_f32_16x16x32_bf16 a[128:131], v[204:207], a[188:191], a[128:131]
    buffer_load_dwordx4 a[160:163], v4, s[16:19], s63 offen offset:0 sc1
    v_mfma_f32_16x16x32_bf16 a[132:135], v[220:223], a[188:191], a[132:135]
    v_exp_f32 v14, v14
    v_mfma_f32_16x16x32_bf16 a[132:135], v[216:219], a[184:187], a[132:135]
    v_exp_f32 v15, v15
    v_mfma_f32_16x16x32_bf16 a[132:135], v[212:215], a[180:183], a[132:135]
    v_add_f32 v8, 1.0, v8
    v_add_f32 v9, 1.0, v9
    v_mfma_f32_16x16x32_bf16 a[132:135], v[208:211], a[176:179], a[132:135]
    buffer_load_dwordx4 a[164:167], v4, s[16:19], s63 offen offset:1024 sc1
    v_mfma_f32_16x16x32_bf16 a[136:139], v[224:227], a[176:179], a[136:139]
    v_add_f32 v10, 1.0, v10
    v_add_f32 v11, 1.0, v11
    v_mfma_f32_16x16x32_bf16 a[136:139], v[228:231], a[180:183], a[136:139]
    v_add_f32 v12, 1.0, v12
    v_add_f32 v13, 1.0, v13
    v_mfma_f32_16x16x32_bf16 a[136:139], v[232:235], a[184:187], a[136:139]
    v_add_f32 v14, 1.0, v14
    v_add_f32 v15, 1.0, v15
    v_mfma_f32_16x16x32_bf16 a[136:139], v[236:239], a[188:191], a[136:139]
    buffer_load_dwordx4 a[168:171], v4, s[16:19], s63 offen offset:2048 sc1
    v_mfma_f32_16x16x32_bf16 a[140:143], v[252:255], a[188:191], a[140:143]
    v_rcp_f32 v8, v8
    v_mfma_f32_16x16x32_bf16 a[140:143], v[248:251], a[184:187], a[140:143]
    v_rcp_f32 v9, v9
    v_mfma_f32_16x16x32_bf16 a[140:143], v[244:247], a[180:183], a[140:143]
    v_rcp_f32 v10, v10
    v_mfma_f32_16x16x32_bf16 a[140:143], v[240:243], a[176:179], a[140:143]
    buffer_load_dwordx4 a[172:175], v4, s[16:19], s63 offen offset:3072 sc1
    s_add_u32 s63, s63, 4096
    s_waitcnt vmcnt(16)
    v_mfma_f32_16x16x32_bf16 a[144:147], v[64:67], a[64:67], 0
    v_rcp_f32 v11, v11
    v_mfma_f32_16x16x32_bf16 a[144:147], v[68:71], a[68:71], a[144:147]
    v_rcp_f32 v12, v12
    v_mfma_f32_16x16x32_bf16 a[144:147], v[72:75], a[72:75], a[144:147]
    v_rcp_f32 v13, v13
    v_mfma_f32_16x16x32_bf16 a[144:147], v[76:79], a[76:79], a[144:147]
    ds_write_b128 v32, a[128:131] offset:32768
    buffer_load_dwordx4 a[176:179], v4, s[16:19], s63 offen offset:0 sc1
    v_mfma_f32_16x16x32_bf16 a[148:151], v[92:95], a[76:79], 0
    v_rcp_f32 v14, v14
    v_mfma_f32_16x16x32_bf16 a[148:151], v[88:91], a[72:75], a[148:151]
    v_rcp_f32 v15, v15
    v_mfma_f32_16x16x32_bf16 a[148:151], v[84:87], a[68:71], a[148:151]
    v_mul_f32 v36, v36, v8
    v_mul_f32 v37, v37, v9
    v_mfma_f32_16x16x32_bf16 a[148:151], v[80:83], a[64:67], a[148:151]
    ds_write_b128 v33, a[132:135] offset:32768
    buffer_load_dwordx4 a[180:183], v4, s[16:19], s63 offen offset:1024 sc1
    v_mfma_f32_16x16x32_bf16 a[152:155], v[96:99], a[64:67], 0
    v_mul_f32 v38, v38, v10
    v_mul_f32 v39, v39, v11
    v_mfma_f32_16x16x32_bf16 a[152:155], v[100:103], a[68:71], a[152:155]
    v_mul_f32 v40, v40, v12
    v_mul_f32 v41, v41, v13
    v_mfma_f32_16x16x32_bf16 a[152:155], v[104:107], a[72:75], a[152:155]
    v_mul_f32 v42, v42, v14
    v_mul_f32 v43, v43, v15
    v_mfma_f32_16x16x32_bf16 a[152:155], v[108:111], a[76:79], a[152:155]
    ds_write_b128 v34, a[136:139] offset:32768
    buffer_load_dwordx4 a[184:187], v4, s[16:19], s63 offen offset:2048 sc1
    v_mfma_f32_16x16x32_bf16 a[156:159], v[124:127], a[76:79], 0
    v_cvt_pk_bf16_f32 v8, v36, v37
    v_cvt_pk_bf16_f32 v9, v38, v39
    v_mfma_f32_16x16x32_bf16 a[156:159], v[120:123], a[72:75], a[156:159]
    v_cvt_pk_bf16_f32 v10, v40, v41
    v_cvt_pk_bf16_f32 v11, v42, v43
    v_mfma_f32_16x16x32_bf16 a[156:159], v[116:119], a[68:71], a[156:159]
    v_lshlrev_b32 v184, 16, v8
    v_and_b32 v185, 0xffff0000, v8
    v_mfma_f32_16x16x32_bf16 a[156:159], v[112:115], a[64:67], a[156:159]
    ds_write_b128 v35, a[140:143] offset:32768
    buffer_load_dwordx4 a[188:191], v4, s[16:19], s63 offen offset:3072 sc1
    s_add_u32 s63, s63, 4096
    s_waitcnt vmcnt(16)
    v_mfma_f32_16x16x32_bf16 a[144:147], a[0:3], a[80:83], a[144:147]
    v_lshlrev_b32 v186, 16, v9
    v_and_b32 v187, 0xffff0000, v9
    v_mfma_f32_16x16x32_bf16 a[144:147], a[4:7], a[84:87], a[144:147]
    v_lshlrev_b32 v188, 16, v10
    v_and_b32 v189, 0xffff0000, v10
    v_mfma_f32_16x16x32_bf16 a[144:147], a[8:11], a[88:91], a[144:147]
    v_lshlrev_b32 v190, 16, v11
    v_and_b32 v191, 0xffff0000, v11
    v_mfma_f32_16x16x32_bf16 a[144:147], a[12:15], a[92:95], a[144:147]
    buffer_load_dwordx4 a[64:67], v4, s[16:19], s63 offen offset:0 sc1
    v_mfma_f32_16x16x32_bf16 a[148:151], a[28:31], a[92:95], a[148:151]
    v_lshlrev_b32 v160, 16, v144
    v_and_b32 v161, 0xffff0000, v144
    v_mfma_f32_16x16x32_bf16 a[148:151], a[24:27], a[88:91], a[148:151]
    v_lshlrev_b32 v162, 16, v145
    v_and_b32 v163, 0xffff0000, v145
    v_mfma_f32_16x16x32_bf16 a[148:151], a[20:23], a[84:87], a[148:151]
    v_lshlrev_b32 v164, 16, v146
    v_and_b32 v165, 0xffff0000, v146
    v_mfma_f32_16x16x32_bf16 a[148:151], a[16:19], a[80:83], a[148:151]
    buffer_load_dwordx4 a[68:71], v4, s[16:19], s63 offen offset:1024 sc1
    v_mfma_f32_16x16x32_bf16 a[152:155], a[32:35], a[80:83], a[152:155]
    v_lshlrev_b32 v166, 16, v147
    v_and_b32 v167, 0xffff0000, v147
    v_mfma_f32_16x16x32_bf16 a[152:155], a[36:39], a[84:87], a[152:155]
    v_lshlrev_b32 v168, 16, v148
    v_and_b32 v169, 0xffff0000, v148
    v_mfma_f32_16x16x32_bf16 a[152:155], a[40:43], a[88:91], a[152:155]
    v_lshlrev_b32 v170, 16, v149
    v_and_b32 v171, 0xffff0000, v149
    v_mfma_f32_16x16x32_bf16 a[152:155], a[44:47], a[92:95], a[152:155]
    buffer_load_dwordx4 a[72:75], v4, s[16:19], s63 offen offset:2048 sc1
    v_mfma_f32_16x16x32_bf16 a[156:159], a[60:63], a[92:95], a[156:159]
    v_lshlrev_b32 v172, 16, v150
    v_and_b32 v173, 0xffff0000, v150
    v_mfma_f32_16x16x32_bf16 a[156:159], a[56:59], a[88:91], a[156:159]
    v_lshlrev_b32 v174, 16, v151
    v_and_b32 v175, 0xffff0000, v151
    v_mfma_f32_16x16x32_bf16 a[156:159], a[52:55], a[84:87], a[156:159]
    v_mfma_f32_16x16x32_bf16 a[156:159], a[48:51], a[80:83], a[156:159]
    buffer_load_dwordx4 a[76:79], v4, s[16:19], s63 offen offset:3072 sc1
    s_add_u32 s63, s63, 4096
    s_waitcnt vmcnt(16)
    v_mfma_f32_16x16x32_bf16 a[144:147], a[192:195], a[96:99], a[144:147]
    v_mfma_f32_16x16x32_bf16 a[144:147], a[196:199], a[100:103], a[144:147]
    v_mfma_f32_16x16x32_bf16 a[144:147], a[200:203], a[104:107], a[144:147]
    v_mfma_f32_16x16x32_bf16 a[144:147], a[204:207], a[108:111], a[144:147]
    buffer_load_dwordx4 a[80:83], v4, s[16:19], s63 offen offset:0 sc1
    v_mfma_f32_16x16x32_bf16 a[148:151], a[220:223], a[108:111], a[148:151]
    v_mfma_f32_16x16x32_bf16 a[148:151], a[216:219], a[104:107], a[148:151]
    v_mfma_f32_16x16x32_bf16 a[148:151], a[212:215], a[100:103], a[148:151]
    v_mfma_f32_16x16x32_bf16 a[148:151], a[208:211], a[96:99], a[148:151]
    buffer_load_dwordx4 a[84:87], v4, s[16:19], s63 offen offset:1024 sc1
    v_mfma_f32_16x16x32_bf16 a[152:155], a[224:227], a[96:99], a[152:155]
    v_mfma_f32_16x16x32_bf16 a[152:155], a[228:231], a[100:103], a[152:155]
    v_mfma_f32_16x16x32_bf16 a[152:155], a[232:235], a[104:107], a[152:155]
    v_mfma_f32_16x16x32_bf16 a[152:155], a[236:239], a[108:111], a[152:155]
    buffer_load_dwordx4 a[88:91], v4, s[16:19], s63 offen offset:2048 sc1
    v_mfma_f32_16x16x32_bf16 a[156:159], a[252:255], a[108:111], a[156:159]
    v_mfma_f32_16x16x32_bf16 a[156:159], a[248:251], a[104:107], a[156:159]
    v_mfma_f32_16x16x32_bf16 a[156:159], a[244:247], a[100:103], a[156:159]
    v_mfma_f32_16x16x32_bf16 a[156:159], a[240:243], a[96:99], a[156:159]
    buffer_load_dwordx4 a[92:95], v4, s[16:19], s63 offen offset:3072 sc1
    s_add_u32 s63, s63, 155648
    s_waitcnt vmcnt(16)
    v_mfma_f32_16x16x32_bf16 a[144:147], v[192:195], a[112:115], a[144:147]
    v_mfma_f32_16x16x32_bf16 a[144:147], v[196:199], a[116:119], a[144:147]
    v_mfma_f32_16x16x32_bf16 a[144:147], v[200:203], a[120:123], a[144:147]
    v_mfma_f32_16x16x32_bf16 a[144:147], v[204:207], a[124:127], a[144:147]
    buffer_load_dwordx4 a[96:99], v4, s[16:19], s63 offen offset:0 sc1
    v_mfma_f32_16x16x32_bf16 a[148:151], v[220:223], a[124:127], a[148:151]
    v_mfma_f32_16x16x32_bf16 a[148:151], v[216:219], a[120:123], a[148:151]
    v_mfma_f32_16x16x32_bf16 a[148:151], v[212:215], a[116:119], a[148:151]
    v_mfma_f32_16x16x32_bf16 a[148:151], v[208:211], a[112:115], a[148:151]
    buffer_load_dwordx4 a[100:103], v4, s[16:19], s63 offen offset:1024 sc1
    v_mfma_f32_16x16x32_bf16 a[152:155], v[224:227], a[112:115], a[152:155]
    v_mfma_f32_16x16x32_bf16 a[152:155], v[228:231], a[116:119], a[152:155]
    v_mfma_f32_16x16x32_bf16 a[152:155], v[232:235], a[120:123], a[152:155]
    v_mfma_f32_16x16x32_bf16 a[152:155], v[236:239], a[124:127], a[152:155]
    buffer_load_dwordx4 a[104:107], v4, s[16:19], s63 offen offset:2048 sc1
    v_mfma_f32_16x16x32_bf16 a[156:159], v[252:255], a[124:127], a[156:159]
    v_mfma_f32_16x16x32_bf16 a[156:159], v[248:251], a[120:123], a[156:159]
    v_mfma_f32_16x16x32_bf16 a[156:159], v[244:247], a[116:119], a[156:159]
    v_mfma_f32_16x16x32_bf16 a[156:159], v[240:243], a[112:115], a[156:159]
    buffer_load_dwordx4 a[108:111], v4, s[16:19], s63 offen offset:3072 sc1
    s_add_u32 s63, s63, 4096
    s_waitcnt vmcnt(16)
    v_mfma_f32_16x16x32_bf16 a[128:131], v[64:67], a[160:163], 0
    v_mfma_f32_16x16x32_bf16 a[128:131], v[68:71], a[164:167], a[128:131]
    v_mfma_f32_16x16x32_bf16 a[128:131], v[72:75], a[168:171], a[128:131]
    v_mfma_f32_16x16x32_bf16 a[128:131], v[76:79], a[172:175], a[128:131]
    ds_write_b128 v32, a[144:147] offset:49152
    ds_write_b128 v33, a[148:151] offset:49152
    buffer_load_dwordx4 a[112:115], v4, s[16:19], s63 offen offset:0 sc1
    v_mfma_f32_16x16x32_bf16 a[132:135], v[92:95], a[172:175], 0
    v_mfma_f32_16x16x32_bf16 a[132:135], v[88:91], a[168:171], a[132:135]
    v_mfma_f32_16x16x32_bf16 a[132:135], v[84:87], a[164:167], a[132:135]
    v_mfma_f32_16x16x32_bf16 a[132:135], v[80:83], a[160:163], a[132:135]
    ds_write_b128 v34, a[152:155] offset:49152
    ds_write_b128 v35, a[156:159] offset:49152
    buffer_load_dwordx4 a[116:119], v4, s[16:19], s63 offen offset:1024 sc1
    v_mfma_f32_16x16x32_bf16 a[136:139], v[96:99], a[160:163], 0
    v_mfma_f32_16x16x32_bf16 a[136:139], v[100:103], a[164:167], a[136:139]
    v_mfma_f32_16x16x32_bf16 a[136:139], v[104:107], a[168:171], a[136:139]
    v_mfma_f32_16x16x32_bf16 a[136:139], v[108:111], a[172:175], a[136:139]
    buffer_load_dwordx4 a[120:123], v4, s[16:19], s63 offen offset:2048 sc1
    v_mfma_f32_16x16x32_bf16 a[140:143], v[124:127], a[172:175], 0
    v_mfma_f32_16x16x32_bf16 a[140:143], v[120:123], a[168:171], a[140:143]
    v_mfma_f32_16x16x32_bf16 a[140:143], v[116:119], a[164:167], a[140:143]
    v_mfma_f32_16x16x32_bf16 a[140:143], v[112:115], a[160:163], a[140:143]
    buffer_load_dwordx4 a[124:127], v4, s[16:19], s63 offen offset:3072 sc1
    s_add_u32 s63, s63, 4096
    s_waitcnt lgkmcnt(0)
    s_barrier
    s_waitcnt vmcnt(16)
    v_mfma_f32_16x16x32_bf16 a[128:131], a[0:3], a[176:179], a[128:131]
    ds_read_b128 v[128:131], v31 offset:0
    v_add_u32 v32, 0x10000, v32
    v_mfma_f32_16x16x32_bf16 a[128:131], a[4:7], a[180:183], a[128:131]
    ds_read_b128 v[132:135], v31 offset:4096
    v_add_u32 v33, 0x10000, v33
    v_mfma_f32_16x16x32_bf16 a[128:131], a[8:11], a[184:187], a[128:131]
    ds_read_b128 v[136:139], v31 offset:8192
    v_add_u32 v34, 0x10000, v34
    v_mfma_f32_16x16x32_bf16 a[128:131], a[12:15], a[188:191], a[128:131]
    buffer_load_dwordx4 a[160:163], v4, s[16:19], s63 offen offset:0 sc1
    v_mfma_f32_16x16x32_bf16 a[132:135], a[28:31], a[188:191], a[132:135]
    ds_read_b128 v[140:143], v31 offset:12288
    v_add_u32 v35, 0x10000, v35
    v_mfma_f32_16x16x32_bf16 a[132:135], a[24:27], a[184:187], a[132:135]
    ds_read_b128 v[144:147], v31 offset:256
    v_mfma_f32_16x16x32_bf16 a[132:135], a[20:23], a[180:183], a[132:135]
    ds_read_b128 v[148:151], v31 offset:4352
    v_mfma_f32_16x16x32_bf16 a[132:135], a[16:19], a[176:179], a[132:135]
    buffer_load_dwordx4 a[164:167], v4, s[16:19], s63 offen offset:1024 sc1
    v_mfma_f32_16x16x32_bf16 a[136:139], a[32:35], a[176:179], a[136:139]
    ds_read_b128 v[152:155], v31 offset:8448
    v_mfma_f32_16x16x32_bf16 a[136:139], a[36:39], a[180:183], a[136:139]
    ds_read_b128 v[156:159], v31 offset:12544
    v_mfma_f32_16x16x32_bf16 a[136:139], a[40:43], a[184:187], a[136:139]
    v_mfma_f32_16x16x32_bf16 a[136:139], a[44:47], a[188:191], a[136:139]
    buffer_load_dwordx4 a[168:171], v4, s[16:19], s63 offen offset:2048 sc1
    v_mfma_f32_16x16x32_bf16 a[140:143], a[60:63], a[188:191], a[140:143]
    v_mfma_f32_16x16x32_bf16 a[140:143], a[56:59], a[184:187], a[140:143]
    v_mfma_f32_16x16x32_bf16 a[140:143], a[52:55], a[180:183], a[140:143]
    v_mfma_f32_16x16x32_bf16 a[140:143], a[48:51], a[176:179], a[140:143]
    buffer_load_dwordx4 a[172:175], v4, s[16:19], s63 offen offset:3072 sc1
    s_add_u32 s63, s63, 4096
    s_waitcnt vmcnt(16) lgkmcnt(0)
    v_mfma_f32_16x16x32_bf16 a[128:131], a[192:195], a[64:67], a[128:131]
    v_add_f32 v128, v128, v132
    v_add_f32 v129, v129, v133
    v_mfma_f32_16x16x32_bf16 a[128:131], a[196:199], a[68:71], a[128:131]
    v_add_f32 v130, v130, v134
    v_add_f32 v131, v131, v135
    v_mfma_f32_16x16x32_bf16 a[128:131], a[200:203], a[72:75], a[128:131]
    v_add_f32 v136, v136, v140
    v_add_f32 v137, v137, v141
    v_mfma_f32_16x16x32_bf16 a[128:131], a[204:207], a[76:79], a[128:131]
    buffer_load_dwordx4 a[176:179], v4, s[16:19], s63 offen offset:0 sc1
    v_mfma_f32_16x16x32_bf16 a[132:135], a[220:223], a[76:79], a[132:135]
    v_add_f32 v138, v138, v142
    v_add_f32 v139, v139, v143
    v_mfma_f32_16x16x32_bf16 a[132:135], a[216:219], a[72:75], a[132:135]
    v_add_f32 v128, v128, v136
    v_add_f32 v129, v129, v137
    v_mfma_f32_16x16x32_bf16 a[132:135], a[212:215], a[68:71], a[132:135]
    v_add_f32 v130, v130, v138
    v_add_f32 v131, v131, v139
    v_mfma_f32_16x16x32_bf16 a[132:135], a[208:211], a[64:67], a[132:135]
    buffer_load_dwordx4 a[180:183], v4, s[16:19], s63 offen offset:1024 sc1
    v_mfma_f32_16x16x32_bf16 a[136:139], a[224:227], a[64:67], a[136:139]
    v_and_or_b32 v132, v128, v29, s4
    v_and_or_b32 v133, v129, v29, s5
    v_mfma_f32_16x16x32_bf16 a[136:139], a[228:231], a[68:71], a[136:139]
    v_and_or_b32 v134, v130, v29, s6
    v_and_or_b32 v135, v131, v29, s7
    v_mfma_f32_16x16x32_bf16 a[136:139], a[232:235], a[72:75], a[136:139]
    v_add_f32 v144, v144, v148
    v_add_f32 v145, v145, v149
    v_mfma_f32_16x16x32_bf16 a[136:139], a[236:239], a[76:79], a[136:139]
    buffer_load_dwordx4 a[184:187], v4, s[16:19], s63 offen offset:2048 sc1
    v_mfma_f32_16x16x32_bf16 a[140:143], a[252:255], a[76:79], a[140:143]
    v_add_f32 v146, v146, v150
    v_add_f32 v147, v147, v151
    v_mfma_f32_16x16x32_bf16 a[140:143], a[248:251], a[72:75], a[140:143]
    v_add_f32 v152, v152, v156
    v_add_f32 v153, v153, v157
    v_mfma_f32_16x16x32_bf16 a[140:143], a[244:247], a[68:71], a[140:143]
    v_add_f32 v154, v154, v158
    v_add_f32 v155, v155, v159
    v_mfma_f32_16x16x32_bf16 a[140:143], a[240:243], a[64:67], a[140:143]
    buffer_load_dwordx4 a[188:191], v4, s[16:19], s63 offen offset:3072 sc1
    s_add_u32 s63, s63, 155648
    v_add_f32 v144, v144, v152
    v_add_f32 v145, v145, v153
    v_add_f32 v146, v146, v154
    v_add_f32 v147, v147, v155
    v_and_or_b32 v148, v144, v29, s4
    v_and_or_b32 v149, v145, v29, s5
    v_and_or_b32 v150, v146, v29, s6
    v_and_or_b32 v151, v147, v29, s7
    buffer_store_dwordx4 v[132:135], v4, s[16:19], s42 offen offset:0 sc1
    buffer_store_dwordx4 v[148:151], v4, s[16:19], s42 offen offset:1024 sc1
    s_waitcnt vmcnt(18)
    v_mfma_f32_16x16x32_bf16 a[128:131], v[192:195], a[80:83], a[128:131]
    ds_read_b128 v[128:131], v31 offset:2048
    v_mfma_f32_16x16x32_bf16 a[128:131], v[196:199], a[84:87], a[128:131]
    ds_read_b128 v[132:135], v31 offset:6144
    v_mfma_f32_16x16x32_bf16 a[128:131], v[200:203], a[88:91], a[128:131]
    ds_read_b128 v[136:139], v31 offset:10240
    v_mfma_f32_16x16x32_bf16 a[128:131], v[204:207], a[92:95], a[128:131]
    buffer_load_dwordx4 a[64:67], v4, s[16:19], s63 offen offset:0 sc1
    v_mfma_f32_16x16x32_bf16 a[132:135], v[220:223], a[92:95], a[132:135]
    ds_read_b128 v[140:143], v31 offset:14336
    v_mfma_f32_16x16x32_bf16 a[132:135], v[216:219], a[88:91], a[132:135]
    ds_read_b128 v[144:147], v31 offset:2304
    v_mfma_f32_16x16x32_bf16 a[132:135], v[212:215], a[84:87], a[132:135]
    ds_read_b128 v[148:151], v31 offset:6400
    v_mfma_f32_16x16x32_bf16 a[132:135], v[208:211], a[80:83], a[132:135]
    buffer_load_dwordx4 a[68:71], v4, s[16:19], s63 offen offset:1024 sc1
    v_mfma_f32_16x16x32_bf16 a[136:139], v[224:227], a[80:83], a[136:139]
    ds_read_b128 v[152:155], v31 offset:10496
    v_mfma_f32_16x16x32_bf16 a[136:139], v[228:231], a[84:87], a[136:139]
    ds_read_b128 v[156:159], v31 offset:14592
    v_mfma_f32_16x16x32_bf16 a[136:139], v[232:235], a[88:91], a[136:139]
    v_mfma_f32_16x16x32_bf16 a[136:139], v[236:239], a[92:95], a[136:139]
    buffer_load_dwordx4 a[72:75], v4, s[16:19], s63 offen offset:2048 sc1
    v_mfma_f32_16x16x32_bf16 a[140:143], v[252:255], a[92:95], a[140:143]
    v_mfma_f32_16x16x32_bf16 a[140:143], v[248:251], a[88:91], a[140:143]
    v_mfma_f32_16x16x32_bf16 a[140:143], v[244:247], a[84:87], a[140:143]
    v_mfma_f32_16x16x32_bf16 a[140:143], v[240:243], a[80:83], a[140:143]
    buffer_load_dwordx4 a[76:79], v4, s[16:19], s63 offen offset:3072 sc1
    s_add_u32 s63, s63, 4096
    s_waitcnt vmcnt(18) lgkmcnt(0)
    v_mfma_f32_16x16x32_bf16 a[144:147], v[64:67], a[96:99], 0
    v_add_f32 v128, v128, v132
    v_add_f32 v129, v129, v133
    v_mfma_f32_16x16x32_bf16 a[144:147], v[68:71], a[100:103], a[144:147]
    v_add_f32 v130, v130, v134
    v_add_f32 v131, v131, v135
    v_mfma_f32_16x16x32_bf16 a[144:147], v[72:75], a[104:107], a[144:147]
    v_add_f32 v136, v136, v140
    v_add_f32 v137, v137, v141
    v_mfma_f32_16x16x32_bf16 a[144:147], v[76:79], a[108:111], a[144:147]
    ds_write_b128 v32, a[128:131] offset:0
    buffer_load_dwordx4 a[80:83], v4, s[16:19], s63 offen offset:0 sc1
    v_mfma_f32_16x16x32_bf16 a[148:151], v[92:95], a[108:111], 0
    v_add_f32 v138, v138, v142
    v_add_f32 v139, v139, v143
    v_mfma_f32_16x16x32_bf16 a[148:151], v[88:91], a[104:107], a[148:151]
    v_add_f32 v128, v128, v136
    v_add_f32 v129, v129, v137
    v_mfma_f32_16x16x32_bf16 a[148:151], v[84:87], a[100:103], a[148:151]
    v_add_f32 v130, v130, v138
    v_add_f32 v131, v131, v139
    v_mfma_f32_16x16x32_bf16 a[148:151], v[80:83], a[96:99], a[148:151]
    ds_write_b128 v33, a[132:135] offset:0
    buffer_load_dwordx4 a[84:87], v4, s[16:19], s63 offen offset:1024 sc1
    v_mfma_f32_16x16x32_bf16 a[152:155], v[96:99], a[96:99], 0
    v_and_or_b32 v132, v128, v29, s4
    v_and_or_b32 v133, v129, v29, s5
    v_mfma_f32_16x16x32_bf16 a[152:155], v[100:103], a[100:103], a[152:155]
    v_and_or_b32 v134, v130, v29, s6
    v_and_or_b32 v135, v131, v29, s7
    v_mfma_f32_16x16x32_bf16 a[152:155], v[104:107], a[104:107], a[152:155]
    v_add_f32 v144, v144, v148
    v_add_f32 v145, v145, v149
    v_mfma_f32_16x16x32_bf16 a[152:155], v[108:111], a[108:111], a[152:155]
    ds_write_b128 v34, a[136:139] offset:0
    buffer_load_dwordx4 a[88:91], v4, s[16:19], s63 offen offset:2048 sc1
    v_mfma_f32_16x16x32_bf16 a[156:159], v[124:127], a[108:111], 0
    v_add_f32 v146, v146, v150
    v_add_f32 v147, v147, v151
    v_mfma_f32_16x16x32_bf16 a[156:159], v[120:123], a[104:107], a[156:159]
    v_add_f32 v152, v152, v156
    v_add_f32 v153, v153, v157
    v_mfma_f32_16x16x32_bf16 a[156:159], v[116:119], a[100:103], a[156:159]
    v_add_f32 v154, v154, v158
    v_add_f32 v155, v155, v159
    v_mfma_f32_16x16x32_bf16 a[156:159], v[112:115], a[96:99], a[156:159]
    ds_write_b128 v35, a[140:143] offset:0
    buffer_load_dwordx4 a[92:95], v4, s[16:19], s63 offen offset:3072 sc1
    s_add_u32 s63, s63, 4096
    v_add_f32 v144, v144, v152
    v_add_f32 v145, v145, v153
    v_add_f32 v146, v146, v154
    v_add_f32 v147, v147, v155
    v_and_or_b32 v148, v144, v29, s4
    v_and_or_b32 v149, v145, v29, s5
    v_and_or_b32 v150, v146, v29, s6
    v_and_or_b32 v151, v147, v29, s7
    buffer_store_dwordx4 v[132:135], v4, s[16:19], s42 offen offset:2048 sc1
    buffer_store_dwordx4 v[148:151], v4, s[16:19], s42 offen offset:3072 sc1
    s_waitcnt vmcnt(20)
    v_mfma_f32_16x16x32_bf16 a[144:147], a[0:3], a[112:115], a[144:147]
    v_mfma_f32_16x16x32_bf16 a[144:147], a[4:7], a[116:119], a[144:147]
    v_mfma_f32_16x16x32_bf16 a[144:147], a[8:11], a[120:123], a[144:147]
    v_mfma_f32_16x16x32_bf16 a[144:147], a[12:15], a[124:127], a[144:147]
    buffer_load_dwordx4 a[96:99], v4, s[16:19], s63 offen offset:0 sc1
    v_mfma_f32_16x16x32_bf16 a[148:151], a[28:31], a[124:127], a[148:151]
    v_mfma_f32_16x16x32_bf16 a[148:151], a[24:27], a[120:123], a[148:151]
    v_mfma_f32_16x16x32_bf16 a[148:151], a[20:23], a[116:119], a[148:151]
    v_mfma_f32_16x16x32_bf16 a[148:151], a[16:19], a[112:115], a[148:151]
    buffer_load_dwordx4 a[100:103], v4, s[16:19], s63 offen offset:1024 sc1
    v_mfma_f32_16x16x32_bf16 a[152:155], a[32:35], a[112:115], a[152:155]
    v_mfma_f32_16x16x32_bf16 a[152:155], a[36:39], a[116:119], a[152:155]
    v_mfma_f32_16x16x32_bf16 a[152:155], a[40:43], a[120:123], a[152:155]
    v_mfma_f32_16x16x32_bf16 a[152:155], a[44:47], a[124:127], a[152:155]
    buffer_load_dwordx4 a[104:107], v4, s[16:19], s63 offen offset:2048 sc1
    v_mfma_f32_16x16x32_bf16 a[156:159], a[60:63], a[124:127], a[156:159]
    v_mfma_f32_16x16x32_bf16 a[156:159], a[56:59], a[120:123], a[156:159]
    v_mfma_f32_16x16x32_bf16 a[156:159], a[52:55], a[116:119], a[156:159]
    v_mfma_f32_16x16x32_bf16 a[156:159], a[48:51], a[112:115], a[156:159]
    buffer_load_dwordx4 a[108:111], v4, s[16:19], s63 offen offset:3072 sc1
    s_add_u32 s63, s63, 4096
    s_waitcnt vmcnt(20)
    v_mfma_f32_16x16x32_bf16 a[144:147], a[192:195], a[160:163], a[144:147]
    v_add_u32 v31, 0x10000, v31
    v_mfma_f32_16x16x32_bf16 a[144:147], a[196:199], a[164:167], a[144:147]
    v_mfma_f32_16x16x32_bf16 a[144:147], a[200:203], a[168:171], a[144:147]
    v_mfma_f32_16x16x32_bf16 a[144:147], a[204:207], a[172:175], a[144:147]
    buffer_load_dwordx4 a[112:115], v4, s[16:19], s63 offen offset:0 sc1
    v_mfma_f32_16x16x32_bf16 a[148:151], a[220:223], a[172:175], a[148:151]
    v_mfma_f32_16x16x32_bf16 a[148:151], a[216:219], a[168:171], a[148:151]
    v_mfma_f32_16x16x32_bf16 a[148:151], a[212:215], a[164:167], a[148:151]
    v_mfma_f32_16x16x32_bf16 a[148:151], a[208:211], a[160:163], a[148:151]
    buffer_load_dwordx4 a[116:119], v4, s[16:19], s63 offen offset:1024 sc1
    v_mfma_f32_16x16x32_bf16 a[152:155], a[224:227], a[160:163], a[152:155]
    v_mfma_f32_16x16x32_bf16 a[152:155], a[228:231], a[164:167], a[152:155]
    v_mfma_f32_16x16x32_bf16 a[152:155], a[232:235], a[168:171], a[152:155]
    v_mfma_f32_16x16x32_bf16 a[152:155], a[236:239], a[172:175], a[152:155]
    buffer_load_dwordx4 a[120:123], v4, s[16:19], s63 offen offset:2048 sc1
    v_mfma_f32_16x16x32_bf16 a[156:159], a[252:255], a[172:175], a[156:159]
    v_mfma_f32_16x16x32_bf16 a[156:159], a[248:251], a[168:171], a[156:159]
    v_mfma_f32_16x16x32_bf16 a[156:159], a[244:247], a[164:167], a[156:159]
    v_mfma_f32_16x16x32_bf16 a[156:159], a[240:243], a[160:163], a[156:159]
    buffer_load_dwordx4 a[124:127], v4, s[16:19], s63 offen offset:3072 sc1
    s_add_u32 s63, s63, 155648
    s_waitcnt vmcnt(20)
    v_mfma_f32_16x16x32_bf16 a[144:147], v[192:195], a[176:179], a[144:147]
    v_mfma_f32_16x16x32_bf16 a[144:147], v[196:199], a[180:183], a[144:147]
    v_mfma_f32_16x16x32_bf16 a[144:147], v[200:203], a[184:187], a[144:147]
    v_mfma_f32_16x16x32_bf16 a[144:147], v[204:207], a[188:191], a[144:147]
    buffer_load_dwordx4 a[160:163], v4, s[16:19], s63 offen offset:0 sc1
    v_mfma_f32_16x16x32_bf16 a[148:151], v[220:223], a[188:191], a[148:151]
    v_mfma_f32_16x16x32_bf16 a[148:151], v[216:219], a[184:187], a[148:151]
    v_mfma_f32_16x16x32_bf16 a[148:151], v[212:215], a[180:183], a[148:151]
    v_mfma_f32_16x16x32_bf16 a[148:151], v[208:211], a[176:179], a[148:151]
    buffer_load_dwordx4 a[164:167], v4, s[16:19], s63 offen offset:1024 sc1
    v_mfma_f32_16x16x32_bf16 a[152:155], v[224:227], a[176:179], a[152:155]
    v_mfma_f32_16x16x32_bf16 a[152:155], v[228:231], a[180:183], a[152:155]
    v_mfma_f32_16x16x32_bf16 a[152:155], v[232:235], a[184:187], a[152:155]
    v_mfma_f32_16x16x32_bf16 a[152:155], v[236:239], a[188:191], a[152:155]
    buffer_load_dwordx4 a[168:171], v4, s[16:19], s63 offen offset:2048 sc1
    v_mfma_f32_16x16x32_bf16 a[156:159], v[252:255], a[188:191], a[156:159]
    v_mfma_f32_16x16x32_bf16 a[156:159], v[248:251], a[184:187], a[156:159]
    v_mfma_f32_16x16x32_bf16 a[156:159], v[244:247], a[180:183], a[156:159]
    v_mfma_f32_16x16x32_bf16 a[156:159], v[240:243], a[176:179], a[156:159]
    buffer_load_dwordx4 a[172:175], v4, s[16:19], s63 offen offset:3072 sc1
    s_add_u32 s63, s63, 4096
    s_waitcnt vmcnt(18)
    v_mfma_f32_16x16x32_bf16 a[128:131], v[64:67], a[64:67], 0
    v_mfma_f32_16x16x32_bf16 a[128:131], v[68:71], a[68:71], a[128:131]
    v_mfma_f32_16x16x32_bf16 a[128:131], v[72:75], a[72:75], a[128:131]
    v_mfma_f32_16x16x32_bf16 a[128:131], v[76:79], a[76:79], a[128:131]
    ds_write_b128 v32, a[144:147] offset:16384
    buffer_load_dwordx4 a[176:179], v4, s[16:19], s63 offen offset:0 sc1
    v_mfma_f32_16x16x32_bf16 a[132:135], v[92:95], a[76:79], 0
    v_mfma_f32_16x16x32_bf16 a[132:135], v[88:91], a[72:75], a[132:135]
    v_mfma_f32_16x16x32_bf16 a[132:135], v[84:87], a[68:71], a[132:135]
    v_mfma_f32_16x16x32_bf16 a[132:135], v[80:83], a[64:67], a[132:135]
    ds_write_b128 v33, a[148:151] offset:16384
    buffer_load_dwordx4 a[180:183], v4, s[16:19], s63 offen offset:1024 sc1
    v_mfma_f32_16x16x32_bf16 a[136:139], v[96:99], a[64:67], 0
    v_mfma_f32_16x16x32_bf16 a[136:139], v[100:103], a[68:71], a[136:139]
    v_mfma_f32_16x16x32_bf16 a[136:139], v[104:107], a[72:75], a[136:139]
    v_mfma_f32_16x16x32_bf16 a[136:139], v[108:111], a[76:79], a[136:139]
    ds_write_b128 v34, a[152:155] offset:16384
    buffer_load_dwordx4 a[184:187], v4, s[16:19], s63 offen offset:2048 sc1
    v_mfma_f32_16x16x32_bf16 a[140:143], v[124:127], a[76:79], 0
    v_mfma_f32_16x16x32_bf16 a[140:143], v[120:123], a[72:75], a[140:143]
    v_mfma_f32_16x16x32_bf16 a[140:143], v[116:119], a[68:71], a[140:143]
    v_mfma_f32_16x16x32_bf16 a[140:143], v[112:115], a[64:67], a[140:143]
    ds_write_b128 v35, a[156:159] offset:16384
    buffer_load_dwordx4 a[188:191], v4, s[16:19], s63 offen offset:3072 sc1
    s_add_u32 s63, s63, 4096
    s_waitcnt vmcnt(18)
    v_mfma_f32_16x16x32_bf16 a[128:131], a[0:3], a[80:83], a[128:131]
    v_mfma_f32_16x16x32_bf16 a[128:131], a[4:7], a[84:87], a[128:131]
    v_mfma_f32_16x16x32_bf16 a[128:131], a[8:11], a[88:91], a[128:131]
    v_mfma_f32_16x16x32_bf16 a[128:131], a[12:15], a[92:95], a[128:131]
    buffer_load_dwordx4 a[64:67], v4, s[16:19], s63 offen offset:0 sc1
    buffer_load_dwordx4 a[68:71], v4, s[16:19], s63 offen offset:1024 sc1
    v_mfma_f32_16x16x32_bf16 a[132:135], a[28:31], a[92:95], a[132:135]
    v_mfma_f32_16x16x32_bf16 a[132:135], a[24:27], a[88:91], a[132:135]
    v_mfma_f32_16x16x32_bf16 a[132:135], a[20:23], a[84:87], a[132:135]
    v_mfma_f32_16x16x32_bf16 a[132:135], a[16:19], a[80:83], a[132:135]
    buffer_load_dwordx4 a[72:75], v4, s[16:19], s63 offen offset:2048 sc1
    buffer_load_dwordx4 a[76:79], v4, s[16:19], s63 offen offset:3072 sc1
    v_mfma_f32_16x16x32_bf16 a[136:139], a[32:35], a[80:83], a[136:139]
    v_mfma_f32_16x16x32_bf16 a[136:139], a[36:39], a[84:87], a[136:139]
    v_mfma_f32_16x16x32_bf16 a[136:139], a[40:43], a[88:91], a[136:139]
    v_mfma_f32_16x16x32_bf16 a[136:139], a[44:47], a[92:95], a[136:139]
    s_add_u32 s63, s63, 4096
    buffer_load_dwordx4 v[128:131], v4, s[16:19], s43 offen offset:0 sc1
    buffer_load_dwordx4 v[132:135], v4, s[16:19], s43 offen offset:1024 sc1
    v_mfma_f32_16x16x32_bf16 a[140:143], a[60:63], a[92:95], a[140:143]
    v_mfma_f32_16x16x32_bf16 a[140:143], a[56:59], a[88:91], a[140:143]
    v_mfma_f32_16x16x32_bf16 a[140:143], a[52:55], a[84:87], a[140:143]
    v_mfma_f32_16x16x32_bf16 a[140:143], a[48:51], a[80:83], a[140:143]
    buffer_load_dwordx4 v[136:139], v4, s[16:19], s43 offen offset:2048 sc1
    buffer_load_dwordx4 v[140:143], v4, s[16:19], s43 offen offset:3072 sc1
    s_waitcnt vmcnt(20)
    v_mfma_f32_16x16x32_bf16 a[128:131], a[192:195], a[96:99], a[128:131]
    v_mfma_f32_16x16x32_bf16 a[128:131], a[196:199], a[100:103], a[128:131]
    v_mfma_f32_16x16x32_bf16 a[128:131], a[200:203], a[104:107], a[128:131]
    v_mfma_f32_16x16x32_bf16 a[128:131], a[204:207], a[108:111], a[128:131]
    buffer_load_dwordx4 a[80:83], v4, s[16:19], s63 offen offset:0 sc1
    v_mfma_f32_16x16x32_bf16 a[132:135], a[220:223], a[108:111], a[132:135]
    v_mfma_f32_16x16x32_bf16 a[132:135], a[216:219], a[104:107], a[132:135]
    v_mfma_f32_16x16x32_bf16 a[132:135], a[212:215], a[100:103], a[132:135]
    v_mfma_f32_16x16x32_bf16 a[132:135], a[208:211], a[96:99], a[132:135]
    buffer_load_dwordx4 a[84:87], v4, s[16:19], s63 offen offset:1024 sc1
    v_mfma_f32_16x16x32_bf16 a[136:139], a[224:227], a[96:99], a[136:139]
    v_mfma_f32_16x16x32_bf16 a[136:139], a[228:231], a[100:103], a[136:139]
    v_mfma_f32_16x16x32_bf16 a[136:139], a[232:235], a[104:107], a[136:139]
    v_mfma_f32_16x16x32_bf16 a[136:139], a[236:239], a[108:111], a[136:139]
    buffer_load_dwordx4 a[88:91], v4, s[16:19], s63 offen offset:2048 sc1
    v_mfma_f32_16x16x32_bf16 a[140:143], a[252:255], a[108:111], a[140:143]
    v_mfma_f32_16x16x32_bf16 a[140:143], a[248:251], a[104:107], a[140:143]
    v_mfma_f32_16x16x32_bf16 a[140:143], a[244:247], a[100:103], a[140:143]
    v_mfma_f32_16x16x32_bf16 a[140:143], a[240:243], a[96:99], a[140:143]
    buffer_load_dwordx4 a[92:95], v4, s[16:19], s63 offen offset:3072 sc1
    s_add_u32 s63, s63, 155648
    s_waitcnt vmcnt(20)
    v_mfma_f32_16x16x32_bf16 a[128:131], v[192:195], a[112:115], a[128:131]
    v_mfma_f32_16x16x32_bf16 a[128:131], v[196:199], a[116:119], a[128:131]
    v_mfma_f32_16x16x32_bf16 a[128:131], v[200:203], a[120:123], a[128:131]
    v_mfma_f32_16x16x32_bf16 a[128:131], v[204:207], a[124:127], a[128:131]
    v_mfma_f32_16x16x32_bf16 a[132:135], v[220:223], a[124:127], a[132:135]
    v_mfma_f32_16x16x32_bf16 a[132:135], v[216:219], a[120:123], a[132:135]
    v_mfma_f32_16x16x32_bf16 a[132:135], v[212:215], a[116:119], a[132:135]
    v_mfma_f32_16x16x32_bf16 a[132:135], v[208:211], a[112:115], a[132:135]
    v_mfma_f32_16x16x32_bf16 a[136:139], v[224:227], a[112:115], a[136:139]
    v_mfma_f32_16x16x32_bf16 a[136:139], v[228:231], a[116:119], a[136:139]
    v_mfma_f32_16x16x32_bf16 a[136:139], v[232:235], a[120:123], a[136:139]
    v_mfma_f32_16x16x32_bf16 a[136:139], v[236:239], a[124:127], a[136:139]
    v_mfma_f32_16x16x32_bf16 a[140:143], v[252:255], a[124:127], a[140:143]
    v_mfma_f32_16x16x32_bf16 a[140:143], v[248:251], a[120:123], a[140:143]
    v_mfma_f32_16x16x32_bf16 a[140:143], v[244:247], a[116:119], a[140:143]
    v_mfma_f32_16x16x32_bf16 a[140:143], v[240:243], a[112:115], a[140:143]
    s_waitcnt vmcnt(16)
    v_mfma_f32_16x16x32_bf16 a[144:147], v[64:67], a[160:163], 0
    v_mfma_f32_16x16x32_bf16 a[144:147], v[68:71], a[164:167], a[144:147]
    v_mfma_f32_16x16x32_bf16 a[144:147], v[72:75], a[168:171], a[144:147]
    v_mfma_f32_16x16x32_bf16 a[144:147], v[76:79], a[172:175], a[144:147]
    ds_write_b128 v32, a[128:131] offset:32768
    v_mfma_f32_16x16x32_bf16 a[148:151], v[92:95], a[172:175], 0
    v_mfma_f32_16x16x32_bf16 a[148:151], v[88:91], a[168:171], a[148:151]
    v_mfma_f32_16x16x32_bf16 a[148:151], v[84:87], a[164:167], a[148:151]
    v_mfma_f32_16x16x32_bf16 a[148:151], v[80:83], a[160:163], a[148:151]
    ds_write_b128 v33, a[132:135] offset:32768
    v_mfma_f32_16x16x32_bf16 a[152:155], v[96:99], a[160:163], 0
    v_mfma_f32_16x16x32_bf16 a[152:155], v[100:103], a[164:167], a[152:155]
    v_mfma_f32_16x16x32_bf16 a[152:155], v[104:107], a[168:171], a[152:155]
    v_mfma_f32_16x16x32_bf16 a[152:155], v[108:111], a[172:175], a[152:155]
    ds_write_b128 v34, a[136:139] offset:32768
    v_mfma_f32_16x16x32_bf16 a[156:159], v[124:127], a[172:175], 0
    v_mfma_f32_16x16x32_bf16 a[156:159], v[120:123], a[168:171], a[156:159]
    v_mfma_f32_16x16x32_bf16 a[156:159], v[116:119], a[164:167], a[156:159]
    v_mfma_f32_16x16x32_bf16 a[156:159], v[112:115], a[160:163], a[156:159]
    ds_write_b128 v35, a[140:143] offset:32768
    s_waitcnt vmcnt(12)
    v_mfma_f32_16x16x32_bf16 a[144:147], a[0:3], a[176:179], a[144:147]
    v_mfma_f32_16x16x32_bf16 a[144:147], a[4:7], a[180:183], a[144:147]
    v_mfma_f32_16x16x32_bf16 a[144:147], a[8:11], a[184:187], a[144:147]
    v_mfma_f32_16x16x32_bf16 a[144:147], a[12:15], a[188:191], a[144:147]
    v_mfma_f32_16x16x32_bf16 a[148:151], a[28:31], a[188:191], a[148:151]
    v_mfma_f32_16x16x32_bf16 a[148:151], a[24:27], a[184:187], a[148:151]
    v_mfma_f32_16x16x32_bf16 a[148:151], a[20:23], a[180:183], a[148:151]
    v_mfma_f32_16x16x32_bf16 a[148:151], a[16:19], a[176:179], a[148:151]
    v_mfma_f32_16x16x32_bf16 a[152:155], a[32:35], a[176:179], a[152:155]
    v_mfma_f32_16x16x32_bf16 a[152:155], a[36:39], a[180:183], a[152:155]
    v_mfma_f32_16x16x32_bf16 a[152:155], a[40:43], a[184:187], a[152:155]
    v_mfma_f32_16x16x32_bf16 a[152:155], a[44:47], a[188:191], a[152:155]
    v_mfma_f32_16x16x32_bf16 a[156:159], a[60:63], a[188:191], a[156:159]
    v_mfma_f32_16x16x32_bf16 a[156:159], a[56:59], a[184:187], a[156:159]
    v_mfma_f32_16x16x32_bf16 a[156:159], a[52:55], a[180:183], a[156:159]
    v_mfma_f32_16x16x32_bf16 a[156:159], a[48:51], a[176:179], a[156:159]
    s_waitcnt vmcnt(4)
    v_mfma_f32_16x16x32_bf16 a[144:147], a[192:195], a[64:67], a[144:147]
    v_xor_b32 v30, s4, v128
    v_bitop3_b32 v30, v30, v129, s5 bitop3:0xf6
    v_mfma_f32_16x16x32_bf16 a[144:147], a[196:199], a[68:71], a[144:147]
    v_bitop3_b32 v30, v30, v130, s6 bitop3:0xf6
    v_bitop3_b32 v30, v30, v131, s7 bitop3:0xf6
    v_mfma_f32_16x16x32_bf16 a[144:147], a[200:203], a[72:75], a[144:147]
    v_bitop3_b32 v30, v30, v132, s4 bitop3:0xf6
    v_bitop3_b32 v30, v30, v133, s5 bitop3:0xf6
    v_mfma_f32_16x16x32_bf16 a[144:147], a[204:207], a[76:79], a[144:147]
    v_bitop3_b32 v30, v30, v134, s6 bitop3:0xf6
    v_bitop3_b32 v30, v30, v135, s7 bitop3:0xf6
    v_mfma_f32_16x16x32_bf16 a[148:151], a[220:223], a[76:79], a[148:151]
    v_bitop3_b32 v30, v30, v136, s4 bitop3:0xf6
    v_bitop3_b32 v30, v30, v137, s5 bitop3:0xf6
    v_mfma_f32_16x16x32_bf16 a[148:151], a[216:219], a[72:75], a[148:151]
    v_bitop3_b32 v30, v30, v138, s6 bitop3:0xf6
    v_bitop3_b32 v30, v30, v139, s7 bitop3:0xf6
    v_mfma_f32_16x16x32_bf16 a[148:151], a[212:215], a[68:71], a[148:151]
    v_bitop3_b32 v30, v30, v140, s4 bitop3:0xf6
    v_bitop3_b32 v30, v30, v141, s5 bitop3:0xf6
    v_mfma_f32_16x16x32_bf16 a[148:151], a[208:211], a[64:67], a[148:151]
    v_bitop3_b32 v30, v30, v142, s6 bitop3:0xf6
    v_bitop3_b32 v30, v30, v143, s7 bitop3:0xf6
    v_mfma_f32_16x16x32_bf16 a[152:155], a[224:227], a[64:67], a[152:155]
    v_and_b32 v30, 0xff, v30
    v_cmp_ne_u32 vcc, 0, v30
    v_mfma_f32_16x16x32_bf16 a[152:155], a[228:231], a[68:71], a[152:155]
    s_cbranch_vccnz L_ex_retry
L_ex_ok:
    v_and_b32 v128, v29, v128
    v_and_b32 v129, v29, v129
    v_mfma_f32_16x16x32_bf16 a[152:155], a[232:235], a[72:75], a[152:155]
    v_and_b32 v130, v29, v130
    v_and_b32 v131, v29, v131
    v_mfma_f32_16x16x32_bf16 a[152:155], a[236:239], a[76:79], a[152:155]
    v_and_b32 v132, v29, v132
    v_and_b32 v133, v29, v133
    v_mfma_f32_16x16x32_bf16 a[156:159], a[252:255], a[76:79], a[156:159]
    v_and_b32 v134, v29, v134
    v_and_b32 v135, v29, v135
    v_mfma_f32_16x16x32_bf16 a[156:159], a[248:251], a[72:75], a[156:159]
    v_and_b32 v136, v29, v136
    v_and_b32 v137, v29, v137
    v_mfma_f32_16x16x32_bf16 a[156:159], a[244:247], a[68:71], a[156:159]
    v_and_b32 v138, v29, v138
    v_and_b32 v139, v29, v139
    v_mfma_f32_16x16x32_bf16 a[156:159], a[240:243], a[64:67], a[156:159]
    v_and_b32 v140, v29, v140
    v_and_b32 v141, v29, v141
    s_waitcnt vmcnt(0)
    v_mfma_f32_16x16x32_bf16 a[144:147], v[192:195], a[80:83], a[144:147]
    v_and_b32 v142, v29, v142
    v_and_b32 v143, v29, v143
    v_mfma_f32_16x16x32_bf16 a[144:147], v[196:199], a[84:87], a[144:147]
    v_fma_f32 v160, v128, v176, v160
    v_fma_f32 v161, v129, v177, v161
    v_mfma_f32_16x16x32_bf16 a[144:147], v[200:203], a[88:91], a[144:147]
    v_fma_f32 v162, v130, v178, v162
    v_fma_f32 v163, v131, v179, v163
    v_mfma_f32_16x16x32_bf16 a[144:147], v[204:207], a[92:95], a[144:147]
    v_fma_f32 v164, v132, v180, v164
    v_fma_f32 v165, v133, v181, v165
    v_mfma_f32_16x16x32_bf16 a[148:151], v[220:223], a[92:95], a[148:151]
    v_fma_f32 v166, v134, v182, v166
    v_fma_f32 v167, v135, v183, v167
    v_mfma_f32_16x16x32_bf16 a[148:151], v[216:219], a[88:91], a[148:151]
    v_fma_f32 v168, v136, v184, v168
    v_fma_f32 v169, v137, v185, v169
    v_mfma_f32_16x16x32_bf16 a[148:151], v[212:215], a[84:87], a[148:151]
    v_fma_f32 v170, v138, v186, v170
    v_fma_f32 v171, v139, v187, v171
    v_mfma_f32_16x16x32_bf16 a[148:151], v[208:211], a[80:83], a[148:151]
    v_fma_f32 v172, v140, v188, v172
    v_fma_f32 v173, v141, v189, v173
    v_mfma_f32_16x16x32_bf16 a[152:155], v[224:227], a[80:83], a[152:155]
    v_fma_f32 v174, v142, v190, v174
    v_fma_f32 v175, v143, v191, v175
    v_mfma_f32_16x16x32_bf16 a[152:155], v[228:231], a[84:87], a[152:155]
    v_mfma_f32_16x16x32_bf16 a[152:155], v[232:235], a[88:91], a[152:155]
    v_mfma_f32_16x16x32_bf16 a[152:155], v[236:239], a[92:95], a[152:155]
    v_mfma_f32_16x16x32_bf16 a[156:159], v[252:255], a[92:95], a[156:159]
    v_mfma_f32_16x16x32_bf16 a[156:159], v[248:251], a[88:91], a[156:159]
    v_mfma_f32_16x16x32_bf16 a[156:159], v[244:247], a[84:87], a[156:159]
    v_mfma_f32_16x16x32_bf16 a[156:159], v[240:243], a[80:83], a[156:159]
    ds_write_b128 v32, a[144:147] offset:49152
    ds_write_b128 v33, a[148:151] offset:49152
    s_nop 0
    s_nop 0
    ds_write_b128 v34, a[152:155] offset:49152
    s_nop 0
    s_nop 0
    s_nop 0
    ds_write_b128 v35, a[156:159] offset:49152
    s_waitcnt lgkmcnt(0)
    s_barrier
    ds_read_b128 v[64:67], v31 offset:0
    ds_read_b128 v[80:83], v31 offset:4096
    ds_read_b128 v[96:99], v31 offset:8192
    ds_read_b128 v[112:115], v31 offset:12288
    ds_read_b128 v[68:71], v31 offset:256
    ds_read_b128 v[84:87], v31 offset:4352
    ds_read_b128 v[100:103], v31 offset:8448
    ds_read_b128 v[116:119], v31 offset:12544
    ds_read_b128 v[72:75], v31 offset:2048
    ds_read_b128 v[88:91], v31 offset:6144
    ds_read_b128 v[104:107], v31 offset:10240
    ds_read_b128 v[120:123], v31 offset:14336
    ds_read_b128 v[76:79], v31 offset:2304
    ds_read_b128 v[92:95], v31 offset:6400
    ds_read_b128 v[108:111], v31 offset:10496
    ds_read_b128 v[124:127], v31 offset:14592
    s_waitcnt lgkmcnt(12)
    v_pk_add_f32 v[64:65], v[64:65], v[80:81]
    v_pk_add_f32 v[96:97], v[96:97], v[112:113]
    v_pk_add_f32 v[66:67], v[66:67], v[82:83]
    v_pk_add_f32 v[98:99], v[98:99], v[114:115]
    v_pk_add_f32 v[64:65], v[64:65], v[96:97]
    v_pk_add_f32 v[66:67], v[66:67], v[98:99]
    v_pk_fma_f32 v[64:65], v[64:65], v[176:177], v[160:161]
    v_pk_fma_f32 v[66:67], v[66:67], v[178:179], v[162:163]
    v_cvt_pk_bf16_f32 v8, v64, v65
    v_cvt_pk_bf16_f32 v9, v66, v67
    s_waitcnt lgkmcnt(8)
    v_pk_add_f32 v[68:69], v[68:69], v[84:85]
    v_pk_add_f32 v[100:101], v[100:101], v[116:117]
    v_pk_add_f32 v[70:71], v[70:71], v[86:87]
    v_pk_add_f32 v[102:103], v[102:103], v[118:119]
    v_pk_add_f32 v[68:69], v[68:69], v[100:101]
    v_pk_add_f32 v[70:71], v[70:71], v[102:103]
    v_pk_fma_f32 v[68:69], v[68:69], v[180:181], v[164:165]
    v_pk_fma_f32 v[70:71], v[70:71], v[182:183], v[166:167]
    v_cvt_pk_bf16_f32 v10, v68, v69
    v_cvt_pk_bf16_f32 v11, v70, v71
    global_store_dwordx4 v45, v[8:11], s[56:57] offset:0
    s_waitcnt lgkmcnt(4)
    v_pk_add_f32 v[72:73], v[72:73], v[88:89]
    v_pk_add_f32 v[104:105], v[104:105], v[120:121]
    v_pk_add_f32 v[74:75], v[74:75], v[90:91]
    v_pk_add_f32 v[106:107], v[106:107], v[122:123]
    v_pk_add_f32 v[72:73], v[72:73], v[104:105]
    v_pk_add_f32 v[74:75], v[74:75], v[106:107]
    v_pk_fma_f32 v[72:73], v[72:73], v[184:185], v[168:169]
    v_pk_fma_f32 v[74:75], v[74:75], v[186:187], v[170:171]
    v_cvt_pk_bf16_f32 v12, v72, v73
    v_cvt_pk_bf16_f32 v13, v74, v75
    s_waitcnt lgkmcnt(0)
    v_pk_add_f32 v[76:77], v[76:77], v[92:93]
    v_pk_add_f32 v[108:109], v[108:109], v[124:125]
    v_pk_add_f32 v[78:79], v[78:79], v[94:95]
    v_pk_add_f32 v[110:111], v[110:111], v[126:127]
    v_pk_add_f32 v[76:77], v[76:77], v[108:109]
    v_pk_add_f32 v[78:79], v[78:79], v[110:111]
    v_pk_fma_f32 v[76:77], v[76:77], v[188:189], v[172:173]
    v_pk_fma_f32 v[78:79], v[78:79], v[190:191], v[174:175]
    v_cvt_pk_bf16_f32 v14, v76, v77
    v_cvt_pk_bf16_f32 v15, v78, v79
    global_store_dwordx4 v45, v[12:15], s[56:57] offset:64
    s_endpgm
L_fallback:
    s_cmp_lg_u32 s0, 0
    s_cbranch_scc1 L_safe
    s_mov_b32 s0, 1
    s_mov_b32 s62, 0
    s_mov_b32 s63, 0x80
    s_lshl_b32 s3, s21, 19
    s_add_u32 s8, s38, s3
    s_addc_u32 s9, s39, 0
    s_mov_b32 s10, 0x80000
    s_add_u32 s12, s40, s3
    s_addc_u32 s13, s41, 0
    s_mov_b32 s14, 0x80000
    s_mov_b32 s23, 0
    s_mov_b32 s24, 0
    s_mov_b32 s34, 0x4000
    s_mov_b32 s35, 0x4000
    s_mov_b32 s27, 0
    v_lshlrev_b32 v3, 4, v0
    v_lshrrev_b32 v60, 2, v2
    v_and_b32 v61, 1, v1
    v_lshl_add_u32 v60, v61, 2, v60
    v_and_b32 v63, 3, v0
    s_waitcnt vmcnt(0) lgkmcnt(0)
    s_barrier
    v_lshl_add_u32 v61, v1, 8, s25
    v_xor_b32 v62, v1, v2
    v_lshl_add_u32 v16, v62, 4, v61
    v_xor_b32 v17, 64, v16
    v_xor_b32 v18, 128, v16
    v_xor_b32 v19, 192, v16
    v_lshlrev_b32 v62, 1, v1
    v_xor_b32 v62, v62, v2
    v_lshl_add_u32 v20, v62, 4, v61
    v_xor_b32 v21, 128, v20
    v_lshrrev_b32 v61, 2, v0
    v_lshlrev_b32 v61, 8, v61
    v_lshl_add_u32 v61, v63, 3, v61
    v_lshl_add_u32 v61, v60, 5, v61
    v_add_u32 v8, 65536, v61
    v_xor_b32 v9, 32, v8
    v_xor_b32 v10, 64, v8
    v_xor_b32 v11, 96, v8
    v_xor_b32 v12, 128, v8
    v_xor_b32 v13, 160, v8
    v_xor_b32 v14, 192, v8
    v_xor_b32 v15, 224, v8
    v_lshrrev_b32 v61, 1, v1
    v_and_b32 v62, 1, v1
    v_lshl_add_u32 v62, v62, 1, v61
    v_lshl_add_u32 v62, s20, 2, v62
    v_xor_b32 v61, v62, v2
    v_lshlrev_b32 v61, 4, v61
    v_lshl_add_u32 v4, v2, 8, v61
    v_xor_b32 v5, 64, v4
    v_xor_b32 v6, 128, v4
    v_xor_b32 v7, 192, v4
    v_mov_b32 v1, v20
    v_mov_b32 v2, v21
    v_mov_b32 v44, 0
    v_mov_b32 v45, 0
    v_mov_b32 v46, 0
    v_mov_b32 v47, 0
    v_mov_b32 v48, 0
    v_mov_b32 v49, 0
    v_mov_b32 v50, 0
    v_mov_b32 v51, 0
    v_mov_b32 v52, 0
    v_mov_b32 v53, 0
    v_mov_b32 v54, 0
    v_mov_b32 v55, 0
    v_mov_b32 v56, 0
    v_mov_b32 v57, 0
    v_mov_b32 v58, 0
    v_mov_b32 v59, 0
    v_mov_b32 v28, 0
    v_mov_b32 v29, 0
    v_mov_b32 v30, 0
    v_mov_b32 v31, 0
    v_mov_b32 v32, 0
    v_mov_b32 v33, 0
    v_mov_b32 v34, 0
    v_mov_b32 v35, 0
    v_mov_b32 v36, 0
    v_mov_b32 v37, 0
    v_mov_b32 v38, 0
    v_mov_b32 v39, 0
    v_mov_b32 v40, 0
    v_mov_b32 v41, 0
    v_mov_b32 v42, 0
    v_mov_b32 v43, 0
    v_mfma_f32_32x32x16_bf16 a[0:15], v[44:47], v[44:47], 0
    v_mfma_f32_32x32x16_bf16 a[16:31], v[44:47], v[44:47], 0
    v_mfma_f32_32x32x16_bf16 a[32:47], v[44:47], v[44:47], 0
    v_mfma_f32_32x32x16_bf16 a[48:63], v[44:47], v[44:47], 0
    v_mfma_f32_32x32x16_bf16 a[64:79], v[44:47], v[44:47], 0
    v_mfma_f32_32x32x16_bf16 a[80:95], v[44:47], v[44:47], 0
    v_mfma_f32_32x32x16_bf16 a[96:111], v[44:47], v[44:47], 0
    v_mfma_f32_32x32x16_bf16 a[112:127], v[44:47], v[44:47], 0
    v_mov_b32 v60, 0xff800000
    v_mov_b32 v61, 0xff800000
    v_mov_b32 v62, 0xff800000
    v_mov_b32 v63, 0xff800000
L_fb_loop:
    s_add_u32 m0, s25, 0
    s_nop 0
    buffer_load_dwordx4 v16, s[8:11], s23 offen offset:0 nt lds
    buffer_load_dwordx4 v17, s[8:11], s23 offen offset:1024 nt lds
    buffer_load_dwordx4 v18, s[8:11], s23 offen offset:2048 nt lds
    buffer_load_dwordx4 v19, s[8:11], s23 offen offset:3072 nt lds
    s_add_u32 s23, s23, 0x4000
    s_bitset0_b32 s23, 19
    s_waitcnt vmcnt(0)
    s_barrier
    ds_read_b128 a[128:131], v4 offset:0
    ds_read_b128 a[132:135], v5 offset:0
    ds_read_b128 a[136:139], v6 offset:0
    ds_read_b128 a[140:143], v7 offset:0
    ds_read_b128 a[144:147], v4 offset:4096
    ds_read_b128 a[148:151], v5 offset:4096
    ds_read_b128 a[152:155], v6 offset:4096
    ds_read_b128 a[156:159], v7 offset:4096
    ds_read_b128 a[160:163], v4 offset:8192
    ds_read_b128 a[164:167], v5 offset:8192
    ds_read_b128 a[168:171], v6 offset:8192
    ds_read_b128 a[172:175], v7 offset:8192
    ds_read_b128 a[176:179], v4 offset:12288
    ds_read_b128 a[180:183], v5 offset:12288
    ds_read_b128 a[184:187], v6 offset:12288
    ds_read_b128 a[188:191], v7 offset:12288
    s_waitcnt lgkmcnt(0)
    s_barrier
    v_mfma_f32_16x16x32_bf16 v[128:131], a[128:131], v[64:67], v[44:47]
    v_mfma_f32_16x16x32_bf16 v[128:131], a[132:135], v[68:71], v[128:131]
    v_mfma_f32_16x16x32_bf16 v[128:131], a[136:139], v[72:75], v[128:131]
    v_mfma_f32_16x16x32_bf16 v[128:131], a[140:143], v[76:79], v[128:131]
    v_mfma_f32_16x16x32_bf16 v[132:135], a[156:159], v[76:79], v[44:47]
    v_mfma_f32_16x16x32_bf16 v[132:135], a[152:155], v[72:75], v[132:135]
    v_mfma_f32_16x16x32_bf16 v[132:135], a[148:151], v[68:71], v[132:135]
    v_mfma_f32_16x16x32_bf16 v[132:135], a[144:147], v[64:67], v[132:135]
    v_mfma_f32_16x16x32_bf16 v[136:139], a[160:163], v[64:67], v[44:47]
    v_mfma_f32_16x16x32_bf16 v[136:139], a[164:167], v[68:71], v[136:139]
    v_mfma_f32_16x16x32_bf16 v[136:139], a[168:171], v[72:75], v[136:139]
    v_mfma_f32_16x16x32_bf16 v[136:139], a[172:175], v[76:79], v[136:139]
    v_mfma_f32_16x16x32_bf16 v[140:143], a[188:191], v[76:79], v[44:47]
    v_mfma_f32_16x16x32_bf16 v[140:143], a[184:187], v[72:75], v[140:143]
    v_mfma_f32_16x16x32_bf16 v[140:143], a[180:183], v[68:71], v[140:143]
    v_mfma_f32_16x16x32_bf16 v[140:143], a[176:179], v[64:67], v[140:143]
    v_mfma_f32_16x16x32_bf16 v[144:147], a[128:131], v[80:83], v[48:51]
    v_mfma_f32_16x16x32_bf16 v[144:147], a[132:135], v[84:87], v[144:147]
    v_mfma_f32_16x16x32_bf16 v[144:147], a[136:139], v[88:91], v[144:147]
    v_mfma_f32_16x16x32_bf16 v[144:147], a[140:143], v[92:95], v[144:147]
    v_mfma_f32_16x16x32_bf16 v[148:151], a[156:159], v[92:95], v[48:51]
    v_mfma_f32_16x16x32_bf16 v[148:151], a[152:155], v[88:91], v[148:151]
    v_mfma_f32_16x16x32_bf16 v[148:151], a[148:151], v[84:87], v[148:151]
    v_mfma_f32_16x16x32_bf16 v[148:151], a[144:147], v[80:83], v[148:151]
    v_mfma_f32_16x16x32_bf16 v[152:155], a[160:163], v[80:83], v[48:51]
    v_mfma_f32_16x16x32_bf16 v[152:155], a[164:167], v[84:87], v[152:155]
    v_mfma_f32_16x16x32_bf16 v[152:155], a[168:171], v[88:91], v[152:155]
    v_mfma_f32_16x16x32_bf16 v[152:155], a[172:175], v[92:95], v[152:155]
    v_mfma_f32_16x16x32_bf16 v[156:159], a[188:191], v[92:95], v[48:51]
    v_mfma_f32_16x16x32_bf16 v[156:159], a[184:187], v[88:91], v[156:159]
    v_mfma_f32_16x16x32_bf16 v[156:159], a[180:183], v[84:87], v[156:159]
    v_mfma_f32_16x16x32_bf16 v[156:159], a[176:179], v[80:83], v[156:159]
    v_mfma_f32_16x16x32_bf16 v[160:163], a[128:131], v[96:99], v[52:55]
    v_mfma_f32_16x16x32_bf16 v[160:163], a[132:135], v[100:103], v[160:163]
    v_mfma_f32_16x16x32_bf16 v[160:163], a[136:139], v[104:107], v[160:163]
    v_mfma_f32_16x16x32_bf16 v[160:163], a[140:143], v[108:111], v[160:163]
    v_mfma_f32_16x16x32_bf16 v[164:167], a[156:159], v[108:111], v[52:55]
    v_mfma_f32_16x16x32_bf16 v[164:167], a[152:155], v[104:107], v[164:167]
    v_mfma_f32_16x16x32_bf16 v[164:167], a[148:151], v[100:103], v[164:167]
    v_mfma_f32_16x16x32_bf16 v[164:167], a[144:147], v[96:99], v[164:167]
    v_mfma_f32_16x16x32_bf16 v[168:171], a[160:163], v[96:99], v[52:55]
    v_mfma_f32_16x16x32_bf16 v[168:171], a[164:167], v[100:103], v[168:171]
    v_mfma_f32_16x16x32_bf16 v[168:171], a[168:171], v[104:107], v[168:171]
    v_mfma_f32_16x16x32_bf16 v[168:171], a[172:175], v[108:111], v[168:171]
    v_mfma_f32_16x16x32_bf16 v[172:175], a[188:191], v[108:111], v[52:55]
    v_mfma_f32_16x16x32_bf16 v[172:175], a[184:187], v[104:107], v[172:175]
    v_mfma_f32_16x16x32_bf16 v[172:175], a[180:183], v[100:103], v[172:175]
    v_mfma_f32_16x16x32_bf16 v[172:175], a[176:179], v[96:99], v[172:175]
    v_mfma_f32_16x16x32_bf16 v[176:179], a[128:131], v[112:115], v[56:59]
    v_mfma_f32_16x16x32_bf16 v[176:179], a[132:135], v[116:119], v[176:179]
    v_mfma_f32_16x16x32_bf16 v[176:179], a[136:139], v[120:123], v[176:179]
    v_mfma_f32_16x16x32_bf16 v[176:179], a[140:143], v[124:127], v[176:179]
    v_mfma_f32_16x16x32_bf16 v[180:183], a[156:159], v[124:127], v[56:59]
    v_mfma_f32_16x16x32_bf16 v[180:183], a[152:155], v[120:123], v[180:183]
    v_mfma_f32_16x16x32_bf16 v[180:183], a[148:151], v[116:119], v[180:183]
    v_mfma_f32_16x16x32_bf16 v[180:183], a[144:147], v[112:115], v[180:183]
    v_mfma_f32_16x16x32_bf16 v[184:187], a[160:163], v[112:115], v[56:59]
    v_mfma_f32_16x16x32_bf16 v[184:187], a[164:167], v[116:119], v[184:187]
    v_mfma_f32_16x16x32_bf16 v[184:187], a[168:171], v[120:123], v[184:187]
    v_mfma_f32_16x16x32_bf16 v[184:187], a[172:175], v[124:127], v[184:187]
    v_mfma_f32_16x16x32_bf16 v[188:191], a[188:191], v[124:127], v[56:59]
    v_mfma_f32_16x16x32_bf16 v[188:191], a[184:187], v[120:123], v[188:191]
    v_mfma_f32_16x16x32_bf16 v[188:191], a[180:183], v[116:119], v[188:191]
    v_mfma_f32_16x16x32_bf16 v[188:191], a[176:179], v[112:115], v[188:191]
    s_nop 7
    v_max3_f32 v60, v60, v128, v129
    v_max3_f32 v60, v60, v130, v131
    v_max3_f32 v60, v60, v132, v133
    v_max3_f32 v60, v60, v134, v135
    v_max3_f32 v60, v60, v136, v137
    v_max3_f32 v60, v60, v138, v139
    v_max3_f32 v60, v60, v140, v141
    v_max3_f32 v60, v60, v142, v143
    v_max3_f32 v61, v61, v144, v145
    v_max3_f32 v61, v61, v146, v147
    v_max3_f32 v61, v61, v148, v149
    v_max3_f32 v61, v61, v150, v151
    v_max3_f32 v61, v61, v152, v153
    v_max3_f32 v61, v61, v154, v155
    v_max3_f32 v61, v61, v156, v157
    v_max3_f32 v61, v61, v158, v159
    v_max3_f32 v62, v62, v160, v161
    v_max3_f32 v62, v62, v162, v163
    v_max3_f32 v62, v62, v164, v165
    v_max3_f32 v62, v62, v166, v167
    v_max3_f32 v62, v62, v168, v169
    v_max3_f32 v62, v62, v170, v171
    v_max3_f32 v62, v62, v172, v173
    v_max3_f32 v62, v62, v174, v175
    v_max3_f32 v63, v63, v176, v177
    v_max3_f32 v63, v63, v178, v179
    v_max3_f32 v63, v63, v180, v181
    v_max3_f32 v63, v63, v182, v183
    v_max3_f32 v63, v63, v184, v185
    v_max3_f32 v63, v63, v186, v187
    v_max3_f32 v63, v63, v188, v189
    v_max3_f32 v63, v63, v190, v191
    s_and_b32 s3, s23, 0x7ffff
    s_cbranch_scc1 L_fb_loop
    s_mov_b32 s23, 0
    s_add_u32 m0, s25, 0
    s_nop 0
    buffer_load_dwordx4 v16, s[8:11], s23 offen offset:0 nt lds
    buffer_load_dwordx4 v17, s[8:11], s23 offen offset:1024 nt lds
    buffer_load_dwordx4 v18, s[8:11], s23 offen offset:2048 nt lds
    buffer_load_dwordx4 v19, s[8:11], s23 offen offset:3072 nt lds
    s_add_u32 s23, s23, 0x4000
    s_bitset0_b32 s23, 19
    s_add_u32 m0, s25, 16384
    s_nop 0
    buffer_load_dwordx4 v16, s[8:11], s23 offen offset:0 nt lds
    buffer_load_dwordx4 v17, s[8:11], s23 offen offset:1024 nt lds
    buffer_load_dwordx4 v18, s[8:11], s23 offen offset:2048 nt lds
    buffer_load_dwordx4 v19, s[8:11], s23 offen offset:3072 nt lds
    s_add_u32 s23, s23, 0x4000
    s_bitset0_b32 s23, 19
    s_add_u32 m0, s26, 16384
    s_nop 0
    buffer_load_dwordx4 v20, s[12:15], s24 offen offset:0 nt lds
    buffer_load_dwordx4 v21, s[12:15], s24 offen offset:1024 nt lds
    buffer_load_dwordx4 v20, s[12:15], s24 offen offset:2048 nt lds
    buffer_load_dwordx4 v21, s[12:15], s24 offen offset:3072 nt lds
    s_add_u32 s24, s24, 0x4000
    s_bitset0_b32 s24, 19
    s_add_u32 m0, s25, 32768
    s_nop 0
    buffer_load_dwordx4 v16, s[8:11], s23 offen offset:0 nt lds
    buffer_load_dwordx4 v17, s[8:11], s23 offen offset:1024 nt lds
    buffer_load_dwordx4 v18, s[8:11], s23 offen offset:2048 nt lds
    buffer_load_dwordx4 v19, s[8:11], s23 offen offset:3072 nt lds
    s_add_u32 s23, s23, 0x4000
    s_bitset0_b32 s23, 19
    s_add_u32 m0, s26, 32768
    s_nop 0
    buffer_load_dwordx4 v20, s[12:15], s24 offen offset:0 nt lds
    buffer_load_dwordx4 v21, s[12:15], s24 offen offset:1024 nt lds
    buffer_load_dwordx4 v20, s[12:15], s24 offen offset:2048 nt lds
    buffer_load_dwordx4 v21, s[12:15], s24 offen offset:3072 nt lds
    s_add_u32 s24, s24, 0x4000
    s_bitset0_b32 s24, 19
    s_add_u32 m0, s25, 49152
    s_nop 0
    buffer_load_dwordx4 v16, s[8:11], s23 offen offset:0 nt lds
    buffer_load_dwordx4 v17, s[8:11], s23 offen offset:1024 nt lds
    buffer_load_dwordx4 v18, s[8:11], s23 offen offset:2048 nt lds
    buffer_load_dwordx4 v19, s[8:11], s23 offen offset:3072 nt lds
    s_add_u32 s23, s23, 0x4000
    s_bitset0_b32 s23, 19
    s_add_u32 m0, s26, 49152
    s_nop 0
    buffer_load_dwordx4 v20, s[12:15], s24 offen offset:0 nt lds
    buffer_load_dwordx4 v21, s[12:15], s24 offen offset:1024 nt lds
    buffer_load_dwordx4 v20, s[12:15], s24 offen offset:2048 nt lds
    buffer_load_dwordx4 v21, s[12:15], s24 offen offset:3072 nt lds
    s_add_u32 s24, s24, 0x4000
    s_bitset0_b32 s24, 19
    v_mov_b32 v128, v60
    v_mov_b32 v129, v61
    v_mov_b32 v130, v62
    v_mov_b32 v131, v63
    s_nop 1
    v_permlane32_swap_b32 v128, v60
    v_permlane32_swap_b32 v129, v61
    v_permlane32_swap_b32 v130, v62
    v_permlane32_swap_b32 v131, v63
    s_nop 1
    v_max_f32 v60, v60, v128
    v_max_f32 v61, v61, v129
    v_max_f32 v62, v62, v130
    v_max_f32 v63, v63, v131
    v_mov_b32 v128, v60
    v_mov_b32 v129, v61
    v_mov_b32 v130, v62
    v_mov_b32 v131, v63
    s_nop 1
    v_permlane16_swap_b32 v128, v60
    v_permlane16_swap_b32 v129, v61
    v_permlane16_swap_b32 v130, v62
    v_permlane16_swap_b32 v131, v63
    s_nop 1
    v_max_f32 v60, v60, v128
    v_max_f32 v61, v61, v129
    v_max_f32 v62, v62, v130
    v_max_f32 v63, v63, v131
    v_sub_f32 v44, 0, v60
    v_sub_f32 v45, 0, v60
    v_sub_f32 v46, 0, v60
    v_sub_f32 v47, 0, v60
    v_sub_f32 v48, 0, v61
    v_sub_f32 v49, 0, v61
    v_sub_f32 v50, 0, v61
    v_sub_f32 v51, 0, v61
    v_sub_f32 v52, 0, v62
    v_sub_f32 v53, 0, v62
    v_sub_f32 v54, 0, v62
    v_sub_f32 v55, 0, v62
    v_sub_f32 v56, 0, v63
    v_sub_f32 v57, 0, v63
    v_sub_f32 v58, 0, v63
    v_sub_f32 v59, 0, v63
    s_waitcnt vmcnt(0)
    s_barrier
    ds_read_b128 a[128:131], v4 offset:0
    ds_read_b128 a[132:135], v5 offset:0
    ds_read_b128 a[136:139], v6 offset:0
    ds_read_b128 a[140:143], v7 offset:0
    ds_read_b128 a[144:147], v4 offset:4096
    ds_read_b128 a[148:151], v5 offset:4096
    ds_read_b128 a[152:155], v6 offset:4096
    ds_read_b128 a[156:159], v7 offset:4096
    ds_read_b128 a[160:163], v4 offset:8192
    ds_read_b128 a[164:167], v5 offset:8192
    ds_read_b128 a[168:171], v6 offset:8192
    ds_read_b128 a[172:175], v7 offset:8192
    ds_read_b128 a[176:179], v4 offset:12288
    ds_read_b128 a[180:183], v5 offset:12288
    ds_read_b128 a[184:187], v6 offset:12288
    ds_read_b128 a[188:191], v7 offset:12288
    s_waitcnt lgkmcnt(0)
    s_branch L_restart
L_nonce_retry:
    s_cmp_eq_u32 s33, 0
    s_cbranch_scc1 L_nonce_ok
    s_sub_u32 s33, s33, 1
    global_load_dword v23, v55, s[58:59] sc1
    s_waitcnt vmcnt(0)
    v_readfirstlane_b32 s46, v23
    s_nop 0
    s_cmp_eq_u32 s46, 0
    s_cbranch_scc1 L_nonce_retry
    s_branch L_nonce_ok
L_stat_retry:
    s_cmp_eq_u32 s33, 0
    s_cbranch_scc1 L_stat_ok
    s_sub_u32 s33, s33, 1
    buffer_load_dwordx2 v[44:45], v61, s[16:19], s1 offen offset:0 sc1
    buffer_load_dwordx2 v[48:49], v61, s[16:19], s1 offen offset:128 sc1
    buffer_load_dwordx2 v[52:53], v61, s[16:19], s1 offen offset:256 sc1
    buffer_load_dwordx2 v[56:57], v61, s[16:19], s1 offen offset:384 sc1
    s_waitcnt vmcnt(0)
    v_xor_b32 v46, s46, v45
    v_xor_b32 v50, s46, v49
    v_xor_b32 v54, s46, v53
    v_xor_b32 v58, s46, v57
    v_or3_b32 v46, v46, v50, v54
    v_or_b32 v46, v46, v58
    v_cmp_ne_u32 vcc, 0, v46
    s_cbranch_vccnz L_stat_retry
    s_branch L_stat_ok
L_key_retry:
    s_cmp_eq_u32 s33, 0
    s_cbranch_scc1 L_key_ok
    s_sub_u32 s33, s33, 1
    s_mov_b32 s3, 16793600
    buffer_load_dwordx4 v[128:131], v3, s[16:19], s3 offen offset:0 sc1
    buffer_load_dwordx4 v[132:135], v3, s[16:19], s3 offen offset:1024 sc1
    buffer_load_dwordx4 v[136:139], v3, s[16:19], s3 offen offset:2048 sc1
    buffer_load_dwordx4 v[140:143], v3, s[16:19], s3 offen offset:3072 sc1
    s_mov_b32 s3, 16797696
    buffer_load_dwordx4 v[144:147], v3, s[16:19], s3 offen offset:0 sc1
    buffer_load_dwordx4 v[148:151], v3, s[16:19], s3 offen offset:1024 sc1
    buffer_load_dwordx4 v[152:155], v3, s[16:19], s3 offen offset:2048 sc1
    buffer_load_dwordx4 v[156:159], v3, s[16:19], s3 offen offset:3072 sc1
    s_mov_b32 s3, 16801792
    buffer_load_dwordx4 v[160:163], v3, s[16:19], s3 offen offset:0 sc1
    buffer_load_dwordx4 v[164:167], v3, s[16:19], s3 offen offset:1024 sc1
    buffer_load_dwordx4 v[168:171], v3, s[16:19], s3 offen offset:2048 sc1
    buffer_load_dwordx4 v[172:175], v3, s[16:19], s3 offen offset:3072 sc1
    s_mov_b32 s3, 16805888
    buffer_load_dwordx4 v[176:179], v3, s[16:19], s3 offen offset:0 sc1
    buffer_load_dwordx4 v[180:183], v3, s[16:19], s3 offen offset:1024 sc1
    buffer_load_dwordx4 v[184:187], v3, s[16:19], s3 offen offset:2048 sc1
    buffer_load_dwordx4 v[224:227], v3, s[16:19], s3 offen offset:3072 sc1
    s_waitcnt vmcnt(0)
    v_mov_b32 v228, 0
    v_bitop3_b32 v228, v228, v130, s46 bitop3:0xf6
    v_bitop3_b32 v228, v228, v134, s46 bitop3:0xf6
    v_bitop3_b32 v228, v228, v138, s46 bitop3:0xf6
    v_bitop3_b32 v228, v228, v142, s46 bitop3:0xf6
    v_bitop3_b32 v228, v228, v146, s46 bitop3:0xf6
    v_bitop3_b32 v228, v228, v150, s46 bitop3:0xf6
    v_bitop3_b32 v228, v228, v154, s46 bitop3:0xf6
    v_bitop3_b32 v228, v228, v158, s46 bitop3:0xf6
    v_bitop3_b32 v228, v228, v162, s46 bitop3:0xf6
    v_bitop3_b32 v228, v228, v166, s46 bitop3:0xf6
    v_bitop3_b32 v228, v228, v170, s46 bitop3:0xf6
    v_bitop3_b32 v228, v228, v174, s46 bitop3:0xf6
    v_bitop3_b32 v228, v228, v178, s46 bitop3:0xf6
    v_bitop3_b32 v228, v228, v182, s46 bitop3:0xf6
    v_bitop3_b32 v228, v228, v186, s46 bitop3:0xf6
    v_bitop3_b32 v228, v228, v226, s46 bitop3:0xf6
    v_cmp_ne_u32 vcc, 0, v228
    s_cbranch_vccnz L_key_retry
    s_mov_b32 s3, 16793600
    buffer_load_dword v234, v232, s[16:19], s3 offen sc1
    s_waitcnt vmcnt(0)
    s_branch L_key_ok
L_rank:
    s_cmp_eq_u32 s64, 0
    s_cbranch_scc1 L_rank_done
    v_mov_b32 v236, 0
    v_cmp_lt_u32 s[4:5], s64, v128
    v_cmp_lt_u32 s[6:7], s64, v129
    v_cmp_lt_u32 vcc, s64, v132
    v_addc_co_u32 v236, s[4:5], 0, v236, s[4:5]
    v_addc_co_u32 v236, s[6:7], 0, v236, s[6:7]
    v_addc_co_u32 v236, vcc, 0, v236, vcc
    v_cmp_lt_u32 s[4:5], s64, v133
    v_cmp_lt_u32 s[6:7], s64, v136
    v_cmp_lt_u32 vcc, s64, v137
    v_addc_co_u32 v236, s[4:5], 0, v236, s[4:5]
    v_addc_co_u32 v236, s[6:7], 0, v236, s[6:7]
    v_addc_co_u32 v236, vcc, 0, v236, vcc
    v_cmp_lt_u32 s[4:5], s64, v140
    v_cmp_lt_u32 s[6:7], s64, v141
    v_cmp_lt_u32 vcc, s64, v144
    v_addc_co_u32 v236, s[4:5], 0, v236, s[4:5]
    v_addc_co_u32 v236, s[6:7], 0, v236, s[6:7]
    v_addc_co_u32 v236, vcc, 0, v236, vcc
    v_cmp_lt_u32 s[4:5], s64, v145
    v_cmp_lt_u32 s[6:7], s64, v148
    v_cmp_lt_u32 vcc, s64, v149
    v_addc_co_u32 v236, s[4:5], 0, v236, s[4:5]
    v_addc_co_u32 v236, s[6:7], 0, v236, s[6:7]
    v_addc_co_u32 v236, vcc, 0, v236, vcc
    v_cmp_lt_u32 s[4:5], s64, v152
    v_cmp_lt_u32 s[6:7], s64, v153
    v_cmp_lt_u32 vcc, s64, v156
    v_addc_co_u32 v236, s[4:5], 0, v236, s[4:5]
    v_addc_co_u32 v236, s[6:7], 0, v236, s[6:7]
    v_addc_co_u32 v236, vcc, 0, v236, vcc
    v_cmp_lt_u32 s[4:5], s64, v157
    v_cmp_lt_u32 s[6:7], s64, v160
    v_cmp_lt_u32 vcc, s64, v161
    v_addc_co_u32 v236, s[4:5], 0, v236, s[4:5]
    v_addc_co_u32 v236, s[6:7], 0, v236, s[6:7]
    v_addc_co_u32 v236, vcc, 0, v236, vcc
    v_cmp_lt_u32 s[4:5], s64, v164
    v_cmp_lt_u32 s[6:7], s64, v165
    v_cmp_lt_u32 vcc, s64, v168
    v_addc_co_u32 v236, s[4:5], 0, v236, s[4:5]
    v_addc_co_u32 v236, s[6:7], 0, v236, s[6:7]
    v_addc_co_u32 v236, vcc, 0, v236, vcc
    v_cmp_lt_u32 s[4:5], s64, v169
    v_cmp_lt_u32 s[6:7], s64, v172
    v_cmp_lt_u32 vcc, s64, v173
    v_addc_co_u32 v236, s[4:5], 0, v236, s[4:5]
    v_addc_co_u32 v236, s[6:7], 0, v236, s[6:7]
    v_addc_co_u32 v236, vcc, 0, v236, vcc
    v_cmp_lt_u32 s[4:5], s64, v176
    v_cmp_lt_u32 s[6:7], s64, v177
    v_cmp_lt_u32 vcc, s64, v180
    v_addc_co_u32 v236, s[4:5], 0, v236, s[4:5]
    v_addc_co_u32 v236, s[6:7], 0, v236, s[6:7]
    v_addc_co_u32 v236, vcc, 0, v236, vcc
    v_cmp_lt_u32 s[4:5], s64, v181
    v_cmp_lt_u32 s[6:7], s64, v184
    v_cmp_lt_u32 vcc, s64, v185
    v_addc_co_u32 v236, s[4:5], 0, v236, s[4:5]
    v_addc_co_u32 v236, s[6:7], 0, v236, s[6:7]
    v_addc_co_u32 v236, vcc, 0, v236, vcc
    v_cmp_lt_u32 s[4:5], s64, v224
    v_cmp_lt_u32 s[6:7], s64, v225
    s_nop 0
    v_addc_co_u32 v236, s[4:5], 0, v236, s[4:5]
    v_addc_co_u32 v236, s[6:7], 0, v236, s[6:7]
    s_nop 1
    v_add_u32_dpp v236, v236, v236 quad_perm:[1,0,3,2] row_mask:0xf bank_mask:0xf
    s_nop 1
    v_add_u32_dpp v236, v236, v236 quad_perm:[2,3,0,1] row_mask:0xf bank_mask:0xf
    s_nop 1
    v_add_u32_dpp v236, v236, v236 row_half_mirror row_mask:0xf bank_mask:0xf
    s_nop 1
    v_add_u32_dpp v236, v236, v236 row_mirror row_mask:0xf bank_mask:0xf
    s_nop 1
    v_add_u32_dpp v236, v236, v236 row_bcast:15 row_mask:0xa bank_mask:0xf
    s_nop 1
    v_add_u32_dpp v236, v236, v236 row_bcast:31 row_mask:0xc bank_mask:0xf
    s_nop 1
    v_readlane_b32 s68, v236, 63
    s_cmp_ge_u32 s68, 8
    s_cbranch_scc1 L_rank_done
    s_not_b32 s3, s64
    s_xor_b32 s67, s64, 0x80000000
    s_bitcmp1_b32 s64, 31
    s_cselect_b32 s3, s67, s3
    s_and_b32 s3, s3, 0xffff0000
    v_mov_b32 v230, 0xbfb8aa3b
    v_mul_f32 v230, s3, v230
    v_exp_f32 v230, v230
    s_andn2_b32 s67, 0x7ff, s64
    v_add_f32 v230, 1.0, v230
    v_rcp_f32 v230, v230
    s_lshl_b32 s68, s68, 3
    v_cvt_pk_bf16_f32 v230, v230, v230
    v_and_b32 v230, 0xffff0000, v230
    v_or_b32 v230, s67, v230
    v_mov_b32 v231, s46
    s_add_u32 s68, s68, 16809984
    s_mov_b64 exec, 1
    buffer_store_dwordx2 v[230:231], off, s[16:19], s68 sc1
    s_mov_b64 exec, -1
    v_cmp_ne_u32 vcc, s64, v234
    s_nop 1
    v_cndmask_b32 v234, 0, v234, vcc
    s_nop 1
    v_max_u32_dpp v235, v234, v234 quad_perm:[1,0,3,2] row_mask:0xf bank_mask:0xf
    s_nop 1
    v_max_u32_dpp v235, v235, v235 quad_perm:[2,3,0,1] row_mask:0xf bank_mask:0xf
    s_nop 1
    v_max_u32_dpp v235, v235, v235 row_half_mirror row_mask:0xf bank_mask:0xf
    s_nop 1
    v_max_u32_dpp v235, v235, v235 row_mirror row_mask:0xf bank_mask:0xf
    s_nop 0
    v_readlane_b32 s3, v235, 0
    v_readlane_b32 s67, v235, 16
    s_max_u32 s64, s3, s67
    v_cmp_lt_u32 vcc, s64, v228
    s_bcnt1_i32_b64 s3, vcc
    s_cmp_lt_u32 s3, 8
    s_cbranch_scc1 L_rank
    s_branch L_rank_done
L_sel_retry:
    s_cmp_eq_u32 s33, 0
    s_cbranch_scc1 L_sel_ok
    s_sub_u32 s33, s33, 1
    v_and_b32 v128, 7, v0
    v_lshlrev_b32 v128, 3, v128
    v_add_u32 v128, 16809984, v128
    buffer_load_dwordx2 v[60:61], v128, s[16:19], 0 offen sc1
    s_waitcnt vmcnt(0)
    v_cmp_ne_u32 vcc, s46, v61
    s_cbranch_vccnz L_sel_retry
    s_branch L_sel_ok
L_fc_retry:
    s_cmp_eq_u32 s33, 0
    s_cbranch_scc1 L_fc_ok
    s_sub_u32 s33, s33, 1
    v_min_u32 v128, 55, v0
    v_lshlrev_b32 v128, 3, v128
    s_lshr_b32 s3, s2, 6
    s_lshl_b32 s3, s3, 9
    s_add_u32 s3, s3, 16814080
    buffer_load_dwordx2 v[62:63], v128, s[16:19], s3 offen sc1
    s_waitcnt vmcnt(0)
    v_xor_b32 v129, s46, v62
    v_bitop3_b32 v129, v129, v63, s46 bitop3:0xf6
    v_cmp_ne_u32 vcc, 0, v129
    s_cbranch_vccnz L_fc_retry
    s_branch L_fc_ok
L_sel2_retry:
    s_cmp_eq_u32 s33, 0
    s_cbranch_scc1 L_sel2_ok
    s_sub_u32 s33, s33, 1
    buffer_load_dwordx2 v[152:153], v154, s[16:19], 0 offen sc1
    s_waitcnt vmcnt(0)
    v_cmp_ne_u32 vcc, s46, v153
    s_cbranch_vccnz L_sel2_retry
    s_branch L_sel2_ok
L_stf_retry:
    s_cmp_eq_u32 s33, 0
    s_cbranch_scc1 L_stf_ok
    s_sub_u32 s33, s33, 1
    buffer_load_dwordx2 v[46:47], v14, s[16:19], 0 offen sc1
    buffer_load_dwordx4 v[160:163], v15, s[16:19], s67 offen offset:0 sc1
    buffer_load_dwordx4 v[164:167], v15, s[16:19], s67 offen offset:16 sc1
    buffer_load_dwordx4 v[168:171], v15, s[16:19], s67 offen offset:128 sc1
    buffer_load_dwordx4 v[172:175], v15, s[16:19], s67 offen offset:144 sc1
    s_waitcnt vmcnt(0)
    v_xor_b32 v10, s46, v47
    v_bitop3_b32 v10, v10, v162, v11 bitop3:0xf6
    v_bitop3_b32 v10, v10, v166, v11 bitop3:0xf6
    v_bitop3_b32 v10, v10, v170, v11 bitop3:0xf6
    v_bitop3_b32 v10, v10, v174, v11 bitop3:0xf6
    v_cmp_ne_u32 vcc, 0, v10
    s_cbranch_vccnz L_stf_retry
    s_branch L_stf_ok
L_ex_retry:
    s_cmp_eq_u32 s33, 0
    s_cbranch_scc1 L_ex_ok
    s_sub_u32 s33, s33, 1
    buffer_load_dwordx4 v[128:131], v4, s[16:19], s43 offen offset:0 sc1
    buffer_load_dwordx4 v[132:135], v4, s[16:19], s43 offen offset:1024 sc1
    buffer_load_dwordx4 v[136:139], v4, s[16:19], s43 offen offset:2048 sc1
    buffer_load_dwordx4 v[140:143], v4, s[16:19], s43 offen offset:3072 sc1
    s_waitcnt vmcnt(0)
    v_xor_b32 v30, s4, v128
    v_bitop3_b32 v30, v30, v129, s5 bitop3:0xf6
    v_bitop3_b32 v30, v30, v130, s6 bitop3:0xf6
    v_bitop3_b32 v30, v30, v131, s7 bitop3:0xf6
    v_bitop3_b32 v30, v30, v132, s4 bitop3:0xf6
    v_bitop3_b32 v30, v30, v133, s5 bitop3:0xf6
    v_bitop3_b32 v30, v30, v134, s6 bitop3:0xf6
    v_bitop3_b32 v30, v30, v135, s7 bitop3:0xf6
    v_bitop3_b32 v30, v30, v136, s4 bitop3:0xf6
    v_bitop3_b32 v30, v30, v137, s5 bitop3:0xf6
    v_bitop3_b32 v30, v30, v138, s6 bitop3:0xf6
    v_bitop3_b32 v30, v30, v139, s7 bitop3:0xf6
    v_bitop3_b32 v30, v30, v140, s4 bitop3:0xf6
    v_bitop3_b32 v30, v30, v141, s5 bitop3:0xf6
    v_bitop3_b32 v30, v30, v142, s6 bitop3:0xf6
    v_bitop3_b32 v30, v30, v143, s7 bitop3:0xf6
    v_and_b32 v30, 0xff, v30
    v_cmp_ne_u32 vcc, 0, v30
    s_cbranch_vccnz L_ex_retry
    s_branch L_ex_ok
L_end:
    s_endpgm
.section .rodata,"a"
.p2align 6
.amdhsa_kernel recurrent_scan__mha_block_cached__moe_arch_mod__prompt_kernel
  .amdhsa_next_free_vgpr 512
  .amdhsa_next_free_sgpr 102
  .amdhsa_accum_offset 256
  .amdhsa_group_segment_fixed_size 0
  .amdhsa_kernarg_size 104
  .amdhsa_user_sgpr_count 2
  .amdhsa_user_sgpr_kernarg_segment_ptr 1
  .amdhsa_system_sgpr_workgroup_id_x 1
  .amdhsa_float_denorm_mode_32 3
.end_amdhsa_kernel
```
